```python
import torch

def _softmax(x, axis=-1):
    return torch.softmax(x, dim=axis)

def _gelu(x):
    return torch.nn.functional.gelu(x, approximate='tanh')

def _silu(x):
    return torch.nn.functional.silu(x)

def _sigmoid(x):
    return torch.sigmoid(x)

def _layernorm(x, axis=-1, eps=1e-05):
    m = x.mean(dim=axis, keepdim=True)
    v = x.var(dim=axis, keepdim=True, unbiased=False)
    return (x - m) / torch.sqrt(v + eps)

def _scatter_add(tgt, idx, src, axis=0):
    return tgt.clone().index_add_(axis, idx, src)

def _segment_sum(src, seg, n):
    out = torch.zeros((n,) + src.shape[1:], dtype=src.dtype)
    return out.index_add_(0, seg, src)

def _pad(x, pw):
    flat = tuple((v for pair in reversed(pw) for v in pair))
    return torch.nn.functional.pad(x, flat)
kernel_name = 'adaLN_cond__grouped_kv_mqa__dense_activation_relu__prompt'

def setup_inputs():

    _w = lambda a: (lambda t: t.to(torch.bfloat16) if t.is_floating_point() else t)(torch.as_tensor(a))

    def _A_setup():
        B, S, D, H = (1, 2048, 1024, 32)
        Dh = D // H
        return {'x': _w((lambda *s: torch.randn(*s, dtype=torch.bfloat16) * 0.05)(B, S, D)), 'wq': _w((lambda *s: torch.randn(*s, dtype=torch.bfloat16) * 0.05)(D, H * Dh)), 'wk': _w((lambda *s: torch.randn(*s, dtype=torch.bfloat16) * 0.05)(D, Dh)), 'wv': _w((lambda *s: torch.randn(*s, dtype=torch.bfloat16) * 0.05)(D, Dh)), 'wo': _w((lambda *s: torch.randn(*s, dtype=torch.bfloat16) * 0.05)(H * Dh, D))}
    _A_in = _A_setup()

    def _B_setup():
        B, S, D, Dff = (1, 2048, 1024, 3584)
        return {'x': _w((lambda *s: torch.randn(*s, dtype=torch.bfloat16) * 0.05)(B, S, D)), 'w1': _w((lambda *s: torch.randn(*s, dtype=torch.bfloat16) * 0.05)(D, Dff)), 'w2': _w((lambda *s: torch.randn(*s, dtype=torch.bfloat16) * 0.05)(Dff, D))}
    _B_in = _B_setup()
    return {'A_x': _A_in['x'], 'A_wq': _A_in['wq'], 'A_wk': _A_in['wk'], 'A_wv': _A_in['wv'], 'A_wo': _A_in['wo'], 'B_x': _B_in['x'], 'B_w1': _B_in['w1'], 'B_w2': _B_in['w2'], 'c': _w((lambda *s: torch.randn(*s, dtype=torch.bfloat16) * 0.2)(1, 1024) * 8.0), 'w_mod': _w((lambda *s: torch.randn(*s, dtype=torch.bfloat16) * 0.2)(1024, 6 * 1024) * 1024 ** (-0.5) * 8.0)}

def reference(A_x, A_wq, A_wk, A_wv, A_wo, B_x, B_w1, B_w2, c, w_mod):

    def _A_ref(x, wq, wk, wv, wo):
        B, S, D = x.shape
        H = 32
        Dh = D // H
        q = (lambda x, *d: x.permute(*d))((x @ wq).reshape(B, S, H, Dh), 0, 2, 1, 3)
        k = x @ wk
        v = x @ wv
        scores = torch.einsum('bhqd,bkd->bhqk', q, k) * Dh ** (-0.5)
        p = _softmax(scores, axis=-1)
        o = torch.einsum('bhqk,bkd->bhqd', p, v)
        return (lambda x, *d: x.permute(*d))(o, 0, 2, 1, 3).reshape(B, S, H * Dh) @ wo

    def _B_ref(x, w1, w2):
        h = torch.einsum('bsd,df->bsf', x, w1)
        zero = torch.zeros_like(h)
        h = torch.maximum(h, zero)
        return torch.einsum('bsf,fd->bsd', h, w2)
    x = A_x
    mod = (_silu(c) @ w_mod).reshape(c.shape[0], 6, 1, -1)
    sa, ca, ga, sb, cb, gb = (mod[:, 0].clone(), mod[:, 1].clone(), mod[:, 2].clone(), mod[:, 3].clone(), mod[:, 4].clone(), mod[:, 5].clone())
    h = _layernorm(x, axis=-1) * (1 + ca) + sa
    x = x + ga * _A_ref(h, A_wq, A_wk, A_wv, A_wo)
    h = _layernorm(x, axis=-1) * (1 + cb) + sb
    x = x + gb * _B_ref(h, B_w1, B_w2)
    return x
```

```asm
; @launch kernel=k3_attn_kernel grid=(256,1,1) block=(512,1,1) lds=163840
.amdgcn_target "amdgcn-amd-amdhsa--gfx950"
.text
.p2align 8
k3_attn_kernel:
    s_cmp_ge_u32 s2, 256
    s_cbranch_scc1 .Lk3_end_1
    s_load_dwordx2 s[6:7], s[0:1], 96
    s_load_dwordx2 s[4:5], s[0:1], 0
    s_load_dwordx2 s[8:9], s[0:1], 64
    s_load_dwordx2 s[10:11], s[0:1], 72
    s_load_dwordx2 s[70:71], s[0:1], 8
    v_lshrrev_b32 v1, 6, v0
    s_nop 0
    v_readfirstlane_b32 s95, v1
    s_and_b32 s14, s2, 7
    s_lshr_b32 s15, s2, 3
    s_and_b32 s94, s15, 3
    s_and_b32 s13, s14, 1
    s_lshl_b32 s13, s13, 2
    s_add_u32 s13, s13, s94
    s_lshr_b32 s3, s15, 2
    s_lshr_b32 s12, s14, 1
    s_lshl_b32 s12, s12, 3
    s_add_u32 s12, s12, s3
    s_lshl_b32 s94, s94, 1
    s_add_u32 s94, s94, s3
    s_lshl_b32 s94, s94, 29
    v_and_b32 v2, 63, v0
    s_mov_b32 s96, 0xffff0000
    s_brev_b32 s49, 8
    s_cmp_ge_u32 s95, 4
    s_cbranch_scc1 .Lk3_loader_2
    s_setprio 2
    s_load_dwordx2 s[58:59], s[0:1], 16
    s_load_dwordx2 s[60:61], s[0:1], 24
    v_lshrrev_b32 v4, 2, v0
    s_mov_b32 s3, 49152
    v_mul_u32_u24 v3, s3, v4
    v_and_b32 v11, 3, v0
    v_lshl_add_u32 v3, v11, 4, v3
    v_lshlrev_b32 v4, 3, v4
    v_mov_b32 v8, 0
    s_and_b32 s40, s14, 1
    s_lshl_b32 s40, s40, 5
    s_add_u32 s40, s40, s15
    s_lshr_b32 s41, s14, 1
    s_mul_i32 s42, s41, 3145728
    s_lshl_b32 s3, s40, 6
    s_add_u32 s42, s42, s3
    s_lshl_b32 s43, s41, 9
    s_waitcnt lgkmcnt(0)
    s_mov_b32 s16, s10
    s_mov_b32 s17, s11
    s_mov_b32 s18, 12582912
    s_mov_b32 s19, 0x20000
    s_mov_b32 s20, s8
    s_mov_b32 s21, s9
    s_mov_b32 s22, 2048
    s_mov_b32 s23, 0x20000
    s_add_u32 s32, s6, 458752
    s_addc_u32 s33, s7, 0
    s_mov_b32 s34, 37120
    s_mov_b32 s35, 0x20000
    buffer_load_dwordx4 v[32:35], v3, s[16:19], s42 offen nt
    buffer_load_dwordx2 v[16:17], v4, s[20:23], s43 offen
    s_mov_b32 s3, 36864
    buffer_load_dword v14, v8, s[32:35], s3 offen sc1
    s_add_u32 s42, s42, 12288
    buffer_load_dwordx4 v[36:39], v3, s[16:19], s42 offen nt
    s_add_u32 s42, s42, 12288
    buffer_load_dwordx4 v[40:43], v3, s[16:19], s42 offen nt
    s_add_u32 s42, s42, 12288
    buffer_load_dwordx4 v[44:47], v3, s[16:19], s42 offen nt
    s_getpc_b64 s[64:65]
.Lk3_here_3:
    s_mov_b32 s66, .Lk3_end_1-.Lk3_here_3
    s_mov_b32 s67, 0x20000
    v_lshlrev_b32 v9, 2, v0
    s_lshl_b32 s3, s15, 10
    buffer_load_dword v229, v9, s[64:67], s3 offen
    v_and_b32 v6, 15, v2
    v_lshrrev_b32 v7, 4, v2
    s_lshl_b32 s44, s12, 2
    s_lshr_b32 s3, s13, 1
    s_add_u32 s44, s44, s3
    v_lshlrev_b32 v9, 4, v2
    s_and_b32 s48, s13, 1
    s_cmp_eq_u32 s48, 0
    s_cselect_b32 s58, s58, s60
    s_cselect_b32 s59, s59, s61
    s_mov_b32 s20, s58
    s_mov_b32 s21, s59
    s_mov_b32 s22, 65536
    s_mov_b32 s23, 0x20000
    s_mov_b32 s60, s70
    s_mov_b32 s61, s71
    s_mov_b32 s62, 2097152
    s_mov_b32 s63, 0x20000
    s_add_u32 s24, s6, 5242880
    s_addc_u32 s25, s7, 0
    s_mov_b32 s26, 4194304
    s_mov_b32 s27, 0x20000
    s_add_u32 s28, s6, 131072
    s_addc_u32 s29, s7, 0
    s_mov_b32 s30, 262144
    s_mov_b32 s31, 0x20000
    s_add_u32 s36, s6, 393216
    s_addc_u32 s37, s7, 0
    s_mov_b32 s38, 32768
    s_mov_b32 s39, 0x20000
    v_lshrrev_b32 v3, 5, v2
    v_lshlrev_b32 v8, 11, v3
    v_lshrrev_b32 v4, 2, v2
    v_and_b32 v4, 3, v4
    v_lshl_add_u32 v8, v4, 7, v8
    v_lshrrev_b32 v5, 1, v4
    s_and_b32 s3, s95, 1
    v_xor_b32 v5, s3, v5
    v_lshl_add_u32 v8, v5, 6, v8
    v_and_b32 v5, 1, v7
    v_lshl_add_u32 v8, v5, 5, v8
    v_lshl_add_u32 v8, v11, 3, v8
    s_lshr_b32 s3, s95, 1
    s_lshl_b32 s3, s3, 9
    s_add_u32 s3, s3, 32768
    v_add_u32 v8, s3, v8
    v_add_u32 v10, 65536, v8
    v_lshl_add_u32 v15, v7, 3, v4
    v_lshlrev_b32 v15, 6, v15
    v_lshl_add_u32 v15, v11, 3, v15
    v_lshl_add_u32 v15, v5, 5, v15
    s_lshl_b32 s3, s95, 14
    s_add_u32 s3, s3, 32768
    v_add_u32 v15, s3, v15
    v_xor_b32 v204, 32, v15
    v_xor_b32 v207, v6, v7
    v_lshlrev_b32 v207, 4, v207
    v_lshl_add_u32 v207, v7, 8, v207
    s_lshl_b32 s3, s95, 13
    s_add_u32 s3, s3, 65536
    v_add_u32 v207, s3, v207
    v_add_u32 v205, s3, v9
    v_xor_b32 v1, 64, v207
    v_add_u32 v1, 1024, v1
    s_lshl_b32 s3, s13, 1
    s_and_b32 s3, s3, 12
    v_add_u32 v0, s3, v6
    v_and_b32 v0, 15, v0
    v_lshlrev_b32 v13, 15, v5
    v_lshl_add_u32 v13, v3, 8, v13
    v_lshl_add_u32 v13, v0, 4, v13
    s_lshl_b32 s46, s12, 7
    s_lshl_b32 s3, s13, 2
    s_add_u32 s46, s46, s3
    s_add_u32 s46, s46, s95
    s_lshl_b32 s46, s46, 10
    s_cmp_eq_u32 s48, 0
    s_cselect_b64 vcc, -1, 0
    s_cselect_b32 s56, 0x3e8293ee, 1.0
    v_cndmask_b32 v206, v3, v5, vcc
    v_cndmask_b32 v0, v5, v3, vcc
    v_lshlrev_b32 v206, 9, v206
    v_lshl_add_u32 v206, v0, 3, v206
    v_lshl_add_u32 v206, v6, 4, v206
    s_lshr_b32 s3, s95, 1
    s_lshl_b32 s3, s3, 30
    v_or_b32 v206, s3, v206
    s_and_b32 s3, s44, 1
    s_cmp_eq_u32 s48, 0
    s_cselect_b32 s45, s95, s3
    s_cselect_b32 s47, s3, s95
    s_lshl_b32 s45, s45, 10
    s_lshl_b32 s47, s47, 8
    s_add_u32 s45, s45, s47
    s_lshl_b32 s47, s48, 11
    s_add_u32 s45, s45, s47
    s_lshr_b32 s47, s44, 1
    s_lshl_b32 s47, s47, 12
    s_add_u32 s45, s45, s47
    v_lshlrev_b32 v0, 1, v3
    v_xor_b32 v0, v11, v0
    v_lshrrev_b32 v228, 2, v2
    v_lshlrev_b32 v228, 6, v228
    v_lshl_add_u32 v228, v0, 4, v228
    v_lshlrev_b32 v11, 5, v11
    v_lshl_add_u32 v11, v7, 3, v11
    s_lshl_b32 s3, s95, 7
    s_add_u32 s3, s3, 0
    v_add_u32 v11, s3, v11
    v_and_b32 v5, 7, v2
    v_mov_b32 v4, 0x3f803f80
    v_cmp_eq_u32 vcc, 0, v5
    v_cmp_eq_u32 s[52:53], 4, v5
    v_mov_b32 v12, 0xdddddddd
    v_cndmask_b32 v200, 0, v4, vcc
    v_cndmask_b32 v201, 0, v4, vcc
    v_cndmask_b32 v202, 0, v4, s[52:53]
    v_cndmask_b32 v203, 0, v4, s[52:53]
    v_bfe_u32 v4, v2, 4, 1
    v_xor_b32 v3, v3, v4
    v_lshlrev_b32 v3, 4, v3
    v_lshl_add_u32 v3, v5, 5, v3
    v_bfe_u32 v4, v2, 3, 2
    v_lshl_add_u32 v4, v4, 10, v3
    s_mov_b32 s50, 0xbfb8aa3b
    s_mov_b32 s51, 0x9e3779b1
    s_waitcnt vmcnt(4)
    v_mul_lo_u32 v14, v14, s51
    v_add_u32 v14, 0x7f4a7c15, v14
    v_lshlrev_b32 v18, 16, v16
    v_and_b32 v19, s96, v16
    v_lshlrev_b32 v20, 16, v17
    v_and_b32 v21, s96, v17
    v_readfirstlane_b32 s100, v14
    v_mul_f32 v22, s50, v18
    v_mul_f32 v23, s50, v19
    v_mul_f32 v24, s50, v20
    v_mul_f32 v25, s50, v21
    v_exp_f32 v22, v22
    v_exp_f32 v23, v23
    v_exp_f32 v24, v24
    v_exp_f32 v25, v25
    v_add_f32 v22, 1.0, v22
    v_add_f32 v23, 1.0, v23
    v_add_f32 v24, 1.0, v24
    v_add_f32 v25, 1.0, v25
    v_rcp_f32 v22, v22
    v_rcp_f32 v23, v23
    v_rcp_f32 v24, v24
    v_rcp_f32 v25, v25
    v_mul_f32 v18, v18, v22
    v_mul_f32 v19, v19, v23
    v_mul_f32 v20, v20, v24
    v_mul_f32 v21, v21, v25
    v_cvt_pk_bf16_f32 v22, v18, v19
    v_lshlrev_b32 v18, 16, v22
    v_and_b32 v19, s96, v22
    v_cvt_pk_bf16_f32 v23, v20, v21
    v_lshlrev_b32 v20, 16, v23
    v_and_b32 v21, s96, v23
    v_lshlrev_b32 v56, 16, v32
    v_and_b32 v57, s96, v32
    v_lshlrev_b32 v58, 16, v33
    v_and_b32 v59, s96, v33
    v_lshlrev_b32 v60, 16, v34
    v_and_b32 v61, s96, v34
    v_lshlrev_b32 v62, 16, v35
    v_and_b32 v63, s96, v35
    v_mul_f32 v48, v56, v18
    v_mul_f32 v49, v57, v18
    v_mul_f32 v50, v58, v18
    v_mul_f32 v51, v59, v18
    v_mul_f32 v52, v60, v18
    v_mul_f32 v53, v61, v18
    v_mul_f32 v54, v62, v18
    v_mul_f32 v55, v63, v18
    s_waitcnt vmcnt(3)
    v_lshlrev_b32 v56, 16, v36
    v_and_b32 v57, s96, v36
    v_lshlrev_b32 v58, 16, v37
    v_and_b32 v59, s96, v37
    v_lshlrev_b32 v60, 16, v38
    v_and_b32 v61, s96, v38
    v_lshlrev_b32 v62, 16, v39
    v_and_b32 v63, s96, v39
    v_fmac_f32 v48, v56, v19
    v_fmac_f32 v49, v57, v19
    v_fmac_f32 v50, v58, v19
    v_fmac_f32 v51, v59, v19
    v_fmac_f32 v52, v60, v19
    v_fmac_f32 v53, v61, v19
    v_fmac_f32 v54, v62, v19
    v_fmac_f32 v55, v63, v19
    s_waitcnt vmcnt(2)
    v_lshlrev_b32 v56, 16, v40
    v_and_b32 v57, s96, v40
    v_lshlrev_b32 v58, 16, v41
    v_and_b32 v59, s96, v41
    v_lshlrev_b32 v60, 16, v42
    v_and_b32 v61, s96, v42
    v_lshlrev_b32 v62, 16, v43
    v_and_b32 v63, s96, v43
    v_fmac_f32 v48, v56, v20
    v_fmac_f32 v49, v57, v20
    v_fmac_f32 v50, v58, v20
    v_fmac_f32 v51, v59, v20
    v_fmac_f32 v52, v60, v20
    v_fmac_f32 v53, v61, v20
    v_fmac_f32 v54, v62, v20
    v_fmac_f32 v55, v63, v20
    s_waitcnt vmcnt(1)
    v_lshlrev_b32 v56, 16, v44
    v_and_b32 v57, s96, v44
    v_lshlrev_b32 v58, 16, v45
    v_and_b32 v59, s96, v45
    v_lshlrev_b32 v60, 16, v46
    v_and_b32 v61, s96, v46
    v_lshlrev_b32 v62, 16, v47
    v_and_b32 v63, s96, v47
    v_fmac_f32 v48, v56, v21
    v_fmac_f32 v49, v57, v21
    v_fmac_f32 v50, v58, v21
    v_fmac_f32 v51, v59, v21
    v_fmac_f32 v52, v60, v21
    v_fmac_f32 v53, v61, v21
    v_fmac_f32 v54, v62, v21
    v_fmac_f32 v55, v63, v21
    v_permlane32_swap_b32 v48, v52
    v_permlane32_swap_b32 v49, v53
    v_permlane32_swap_b32 v50, v54
    v_permlane32_swap_b32 v51, v55
    v_add_f32 v48, v48, v52
    v_add_f32 v49, v49, v53
    v_add_f32 v50, v50, v54
    v_add_f32 v51, v51, v55
    s_lshl_b32 s3, s95, 2
    s_add_u32 s3, s3, 512
    v_mov_b32 v16, s3
    v_permlane16_swap_b32 v48, v50
    v_permlane16_swap_b32 v49, v51
    v_add_f32 v48, v48, v50
    v_add_f32 v49, v49, v51
    s_nop 0
    v_add_f32_dpp v48, v48, v48 row_ror:8 row_mask:0xf bank_mask:0xf
    v_add_f32_dpp v49, v49, v49 row_ror:8 row_mask:0xf bank_mask:0xf
    s_nop 0
    v_add_f32_dpp v48, v48, v48 row_ror:4 row_mask:0xf bank_mask:0xf
    v_add_f32_dpp v49, v49, v49 row_ror:4 row_mask:0xf bank_mask:0xf
    s_mov_b32 exec_lo, 0x000f000f
    s_mov_b32 exec_hi, 0x000f000f
    ds_write_b64 v11, v[48:49]
    s_mov_b64 exec, 1
    ds_write_b32 v16, v14
    s_mov_b64 exec, -1
    s_cmp_lg_u32 s95, 0
    s_cbranch_scc1 .Lk3_np_4
    v_mov_b32 v16, 512
    v_and_b32 v17, 0x70, v9
    v_add_u32 v17, 0, v17
    s_mov_b64 exec, 0xff
    s_lshl_b32 s42, s41, 13
    s_lshl_b32 s3, s40, 7
    s_add_u32 s42, s42, s3
    s_mov_b32 s52, 0x100000
    s_mov_b32 s53, 0x07060503
    s_mov_b32 s54, 0x07060502
    s_mov_b32 s55, 0x07060501
.Lk3_sp_6:
    ds_read_b128 v[20:23], v16
    ds_read_b128 v[32:35], v17 offset:0
    ds_read_b128 v[36:39], v17 offset:128
    ds_read_b128 v[40:43], v17 offset:256
    ds_read_b128 v[44:47], v17 offset:384
    s_waitcnt lgkmcnt(4)
    v_xor_b32 v21, v21, v14
    v_xor_b32 v22, v22, v14
    v_xor_b32 v23, v23, v14
    v_or3_b32 v21, v21, v22, v23
    v_cmp_eq_u32 vcc, 0, v21
    s_waitcnt lgkmcnt(0)
    s_cbranch_vccnz .Lk3_so_7
    s_sub_u32 s52, s52, 1
    s_cbranch_scc0 .Lk3_sp_6
.Lk3_so_7:
    v_add_f32 v32, v32, v36
    v_add_f32 v40, v40, v44
    v_add_f32 v33, v33, v37
    v_add_f32 v41, v41, v45
    v_add_f32 v34, v34, v38
    v_add_f32 v42, v42, v46
    v_add_f32 v35, v35, v39
    v_add_f32 v43, v43, v47
    v_add_f32 v35, v35, v43
    v_add_f32 v32, v32, v40
    v_add_f32 v33, v33, v41
    v_add_f32 v34, v34, v42
    v_perm_b32 v32, v32, v35, s53
    v_perm_b32 v33, v33, v35, s54
    v_perm_b32 v34, v34, v35, s55
    v_mov_b32 v35, v14
    buffer_store_dwordx4 v[32:35], v9, s[32:35], s42 offen sc1
    s_mov_b64 exec, -1
    s_branch .Lk3_pj_5
.Lk3_np_4:
.Lk3_pj_5:
    s_setprio 0
    v_bfe_u32 v224, v2, 3, 1
    v_bfe_u32 v225, v2, 4, 1
    v_lshl_add_u32 v224, v225, 3, v224
    v_lshlrev_b32 v225, 2, v225
    v_and_b32 v0, 7, v2
    v_xor_b32 v225, v225, v0
    v_lshrrev_b32 v0, 5, v2
    v_lshlrev_b32 v224, 11, v224
    v_lshl_add_u32 v224, v0, 7, v224
    v_lshl_add_u32 v224, v225, 4, v224
    v_add_u32 v225, 31744, v224
    v_add_u32 v226, 63488, v224
    v_add_u32 v227, 95232, v224
    s_lshl_b32 s98, s95, 12
    s_lshl_b32 s97, s13, 8
    s_add_u32 s97, s97, s98
    s_lshl_b32 s44, s95, 14
    s_mov_b32 s47, s94
    s_add_u32 m0, s44, 32768
    s_lshr_b32 s3, s94, 16
    s_add_u32 s3, s3, s44
    s_and_b32 s3, s3, 0xffff
    s_add_u32 s44, s44, 4096
    buffer_load_dwordx4 v228, s[20:23], s3 offen offset:0 lds
    buffer_load_dwordx4 v228, s[20:23], s3 offen offset:1024 lds
    buffer_load_dwordx4 v228, s[20:23], s3 offen offset:2048 lds
    buffer_load_dwordx4 v228, s[20:23], s3 offen offset:3072 lds
    s_add_u32 m0, s44, 32768
    s_lshr_b32 s3, s94, 16
    s_add_u32 s3, s3, s44
    s_and_b32 s3, s3, 0xffff
    s_add_u32 s44, s44, 4096
    buffer_load_dwordx4 v228, s[20:23], s3 offen offset:0 lds
    buffer_load_dwordx4 v228, s[20:23], s3 offen offset:1024 lds
    buffer_load_dwordx4 v228, s[20:23], s3 offen offset:2048 lds
    buffer_load_dwordx4 v228, s[20:23], s3 offen offset:3072 lds
    s_add_u32 m0, s44, 32768
    s_lshr_b32 s3, s94, 16
    s_add_u32 s3, s3, s44
    s_and_b32 s3, s3, 0xffff
    s_add_u32 s44, s44, 4096
    buffer_load_dwordx4 v228, s[20:23], s3 offen offset:0 lds
    buffer_load_dwordx4 v228, s[20:23], s3 offen offset:1024 lds
    buffer_load_dwordx4 v228, s[20:23], s3 offen offset:2048 lds
    buffer_load_dwordx4 v228, s[20:23], s3 offen offset:3072 lds
    s_add_u32 m0, s44, 32768
    s_lshr_b32 s3, s94, 16
    s_add_u32 s3, s3, s44
    s_and_b32 s3, s3, 0xffff
    s_add_u32 s44, s44, 4096
    buffer_load_dwordx4 v228, s[20:23], s3 offen offset:0 lds
    buffer_load_dwordx4 v228, s[20:23], s3 offen offset:1024 lds
    buffer_load_dwordx4 v228, s[20:23], s3 offen offset:2048 lds
    buffer_load_dwordx4 v228, s[20:23], s3 offen offset:3072 lds
    s_barrier
    s_add_u32 m0, s98, 98304
    s_lshr_b32 s99, s47, 11
    s_add_u32 s99, s99, s97
    s_add_u32 s47, s47, s49
    buffer_load_dwordx4 v224, s[60:63], s99 offen offset:0 lds
    buffer_load_dwordx4 v225, s[60:63], s99 offen offset:1024 lds
    buffer_load_dwordx4 v226, s[60:63], s99 offen offset:2048 lds
    buffer_load_dwordx4 v227, s[60:63], s99 offen offset:3072 lds
    s_add_u32 m0, s98, 114688
    s_lshr_b32 s99, s47, 11
    s_add_u32 s99, s99, s97
    s_add_u32 s47, s47, s49
    buffer_load_dwordx4 v224, s[60:63], s99 offen offset:0 lds
    buffer_load_dwordx4 v225, s[60:63], s99 offen offset:1024 lds
    buffer_load_dwordx4 v226, s[60:63], s99 offen offset:2048 lds
    buffer_load_dwordx4 v227, s[60:63], s99 offen offset:3072 lds
    s_add_u32 m0, s98, 131072
    s_lshr_b32 s99, s47, 11
    s_add_u32 s99, s99, s97
    s_add_u32 s47, s47, s49
    buffer_load_dwordx4 v224, s[60:63], s99 offen offset:0 lds
    buffer_load_dwordx4 v225, s[60:63], s99 offen offset:1024 lds
    buffer_load_dwordx4 v226, s[60:63], s99 offen offset:2048 lds
    buffer_load_dwordx4 v227, s[60:63], s99 offen offset:3072 lds
    s_add_u32 m0, s98, 147456
    s_lshr_b32 s99, s47, 11
    s_add_u32 s99, s99, s97
    s_add_u32 s47, s47, s49
    buffer_load_dwordx4 v224, s[60:63], s99 offen offset:0 lds
    buffer_load_dwordx4 v225, s[60:63], s99 offen offset:1024 lds
    buffer_load_dwordx4 v226, s[60:63], s99 offen offset:2048 lds
    buffer_load_dwordx4 v227, s[60:63], s99 offen offset:3072 lds
    s_waitcnt vmcnt(16)
    ds_read_b64_tr_b16 v[112:113], v15 offset:0
    ds_read_b64_tr_b16 v[114:115], v15 offset:256
    ds_read_b64_tr_b16 v[116:117], v204 offset:0
    ds_read_b64_tr_b16 v[118:119], v204 offset:256
    ds_read_b64_tr_b16 v[120:121], v15 offset:2048
    ds_read_b64_tr_b16 v[122:123], v15 offset:2304
    ds_read_b64_tr_b16 v[124:125], v204 offset:2048
    ds_read_b64_tr_b16 v[126:127], v204 offset:2304
    ds_read_b64_tr_b16 v[128:129], v15 offset:4096
    ds_read_b64_tr_b16 v[130:131], v15 offset:4352
    ds_read_b64_tr_b16 v[132:133], v204 offset:4096
    ds_read_b64_tr_b16 v[134:135], v204 offset:4352
    ds_read_b64_tr_b16 v[136:137], v15 offset:6144
    ds_read_b64_tr_b16 v[138:139], v15 offset:6400
    ds_read_b64_tr_b16 v[140:141], v204 offset:6144
    ds_read_b64_tr_b16 v[142:143], v204 offset:6400
    ds_read_b64_tr_b16 v[144:145], v15 offset:8192
    ds_read_b64_tr_b16 v[146:147], v15 offset:8448
    ds_read_b64_tr_b16 v[148:149], v204 offset:8192
    ds_read_b64_tr_b16 v[150:151], v204 offset:8448
    ds_read_b64_tr_b16 v[152:153], v15 offset:10240
    ds_read_b64_tr_b16 v[154:155], v15 offset:10496
    ds_read_b64_tr_b16 v[156:157], v204 offset:10240
    ds_read_b64_tr_b16 v[158:159], v204 offset:10496
    ds_read_b64_tr_b16 v[160:161], v15 offset:12288
    ds_read_b64_tr_b16 v[162:163], v15 offset:12544
    ds_read_b64_tr_b16 v[164:165], v204 offset:12288
    ds_read_b64_tr_b16 v[166:167], v204 offset:12544
    ds_read_b64_tr_b16 v[168:169], v15 offset:14336
    ds_read_b64_tr_b16 v[170:171], v15 offset:14592
    ds_read_b64_tr_b16 v[172:173], v204 offset:14336
    ds_read_b64_tr_b16 v[174:175], v204 offset:14592
    s_waitcnt vmcnt(0) lgkmcnt(0)
    s_barrier
    ds_read_b64_tr_b16 v[48:49], v10 offset:0
    ds_read_b64_tr_b16 v[50:51], v10 offset:1024
    ds_read_b64_tr_b16 v[52:53], v10 offset:4096
    ds_read_b64_tr_b16 v[54:55], v10 offset:5120
    ds_read_b64_tr_b16 v[56:57], v10 offset:8192
    ds_read_b64_tr_b16 v[58:59], v10 offset:9216
    ds_read_b64_tr_b16 v[60:61], v10 offset:12288
    ds_read_b64_tr_b16 v[62:63], v10 offset:13312
    ds_read_b64_tr_b16 v[208:209], v10 offset:16384
    ds_read_b64_tr_b16 v[210:211], v10 offset:17408
    ds_read_b64_tr_b16 v[212:213], v10 offset:20480
    ds_read_b64_tr_b16 v[214:215], v10 offset:21504
    ds_read_b64_tr_b16 v[216:217], v10 offset:24576
    ds_read_b64_tr_b16 v[218:219], v10 offset:25600
    ds_read_b64_tr_b16 v[220:221], v10 offset:28672
    ds_read_b64_tr_b16 v[222:223], v10 offset:29696
    ds_read_b64_tr_b16 v[64:65], v10 offset:32768
    ds_read_b64_tr_b16 v[66:67], v10 offset:33792
    ds_read_b64_tr_b16 v[68:69], v10 offset:36864
    ds_read_b64_tr_b16 v[70:71], v10 offset:37888
    ds_read_b64_tr_b16 v[72:73], v10 offset:40960
    ds_read_b64_tr_b16 v[74:75], v10 offset:41984
    ds_read_b64_tr_b16 v[76:77], v10 offset:45056
    ds_read_b64_tr_b16 v[78:79], v10 offset:46080
    ds_read_b64_tr_b16 v[80:81], v10 offset:49152
    ds_read_b64_tr_b16 v[82:83], v10 offset:50176
    ds_read_b64_tr_b16 v[84:85], v10 offset:53248
    ds_read_b64_tr_b16 v[86:87], v10 offset:54272
    ds_read_b64_tr_b16 v[88:89], v10 offset:57344
    ds_read_b64_tr_b16 v[90:91], v10 offset:58368
    ds_read_b64_tr_b16 v[92:93], v10 offset:61440
    ds_read_b64_tr_b16 v[94:95], v10 offset:62464
    s_add_u32 m0, s98, 32768
    s_lshr_b32 s99, s47, 11
    s_add_u32 s99, s99, s97
    s_add_u32 s47, s47, s49
    buffer_load_dwordx4 v224, s[60:63], s99 offen offset:0 lds
    buffer_load_dwordx4 v225, s[60:63], s99 offen offset:1024 lds
    buffer_load_dwordx4 v226, s[60:63], s99 offen offset:2048 lds
    buffer_load_dwordx4 v227, s[60:63], s99 offen offset:3072 lds
    s_add_u32 m0, s98, 49152
    s_lshr_b32 s99, s47, 11
    s_add_u32 s99, s99, s97
    s_add_u32 s47, s47, s49
    buffer_load_dwordx4 v224, s[60:63], s99 offen offset:0 lds
    buffer_load_dwordx4 v225, s[60:63], s99 offen offset:1024 lds
    buffer_load_dwordx4 v226, s[60:63], s99 offen offset:2048 lds
    buffer_load_dwordx4 v227, s[60:63], s99 offen offset:3072 lds
    s_waitcnt vmcnt(0) lgkmcnt(0)
    s_barrier
    ds_read_b64_tr_b16 v[96:97], v8 offset:0
    ds_read_b64_tr_b16 v[98:99], v8 offset:1024
    ds_read_b64_tr_b16 v[100:101], v8 offset:4096
    ds_read_b64_tr_b16 v[102:103], v8 offset:5120
    ds_read_b64_tr_b16 v[104:105], v8 offset:8192
    ds_read_b64_tr_b16 v[106:107], v8 offset:9216
    ds_read_b64_tr_b16 v[108:109], v8 offset:12288
    ds_read_b64_tr_b16 v[110:111], v8 offset:13312
    ds_read_b64_tr_b16 v[176:177], v8 offset:16384
    ds_read_b64_tr_b16 v[178:179], v8 offset:17408
    ds_read_b64_tr_b16 v[180:181], v8 offset:20480
    ds_read_b64_tr_b16 v[182:183], v8 offset:21504
    ds_read_b64_tr_b16 v[192:193], v8 offset:24576
    ds_read_b64_tr_b16 v[194:195], v8 offset:25600
    ds_read_b64_tr_b16 v[196:197], v8 offset:28672
    ds_read_b64_tr_b16 v[198:199], v8 offset:29696
    s_add_u32 m0, s98, 98304
    s_lshr_b32 s99, s47, 11
    s_add_u32 s99, s99, s97
    s_add_u32 s47, s47, s49
    buffer_load_dwordx4 v224, s[60:63], s99 offen offset:0 lds
    buffer_load_dwordx4 v225, s[60:63], s99 offen offset:1024 lds
    buffer_load_dwordx4 v226, s[60:63], s99 offen offset:2048 lds
    buffer_load_dwordx4 v227, s[60:63], s99 offen offset:3072 lds
    s_add_u32 m0, s98, 114688
    s_lshr_b32 s99, s47, 11
    s_add_u32 s99, s99, s97
    s_add_u32 s47, s47, s49
    buffer_load_dwordx4 v224, s[60:63], s99 offen offset:0 lds
    buffer_load_dwordx4 v225, s[60:63], s99 offen offset:1024 lds
    buffer_load_dwordx4 v226, s[60:63], s99 offen offset:2048 lds
    buffer_load_dwordx4 v227, s[60:63], s99 offen offset:3072 lds
    s_add_u32 m0, s98, 131072
    s_lshr_b32 s99, s47, 11
    s_add_u32 s99, s99, s97
    s_add_u32 s47, s47, s49
    buffer_load_dwordx4 v224, s[60:63], s99 offen offset:0 lds
    buffer_load_dwordx4 v225, s[60:63], s99 offen offset:1024 lds
    buffer_load_dwordx4 v226, s[60:63], s99 offen offset:2048 lds
    buffer_load_dwordx4 v227, s[60:63], s99 offen offset:3072 lds
    s_add_u32 m0, s98, 147456
    s_lshr_b32 s99, s47, 11
    s_add_u32 s99, s99, s97
    s_add_u32 s47, s47, s49
    buffer_load_dwordx4 v224, s[60:63], s99 offen offset:0 lds
    buffer_load_dwordx4 v225, s[60:63], s99 offen offset:1024 lds
    buffer_load_dwordx4 v226, s[60:63], s99 offen offset:2048 lds
    buffer_load_dwordx4 v227, s[60:63], s99 offen offset:3072 lds
    s_waitcnt lgkmcnt(0)
    s_barrier
    s_add_u32 m0, s98, 32768
    s_lshr_b32 s99, s47, 11
    s_add_u32 s99, s99, s97
    s_add_u32 s47, s47, s49
    buffer_load_dwordx4 v224, s[60:63], s99 offen offset:0 lds
    buffer_load_dwordx4 v225, s[60:63], s99 offen offset:1024 lds
    buffer_load_dwordx4 v226, s[60:63], s99 offen offset:2048 lds
    buffer_load_dwordx4 v227, s[60:63], s99 offen offset:3072 lds
    s_add_u32 m0, s98, 49152
    s_lshr_b32 s99, s47, 11
    s_add_u32 s99, s99, s97
    s_add_u32 s47, s47, s49
    buffer_load_dwordx4 v224, s[60:63], s99 offen offset:0 lds
    buffer_load_dwordx4 v225, s[60:63], s99 offen offset:1024 lds
    buffer_load_dwordx4 v226, s[60:63], s99 offen offset:2048 lds
    buffer_load_dwordx4 v227, s[60:63], s99 offen offset:3072 lds
    s_setprio 1
    s_barrier
    ds_read_b128 v[16:19], v207 offset:0
    ds_read_b128 v[20:23], v1 offset:0
    ds_read_b128 v[24:27], v207 offset:2048
    ds_read_b128 v[28:31], v1 offset:2048
    ds_read_b128 v[32:35], v207 offset:4096
    ds_read_b128 v[36:39], v1 offset:4096
    ds_read_b128 v[40:43], v207 offset:6144
    ds_read_b128 v[44:47], v1 offset:6144
    s_cmp_eq_u32 s48, 1
    s_cbranch_scc1 .Lk3_vpath_8
    s_waitcnt lgkmcnt(7)
    v_mfma_f32_16x16x32_bf16 v[184:187], v[112:115], v[16:19], 0
    v_mfma_f32_16x16x32_bf16 v[188:191], v[116:119], v[16:19], 0
    s_waitcnt lgkmcnt(6)
    v_mfma_f32_16x16x32_bf16 v[184:187], v[120:123], v[20:23], v[184:187]
    v_mfma_f32_16x16x32_bf16 v[188:191], v[124:127], v[20:23], v[188:191]
    ds_read_b128 v[112:115], v4 offset:0
    ds_read_b128 v[116:119], v4 offset:4096
    s_waitcnt lgkmcnt(7)
    v_mfma_f32_16x16x32_bf16 v[184:187], v[128:131], v[24:27], v[184:187]
    v_mfma_f32_16x16x32_bf16 v[188:191], v[132:135], v[24:27], v[188:191]
    ds_read_b128 v[120:123], v4 offset:256
    ds_read_b128 v[124:127], v4 offset:4352
    s_waitcnt lgkmcnt(8)
    v_mfma_f32_16x16x32_bf16 v[184:187], v[136:139], v[28:31], v[184:187]
    v_mfma_f32_16x16x32_bf16 v[188:191], v[140:143], v[28:31], v[188:191]
    ds_read_b128 v[128:131], v4 offset:512
    ds_read_b128 v[132:135], v4 offset:4608
    s_waitcnt lgkmcnt(9)
    v_mfma_f32_16x16x32_bf16 v[184:187], v[144:147], v[32:35], v[184:187]
    v_mfma_f32_16x16x32_bf16 v[188:191], v[148:151], v[32:35], v[188:191]
    ds_read_b128 v[136:139], v4 offset:768
    ds_read_b128 v[140:143], v4 offset:4864
    s_waitcnt lgkmcnt(10)
    v_mfma_f32_16x16x32_bf16 v[184:187], v[152:155], v[36:39], v[184:187]
    v_mfma_f32_16x16x32_bf16 v[188:191], v[156:159], v[36:39], v[188:191]
    s_waitcnt lgkmcnt(9)
    v_mfma_f32_16x16x32_bf16 v[184:187], v[160:163], v[40:43], v[184:187]
    v_mfma_f32_16x16x32_bf16 v[188:191], v[164:167], v[40:43], v[188:191]
    s_waitcnt lgkmcnt(8)
    v_mfma_f32_16x16x32_bf16 v[184:187], v[168:171], v[44:47], v[184:187]
    v_mfma_f32_16x16x32_bf16 v[188:191], v[172:175], v[44:47], v[188:191]
    s_branch .Lk3_join_9
.Lk3_vpath_8:
    s_waitcnt lgkmcnt(7)
    v_mfma_f32_16x16x32_bf16 v[184:187], v[16:19], v[112:115], 0
    v_mfma_f32_16x16x32_bf16 v[188:191], v[16:19], v[116:119], 0
    s_waitcnt lgkmcnt(6)
    v_mfma_f32_16x16x32_bf16 v[184:187], v[20:23], v[120:123], v[184:187]
    v_mfma_f32_16x16x32_bf16 v[188:191], v[20:23], v[124:127], v[188:191]
    ds_read_b128 v[112:115], v4 offset:0
    ds_read_b128 v[116:119], v4 offset:4096
    s_waitcnt lgkmcnt(7)
    v_mfma_f32_16x16x32_bf16 v[184:187], v[24:27], v[128:131], v[184:187]
    v_mfma_f32_16x16x32_bf16 v[188:191], v[24:27], v[132:135], v[188:191]
    ds_read_b128 v[120:123], v4 offset:256
    ds_read_b128 v[124:127], v4 offset:4352
    s_waitcnt lgkmcnt(8)
    v_mfma_f32_16x16x32_bf16 v[184:187], v[28:31], v[136:139], v[184:187]
    v_mfma_f32_16x16x32_bf16 v[188:191], v[28:31], v[140:143], v[188:191]
    ds_read_b128 v[128:131], v4 offset:512
    ds_read_b128 v[132:135], v4 offset:4608
    s_waitcnt lgkmcnt(9)
    v_mfma_f32_16x16x32_bf16 v[184:187], v[32:35], v[144:147], v[184:187]
    v_mfma_f32_16x16x32_bf16 v[188:191], v[32:35], v[148:151], v[188:191]
    ds_read_b128 v[136:139], v4 offset:768
    ds_read_b128 v[140:143], v4 offset:4864
    s_waitcnt lgkmcnt(10)
    v_mfma_f32_16x16x32_bf16 v[184:187], v[36:39], v[152:155], v[184:187]
    v_mfma_f32_16x16x32_bf16 v[188:191], v[36:39], v[156:159], v[188:191]
    s_waitcnt lgkmcnt(9)
    v_mfma_f32_16x16x32_bf16 v[184:187], v[40:43], v[160:163], v[184:187]
    v_mfma_f32_16x16x32_bf16 v[188:191], v[40:43], v[164:167], v[188:191]
    s_waitcnt lgkmcnt(8)
    v_mfma_f32_16x16x32_bf16 v[184:187], v[44:47], v[168:171], v[184:187]
    v_mfma_f32_16x16x32_bf16 v[188:191], v[44:47], v[172:175], v[188:191]
.Lk3_join_9:
    s_waitcnt lgkmcnt(6)
    v_mfma_f32_32x32x16_bf16 v[16:31], v[48:51], v[112:115], 0
    ds_read_b128 v[144:147], v4 offset:8192
    v_mfma_f32_32x32x16_bf16 v[32:47], v[48:51], v[116:119], 0
    s_nop 2
    ds_write_b128 v205, v[184:187]
    ds_write_b128 v205, v[188:191] offset:1024
    s_lshl_b32 s3, s95, 10
    s_add_u32 s3, s3, 65536
    v_add_u32 v205, s3, v9
    ds_read_b128 v[148:151], v4 offset:12288
    s_waitcnt lgkmcnt(8)
    v_mfma_f32_32x32x16_bf16 v[16:31], v[52:55], v[120:123], v[16:31]
    ds_read_b128 v[152:155], v4 offset:8448
    v_mfma_f32_32x32x16_bf16 v[32:47], v[52:55], v[124:127], v[32:47]
    ds_read_b128 v[156:159], v4 offset:12544
    s_waitcnt lgkmcnt(8)
    v_mfma_f32_32x32x16_bf16 v[16:31], v[56:59], v[128:131], v[16:31]
    ds_read_b128 v[160:163], v4 offset:8704
    v_mfma_f32_32x32x16_bf16 v[32:47], v[56:59], v[132:135], v[32:47]
    ds_read_b128 v[164:167], v4 offset:12800
    s_waitcnt lgkmcnt(8)
    v_mfma_f32_32x32x16_bf16 v[16:31], v[60:63], v[136:139], v[16:31]
    ds_read_b128 v[168:171], v4 offset:8960
    v_mfma_f32_32x32x16_bf16 v[32:47], v[60:63], v[140:143], v[32:47]
    ds_read_b128 v[172:175], v4 offset:13056
    s_waitcnt lgkmcnt(6)
    s_barrier
    ds_read_b128 v[224:227], v205 offset:0
    ds_read_b128 v[228:231], v205 offset:8192
    ds_read_b128 v[232:235], v205 offset:16384
    ds_read_b128 v[236:239], v205 offset:24576
    v_mfma_f32_32x32x16_bf16 v[16:31], v[208:211], v[144:147], v[16:31]
    ds_read_b128 v[112:115], v4 offset:16384
    v_mfma_f32_32x32x16_bf16 v[32:47], v[208:211], v[148:151], v[32:47]
    ds_read_b128 v[116:119], v4 offset:20480
    s_waitcnt lgkmcnt(10)
    v_mfma_f32_32x32x16_bf16 v[16:31], v[212:215], v[152:155], v[16:31]
    ds_read_b128 v[120:123], v4 offset:16640
    v_mfma_f32_32x32x16_bf16 v[32:47], v[212:215], v[156:159], v[32:47]
    ds_read_b128 v[124:127], v4 offset:20736
    s_waitcnt lgkmcnt(4)
    v_add_f32 v224, v224, v228
    v_add_f32 v225, v225, v229
    v_add_f32 v226, v226, v230
    v_add_f32 v227, v227, v231
    v_add_f32 v232, v232, v236
    v_mfma_f32_32x32x16_bf16 v[16:31], v[216:219], v[160:163], v[16:31]
    ds_read_b128 v[128:131], v4 offset:16896
    v_add_f32 v233, v233, v237
    v_add_f32 v234, v234, v238
    v_add_f32 v235, v235, v239
    v_add_f32 v224, v224, v232
    v_add_f32 v225, v225, v233
    v_mfma_f32_32x32x16_bf16 v[32:47], v[216:219], v[164:167], v[32:47]
    ds_read_b128 v[132:135], v4 offset:20992
    v_add_f32 v226, v226, v234
    v_add_f32 v227, v227, v235
    v_mul_f32 v224, s56, v224
    v_mul_f32 v225, s56, v225
    v_mul_f32 v226, s56, v226
    v_mfma_f32_32x32x16_bf16 v[16:31], v[220:223], v[168:171], v[16:31]
    ds_read_b128 v[136:139], v4 offset:17152
    v_mul_f32 v227, s56, v227
    v_cvt_pk_bf16_f32 v224, v224, v225
    v_cvt_pk_bf16_f32 v225, v226, v227
    buffer_store_dwordx2 v[224:225], v206, s[28:31], s45 offen sc1
    v_mfma_f32_32x32x16_bf16 v[32:47], v[220:223], v[172:175], v[32:47]
    ds_read_b128 v[140:143], v4 offset:21248
    s_waitcnt lgkmcnt(6)
    s_barrier
    v_mfma_f32_32x32x16_bf16 v[16:31], v[64:67], v[112:115], v[16:31]
    ds_read_b128 v[144:147], v4 offset:24576
    v_mfma_f32_32x32x16_bf16 v[32:47], v[64:67], v[116:119], v[32:47]
    ds_read_b128 v[148:151], v4 offset:28672
    s_waitcnt lgkmcnt(6)
    v_mfma_f32_32x32x16_bf16 v[16:31], v[68:71], v[120:123], v[16:31]
    ds_read_b128 v[152:155], v4 offset:24832
    v_mfma_f32_32x32x16_bf16 v[32:47], v[68:71], v[124:127], v[32:47]
    ds_read_b128 v[156:159], v4 offset:28928
    s_waitcnt lgkmcnt(6)
    v_mfma_f32_32x32x16_bf16 v[16:31], v[72:75], v[128:131], v[16:31]
    ds_read_b128 v[160:163], v4 offset:25088
    v_mfma_f32_32x32x16_bf16 v[32:47], v[72:75], v[132:135], v[32:47]
    ds_read_b128 v[164:167], v4 offset:29184
    s_waitcnt lgkmcnt(6)
    v_mfma_f32_32x32x16_bf16 v[16:31], v[76:79], v[136:139], v[16:31]
    ds_read_b128 v[168:171], v4 offset:25344
    v_mfma_f32_32x32x16_bf16 v[32:47], v[76:79], v[140:143], v[32:47]
    ds_read_b128 v[172:175], v4 offset:29440
    s_waitcnt lgkmcnt(6)
    s_barrier
    v_mfma_f32_32x32x16_bf16 v[16:31], v[80:83], v[144:147], v[16:31]
    ds_read_b128 v[112:115], v4 offset:0
    v_mov_b32 v184, 0
    v_mfma_f32_32x32x16_bf16 v[32:47], v[80:83], v[148:151], v[32:47]
    ds_read_b128 v[116:119], v4 offset:4096
    v_mov_b32 v185, 0
    s_waitcnt lgkmcnt(6)
    v_mfma_f32_32x32x16_bf16 v[16:31], v[84:87], v[152:155], v[16:31]
    ds_read_b128 v[120:123], v4 offset:256
    v_mov_b32 v186, 0
    v_mfma_f32_32x32x16_bf16 v[32:47], v[84:87], v[156:159], v[32:47]
    ds_read_b128 v[124:127], v4 offset:4352
    v_mov_b32 v187, 0
    s_waitcnt lgkmcnt(6)
    v_mfma_f32_32x32x16_bf16 v[16:31], v[88:91], v[160:163], v[16:31]
    ds_read_b128 v[128:131], v4 offset:512
    v_mov_b32 v188, 0
    v_mfma_f32_32x32x16_bf16 v[32:47], v[88:91], v[164:167], v[32:47]
    ds_read_b128 v[132:135], v4 offset:4608
    v_mov_b32 v189, 0
    s_waitcnt lgkmcnt(6)
    v_mfma_f32_32x32x16_bf16 v[16:31], v[92:95], v[168:171], v[16:31]
    ds_read_b128 v[136:139], v4 offset:768
    v_mov_b32 v190, 0
    v_mfma_f32_32x32x16_bf16 v[32:47], v[92:95], v[172:175], v[32:47]
    ds_read_b128 v[140:143], v4 offset:4864
    v_mov_b32 v191, 0
    s_waitcnt lgkmcnt(6)
    s_waitcnt vmcnt(0)
    s_barrier
    v_mfma_f32_32x32x16_bf16 v[16:31], v[96:99], v[112:115], v[16:31]
    ds_read_b128 v[144:147], v4 offset:8192
    v_mov_b32 v64, 0
    v_mfma_f32_32x32x16_bf16 v[32:47], v[96:99], v[116:119], v[32:47]
    ds_read_b128 v[148:151], v4 offset:12288
    v_mov_b32 v65, 0
    s_waitcnt lgkmcnt(6)
    v_mfma_f32_32x32x16_bf16 v[16:31], v[100:103], v[120:123], v[16:31]
    ds_read_b128 v[152:155], v4 offset:8448
    v_mov_b32 v66, 0
    v_mfma_f32_32x32x16_bf16 v[32:47], v[100:103], v[124:127], v[32:47]
    ds_read_b128 v[156:159], v4 offset:12544
    v_mov_b32 v67, 0
    s_waitcnt lgkmcnt(6)
    v_mfma_f32_32x32x16_bf16 v[16:31], v[104:107], v[128:131], v[16:31]
    ds_read_b128 v[160:163], v4 offset:8704
    v_mov_b32 v68, 0
    v_mfma_f32_32x32x16_bf16 v[32:47], v[104:107], v[132:135], v[32:47]
    ds_read_b128 v[164:167], v4 offset:12800
    v_mov_b32 v69, 0
    s_waitcnt lgkmcnt(6)
    v_mfma_f32_32x32x16_bf16 v[16:31], v[108:111], v[136:139], v[16:31]
    ds_read_b128 v[168:171], v4 offset:8960
    v_mov_b32 v70, 0
    v_mfma_f32_32x32x16_bf16 v[32:47], v[108:111], v[140:143], v[32:47]
    ds_read_b128 v[172:175], v4 offset:13056
    v_mov_b32 v71, 0
    s_cmp_lg_u32 s95, 0
    s_cbranch_scc1 .Lk3_nf_10
    s_lshl_b32 s3, s2, 4
    s_add_u32 s3, s3, 32768
    s_mov_b64 exec, 1
    buffer_store_dword v14, v9, s[32:35], s3 offen sc1
    s_mov_b64 exec, -1
.Lk3_nf_10:
    s_waitcnt lgkmcnt(6)
    s_barrier
    v_mfma_f32_32x32x16_bf16 v[16:31], v[176:179], v[144:147], v[16:31]
    ds_read_b64_tr_b16 v[48:49], v10 offset:0
    ds_read_b64_tr_b16 v[50:51], v10 offset:1024
    v_mov_b32 v72, 0
    v_mfma_f32_32x32x16_bf16 v[32:47], v[176:179], v[148:151], v[32:47]
    ds_read_b128 v[112:115], v4 offset:16384
    ds_read_b128 v[116:119], v4 offset:20480
    v_mov_b32 v73, 0
    s_waitcnt lgkmcnt(8)
    v_mfma_f32_32x32x16_bf16 v[16:31], v[180:183], v[152:155], v[16:31]
    ds_read_b64_tr_b16 v[52:53], v10 offset:4096
    ds_read_b64_tr_b16 v[54:55], v10 offset:5120
    v_mov_b32 v74, 0
    v_mfma_f32_32x32x16_bf16 v[32:47], v[180:183], v[156:159], v[32:47]
    ds_read_b128 v[120:123], v4 offset:16640
    ds_read_b128 v[124:127], v4 offset:20736
    v_mov_b32 v75, 0
    s_waitcnt lgkmcnt(10)
    v_mfma_f32_32x32x16_bf16 v[16:31], v[192:195], v[160:163], v[16:31]
    ds_read_b64_tr_b16 v[56:57], v10 offset:8192
    ds_read_b64_tr_b16 v[58:59], v10 offset:9216
    v_mov_b32 v76, 0
    v_mfma_f32_32x32x16_bf16 v[32:47], v[192:195], v[164:167], v[32:47]
    ds_read_b128 v[128:131], v4 offset:16896
    ds_read_b128 v[132:135], v4 offset:20992
    v_mov_b32 v77, 0
    s_waitcnt lgkmcnt(12)
    v_mfma_f32_32x32x16_bf16 v[16:31], v[196:199], v[168:171], v[16:31]
    ds_read_b64_tr_b16 v[60:61], v10 offset:12288
    ds_read_b64_tr_b16 v[62:63], v10 offset:13312
    v_mov_b32 v78, 0
    v_mfma_f32_32x32x16_bf16 v[32:47], v[196:199], v[172:175], v[32:47]
    ds_read_b128 v[136:139], v4 offset:17152
    ds_read_b128 v[140:143], v4 offset:21248
    v_mov_b32 v79, 0
    s_waitcnt lgkmcnt(12)
    s_barrier
    v_mfma_f32_32x32x16_bf16 v[16:31], v[48:51], v[112:115], v[16:31]
    ds_read_b64_tr_b16 v[208:209], v10 offset:16384
    ds_read_b64_tr_b16 v[210:211], v10 offset:17408
    v_mov_b32 v80, 0
    v_mfma_f32_32x32x16_bf16 v[32:47], v[48:51], v[116:119], v[32:47]
    ds_read_b128 v[144:147], v4 offset:24576
    ds_read_b128 v[148:151], v4 offset:28672
    v_mov_b32 v81, 0
    s_waitcnt lgkmcnt(12)
    v_mfma_f32_32x32x16_bf16 v[16:31], v[52:55], v[120:123], v[16:31]
    ds_read_b64_tr_b16 v[212:213], v10 offset:20480
    ds_read_b64_tr_b16 v[214:215], v10 offset:21504
    v_mov_b32 v82, 0
    v_mfma_f32_32x32x16_bf16 v[32:47], v[52:55], v[124:127], v[32:47]
    ds_read_b128 v[152:155], v4 offset:24832
    ds_read_b128 v[156:159], v4 offset:28928
    v_mov_b32 v83, 0
    s_waitcnt lgkmcnt(12)
    v_mfma_f32_32x32x16_bf16 v[16:31], v[56:59], v[128:131], v[16:31]
    ds_read_b64_tr_b16 v[216:217], v10 offset:24576
    ds_read_b64_tr_b16 v[218:219], v10 offset:25600
    v_mov_b32 v84, 0
    v_mfma_f32_32x32x16_bf16 v[32:47], v[56:59], v[132:135], v[32:47]
    ds_read_b128 v[160:163], v4 offset:25088
    ds_read_b128 v[164:167], v4 offset:29184
    v_mov_b32 v85, 0
    s_waitcnt lgkmcnt(12)
    v_mfma_f32_32x32x16_bf16 v[16:31], v[60:63], v[136:139], v[16:31]
    ds_read_b64_tr_b16 v[220:221], v10 offset:28672
    ds_read_b64_tr_b16 v[222:223], v10 offset:29696
    v_mov_b32 v86, 0
    v_mfma_f32_32x32x16_bf16 v[32:47], v[60:63], v[140:143], v[32:47]
    ds_read_b128 v[168:171], v4 offset:25344
    ds_read_b128 v[172:175], v4 offset:29440
    v_mov_b32 v87, 0
    s_waitcnt lgkmcnt(12)
    s_barrier
    v_mfma_f32_32x32x16_bf16 v[16:31], v[208:211], v[144:147], v[16:31]
    ds_read_b64_tr_b16 v[48:49], v10 offset:32768
    ds_read_b64_tr_b16 v[50:51], v10 offset:33792
    v_mov_b32 v88, 0
    v_mfma_f32_32x32x16_bf16 v[32:47], v[208:211], v[148:151], v[32:47]
    ds_read_b128 v[112:115], v4 offset:0
    ds_read_b128 v[116:119], v4 offset:4096
    v_mov_b32 v89, 0
    s_waitcnt lgkmcnt(12)
    v_mfma_f32_32x32x16_bf16 v[16:31], v[212:215], v[152:155], v[16:31]
    ds_read_b64_tr_b16 v[52:53], v10 offset:36864
    ds_read_b64_tr_b16 v[54:55], v10 offset:37888
    v_mov_b32 v90, 0
    v_mfma_f32_32x32x16_bf16 v[32:47], v[212:215], v[156:159], v[32:47]
    ds_read_b128 v[120:123], v4 offset:256
    ds_read_b128 v[124:127], v4 offset:4352
    v_mov_b32 v91, 0
    s_waitcnt lgkmcnt(12)
    v_mfma_f32_32x32x16_bf16 v[16:31], v[216:219], v[160:163], v[16:31]
    ds_read_b64_tr_b16 v[56:57], v10 offset:40960
    ds_read_b64_tr_b16 v[58:59], v10 offset:41984
    v_mov_b32 v92, 0
    v_mfma_f32_32x32x16_bf16 v[32:47], v[216:219], v[164:167], v[32:47]
    ds_read_b128 v[128:131], v4 offset:512
    ds_read_b128 v[132:135], v4 offset:4608
    v_mov_b32 v93, 0
    s_waitcnt lgkmcnt(12)
    v_mfma_f32_32x32x16_bf16 v[16:31], v[220:223], v[168:171], v[16:31]
    ds_read_b64_tr_b16 v[60:61], v10 offset:45056
    ds_read_b64_tr_b16 v[62:63], v10 offset:46080
    v_mov_b32 v94, 0
    v_mfma_f32_32x32x16_bf16 v[32:47], v[220:223], v[172:175], v[32:47]
    ds_read_b128 v[136:139], v4 offset:768
    ds_read_b128 v[140:143], v4 offset:4864
    v_mov_b32 v95, 0
    s_waitcnt lgkmcnt(12)
    s_barrier
    v_mfma_f32_32x32x16_bf16 v[16:31], v[48:51], v[112:115], v[16:31]
    ds_read_b64_tr_b16 v[208:209], v10 offset:49152
    ds_read_b64_tr_b16 v[210:211], v10 offset:50176
    v_mov_b32 v96, 0
    v_mfma_f32_32x32x16_bf16 v[32:47], v[48:51], v[116:119], v[32:47]
    ds_read_b128 v[144:147], v4 offset:8192
    ds_read_b128 v[148:151], v4 offset:12288
    v_mov_b32 v97, 0
    s_waitcnt lgkmcnt(12)
    v_mfma_f32_32x32x16_bf16 v[16:31], v[52:55], v[120:123], v[16:31]
    ds_read_b64_tr_b16 v[212:213], v10 offset:53248
    ds_read_b64_tr_b16 v[214:215], v10 offset:54272
    v_mov_b32 v98, 0
    v_mfma_f32_32x32x16_bf16 v[32:47], v[52:55], v[124:127], v[32:47]
    ds_read_b128 v[152:155], v4 offset:8448
    ds_read_b128 v[156:159], v4 offset:12544
    v_mov_b32 v99, 0
    s_waitcnt lgkmcnt(12)
    v_mfma_f32_32x32x16_bf16 v[16:31], v[56:59], v[128:131], v[16:31]
    ds_read_b64_tr_b16 v[216:217], v10 offset:57344
    ds_read_b64_tr_b16 v[218:219], v10 offset:58368
    v_mov_b32 v100, 0
    v_mfma_f32_32x32x16_bf16 v[32:47], v[56:59], v[132:135], v[32:47]
    ds_read_b128 v[160:163], v4 offset:8704
    ds_read_b128 v[164:167], v4 offset:12800
    v_mov_b32 v101, 0
    s_waitcnt lgkmcnt(12)
    v_mfma_f32_32x32x16_bf16 v[16:31], v[60:63], v[136:139], v[16:31]
    ds_read_b64_tr_b16 v[220:221], v10 offset:61440
    ds_read_b64_tr_b16 v[222:223], v10 offset:62464
    v_mov_b32 v102, 0
    v_mfma_f32_32x32x16_bf16 v[32:47], v[60:63], v[140:143], v[32:47]
    ds_read_b128 v[168:171], v4 offset:8960
    ds_read_b128 v[172:175], v4 offset:13056
    v_mov_b32 v103, 0
    s_waitcnt lgkmcnt(12)
    s_barrier
    v_mfma_f32_32x32x16_bf16 v[16:31], v[208:211], v[144:147], v[16:31]
    ds_read_b64_tr_b16 v[48:49], v8 offset:0
    ds_read_b64_tr_b16 v[50:51], v8 offset:1024
    v_mov_b32 v104, 0
    v_mfma_f32_32x32x16_bf16 v[32:47], v[208:211], v[148:151], v[32:47]
    ds_read_b128 v[112:115], v4 offset:16384
    ds_read_b128 v[116:119], v4 offset:20480
    v_mov_b32 v105, 0
    s_waitcnt lgkmcnt(12)
    v_mfma_f32_32x32x16_bf16 v[16:31], v[212:215], v[152:155], v[16:31]
    ds_read_b64_tr_b16 v[52:53], v8 offset:4096
    ds_read_b64_tr_b16 v[54:55], v8 offset:5120
    v_mov_b32 v106, 0
    v_mfma_f32_32x32x16_bf16 v[32:47], v[212:215], v[156:159], v[32:47]
    ds_read_b128 v[120:123], v4 offset:16640
    ds_read_b128 v[124:127], v4 offset:20736
    v_mov_b32 v107, 0
    s_waitcnt lgkmcnt(12)
    v_mfma_f32_32x32x16_bf16 v[16:31], v[216:219], v[160:163], v[16:31]
    ds_read_b64_tr_b16 v[56:57], v8 offset:8192
    ds_read_b64_tr_b16 v[58:59], v8 offset:9216
    v_mov_b32 v108, 0
    v_mfma_f32_32x32x16_bf16 v[32:47], v[216:219], v[164:167], v[32:47]
    ds_read_b128 v[128:131], v4 offset:16896
    ds_read_b128 v[132:135], v4 offset:20992
    v_mov_b32 v109, 0
    s_waitcnt lgkmcnt(12)
    v_mfma_f32_32x32x16_bf16 v[16:31], v[220:223], v[168:171], v[16:31]
    ds_read_b64_tr_b16 v[60:61], v8 offset:12288
    ds_read_b64_tr_b16 v[62:63], v8 offset:13312
    v_mov_b32 v110, 0
    v_mfma_f32_32x32x16_bf16 v[32:47], v[220:223], v[172:175], v[32:47]
    ds_read_b128 v[136:139], v4 offset:17152
    ds_read_b128 v[140:143], v4 offset:21248
    v_mov_b32 v111, 0
    s_waitcnt lgkmcnt(12)
    s_barrier
    v_mfma_f32_32x32x16_bf16 v[16:31], v[48:51], v[112:115], v[16:31]
    ds_read_b64_tr_b16 v[208:209], v8 offset:16384
    ds_read_b64_tr_b16 v[210:211], v8 offset:17408
    v_mov_b32 v192, 0
    v_mfma_f32_32x32x16_bf16 v[32:47], v[48:51], v[116:119], v[32:47]
    ds_read_b128 v[144:147], v4 offset:24576
    ds_read_b128 v[148:151], v4 offset:28672
    v_mov_b32 v193, 0
    s_waitcnt lgkmcnt(12)
    v_mfma_f32_32x32x16_bf16 v[16:31], v[52:55], v[120:123], v[16:31]
    ds_read_b64_tr_b16 v[212:213], v8 offset:20480
    ds_read_b64_tr_b16 v[214:215], v8 offset:21504
    v_mov_b32 v194, 0
    v_mfma_f32_32x32x16_bf16 v[32:47], v[52:55], v[124:127], v[32:47]
    ds_read_b128 v[152:155], v4 offset:24832
    ds_read_b128 v[156:159], v4 offset:28928
    v_mov_b32 v195, 0
    s_waitcnt lgkmcnt(12)
    v_mfma_f32_32x32x16_bf16 v[16:31], v[56:59], v[128:131], v[16:31]
    ds_read_b64_tr_b16 v[216:217], v8 offset:24576
    ds_read_b64_tr_b16 v[218:219], v8 offset:25600
    v_mov_b32 v196, 0
    v_mfma_f32_32x32x16_bf16 v[32:47], v[56:59], v[132:135], v[32:47]
    ds_read_b128 v[160:163], v4 offset:25088
    ds_read_b128 v[164:167], v4 offset:29184
    v_mov_b32 v197, 0
    s_waitcnt lgkmcnt(12)
    v_mfma_f32_32x32x16_bf16 v[16:31], v[60:63], v[136:139], v[16:31]
    ds_read_b64_tr_b16 v[220:221], v8 offset:28672
    ds_read_b64_tr_b16 v[222:223], v8 offset:29696
    v_mov_b32 v198, 0
    v_mfma_f32_32x32x16_bf16 v[32:47], v[60:63], v[140:143], v[32:47]
    ds_read_b128 v[168:171], v4 offset:25344
    ds_read_b128 v[172:175], v4 offset:29440
    v_mov_b32 v199, 0
    s_waitcnt lgkmcnt(12)
    s_barrier
    v_mfma_f32_32x32x16_bf16 v[16:31], v[208:211], v[144:147], v[16:31]
    ds_read_b64_tr_b16 v[48:49], v8 offset:32768
    ds_read_b64_tr_b16 v[50:51], v8 offset:33792
    v_mfma_f32_32x32x16_bf16 v[32:47], v[208:211], v[148:151], v[32:47]
    ds_read_b128 v[112:115], v4 offset:0
    ds_read_b128 v[116:119], v4 offset:4096
    s_waitcnt lgkmcnt(12)
    v_mfma_f32_32x32x16_bf16 v[16:31], v[212:215], v[152:155], v[16:31]
    ds_read_b64_tr_b16 v[52:53], v8 offset:36864
    ds_read_b64_tr_b16 v[54:55], v8 offset:37888
    v_mfma_f32_32x32x16_bf16 v[32:47], v[212:215], v[156:159], v[32:47]
    ds_read_b128 v[120:123], v4 offset:256
    ds_read_b128 v[124:127], v4 offset:4352
    s_waitcnt lgkmcnt(12)
    v_mfma_f32_32x32x16_bf16 v[16:31], v[216:219], v[160:163], v[16:31]
    ds_read_b64_tr_b16 v[56:57], v8 offset:40960
    ds_read_b64_tr_b16 v[58:59], v8 offset:41984
    v_mfma_f32_32x32x16_bf16 v[32:47], v[216:219], v[164:167], v[32:47]
    ds_read_b128 v[128:131], v4 offset:512
    ds_read_b128 v[132:135], v4 offset:4608
    s_waitcnt lgkmcnt(12)
    v_mfma_f32_32x32x16_bf16 v[16:31], v[220:223], v[168:171], v[16:31]
    ds_read_b64_tr_b16 v[60:61], v8 offset:45056
    ds_read_b64_tr_b16 v[62:63], v8 offset:46080
    v_mfma_f32_32x32x16_bf16 v[32:47], v[220:223], v[172:175], v[32:47]
    ds_read_b128 v[136:139], v4 offset:768
    ds_read_b128 v[140:143], v4 offset:4864
    s_waitcnt lgkmcnt(12)
    s_barrier
    v_mfma_f32_32x32x16_bf16 v[16:31], v[48:51], v[112:115], v[16:31]
    ds_read_b64_tr_b16 v[208:209], v8 offset:49152
    ds_read_b64_tr_b16 v[210:211], v8 offset:50176
    v_mfma_f32_32x32x16_bf16 v[32:47], v[48:51], v[116:119], v[32:47]
    ds_read_b128 v[144:147], v4 offset:8192
    ds_read_b128 v[148:151], v4 offset:12288
    s_waitcnt lgkmcnt(12)
    v_mfma_f32_32x32x16_bf16 v[16:31], v[52:55], v[120:123], v[16:31]
    ds_read_b64_tr_b16 v[212:213], v8 offset:53248
    ds_read_b64_tr_b16 v[214:215], v8 offset:54272
    v_mfma_f32_32x32x16_bf16 v[32:47], v[52:55], v[124:127], v[32:47]
    ds_read_b128 v[152:155], v4 offset:8448
    ds_read_b128 v[156:159], v4 offset:12544
    s_waitcnt lgkmcnt(12)
    v_mfma_f32_32x32x16_bf16 v[16:31], v[56:59], v[128:131], v[16:31]
    ds_read_b64_tr_b16 v[216:217], v8 offset:57344
    ds_read_b64_tr_b16 v[218:219], v8 offset:58368
    v_mfma_f32_32x32x16_bf16 v[32:47], v[56:59], v[132:135], v[32:47]
    ds_read_b128 v[160:163], v4 offset:8704
    ds_read_b128 v[164:167], v4 offset:12800
    s_waitcnt lgkmcnt(12)
    v_mfma_f32_32x32x16_bf16 v[16:31], v[60:63], v[136:139], v[16:31]
    ds_read_b64_tr_b16 v[220:221], v8 offset:61440
    ds_read_b64_tr_b16 v[222:223], v8 offset:62464
    v_mfma_f32_32x32x16_bf16 v[32:47], v[60:63], v[140:143], v[32:47]
    ds_read_b128 v[168:171], v4 offset:8960
    ds_read_b128 v[172:175], v4 offset:13056
    s_waitcnt lgkmcnt(12)
    s_barrier
    v_mfma_f32_32x32x16_bf16 v[16:31], v[208:211], v[144:147], v[16:31]
    ds_read_b64_tr_b16 v[48:49], v10 offset:0
    ds_read_b64_tr_b16 v[50:51], v10 offset:1024
    v_mfma_f32_32x32x16_bf16 v[32:47], v[208:211], v[148:151], v[32:47]
    ds_read_b128 v[112:115], v4 offset:16384
    ds_read_b128 v[116:119], v4 offset:20480
    s_waitcnt lgkmcnt(12)
    v_mfma_f32_32x32x16_bf16 v[16:31], v[212:215], v[152:155], v[16:31]
    ds_read_b64_tr_b16 v[52:53], v10 offset:4096
    ds_read_b64_tr_b16 v[54:55], v10 offset:5120
    v_mfma_f32_32x32x16_bf16 v[32:47], v[212:215], v[156:159], v[32:47]
    ds_read_b128 v[120:123], v4 offset:16640
    ds_read_b128 v[124:127], v4 offset:20736
    s_waitcnt lgkmcnt(12)
    v_mfma_f32_32x32x16_bf16 v[16:31], v[216:219], v[160:163], v[16:31]
    ds_read_b64_tr_b16 v[56:57], v10 offset:8192
    ds_read_b64_tr_b16 v[58:59], v10 offset:9216
    v_mfma_f32_32x32x16_bf16 v[32:47], v[216:219], v[164:167], v[32:47]
    ds_read_b128 v[128:131], v4 offset:16896
    ds_read_b128 v[132:135], v4 offset:20992
    s_waitcnt lgkmcnt(12)
    v_mfma_f32_32x32x16_bf16 v[16:31], v[220:223], v[168:171], v[16:31]
    ds_read_b64_tr_b16 v[60:61], v10 offset:12288
    ds_read_b64_tr_b16 v[62:63], v10 offset:13312
    v_mfma_f32_32x32x16_bf16 v[32:47], v[220:223], v[172:175], v[32:47]
    ds_read_b128 v[136:139], v4 offset:17152
    ds_read_b128 v[140:143], v4 offset:21248
    s_waitcnt lgkmcnt(12)
    s_barrier
    v_mfma_f32_32x32x16_bf16 v[16:31], v[48:51], v[112:115], v[16:31]
    ds_read_b64_tr_b16 v[208:209], v10 offset:16384
    ds_read_b64_tr_b16 v[210:211], v10 offset:17408
    v_mfma_f32_32x32x16_bf16 v[32:47], v[48:51], v[116:119], v[32:47]
    ds_read_b128 v[144:147], v4 offset:24576
    ds_read_b128 v[148:151], v4 offset:28672
    s_waitcnt lgkmcnt(12)
    v_mfma_f32_32x32x16_bf16 v[16:31], v[52:55], v[120:123], v[16:31]
    ds_read_b64_tr_b16 v[212:213], v10 offset:20480
    ds_read_b64_tr_b16 v[214:215], v10 offset:21504
    v_mfma_f32_32x32x16_bf16 v[32:47], v[52:55], v[124:127], v[32:47]
    ds_read_b128 v[152:155], v4 offset:24832
    ds_read_b128 v[156:159], v4 offset:28928
    s_waitcnt lgkmcnt(12)
    v_mfma_f32_32x32x16_bf16 v[16:31], v[56:59], v[128:131], v[16:31]
    ds_read_b64_tr_b16 v[216:217], v10 offset:24576
    ds_read_b64_tr_b16 v[218:219], v10 offset:25600
    v_mfma_f32_32x32x16_bf16 v[32:47], v[56:59], v[132:135], v[32:47]
    ds_read_b128 v[160:163], v4 offset:25088
    ds_read_b128 v[164:167], v4 offset:29184
    s_waitcnt lgkmcnt(12)
    v_mfma_f32_32x32x16_bf16 v[16:31], v[60:63], v[136:139], v[16:31]
    ds_read_b64_tr_b16 v[220:221], v10 offset:28672
    ds_read_b64_tr_b16 v[222:223], v10 offset:29696
    v_mfma_f32_32x32x16_bf16 v[32:47], v[60:63], v[140:143], v[32:47]
    ds_read_b128 v[168:171], v4 offset:25344
    ds_read_b128 v[172:175], v4 offset:29440
    s_waitcnt lgkmcnt(12)
    v_mfma_f32_32x32x16_bf16 v[16:31], v[208:211], v[144:147], v[16:31]
    v_add_u32 v8, 98304, v9
    v_add_u32 v10, 32768, v8
    v_add_u32 v11, 49152, v8
    s_mov_b32 s40, 49152
    v_mfma_f32_32x32x16_bf16 v[32:47], v[208:211], v[148:151], v[32:47]
    s_waitcnt lgkmcnt(8)
    v_mfma_f32_32x32x16_bf16 v[16:31], v[212:215], v[152:155], v[16:31]
    v_mfma_f32_32x32x16_bf16 v[32:47], v[212:215], v[156:159], v[32:47]
    s_waitcnt lgkmcnt(4)
    v_mfma_f32_32x32x16_bf16 v[16:31], v[216:219], v[160:163], v[16:31]
    v_mfma_f32_32x32x16_bf16 v[32:47], v[216:219], v[164:167], v[32:47]
    s_waitcnt lgkmcnt(0)
    v_mfma_f32_32x32x16_bf16 v[16:31], v[220:223], v[168:171], v[16:31]
    v_mfma_f32_32x32x16_bf16 v[32:47], v[220:223], v[172:175], v[32:47]
    s_nop 10
    v_cvt_pk_bf16_f32 v144, v16, v17
    v_cvt_pk_bf16_f32 v145, v18, v19
    v_cvt_pk_bf16_f32 v146, v20, v21
    v_cvt_pk_bf16_f32 v147, v22, v23
    v_cvt_pk_bf16_f32 v148, v24, v25
    v_cvt_pk_bf16_f32 v149, v26, v27
    v_cvt_pk_bf16_f32 v150, v28, v29
    v_cvt_pk_bf16_f32 v151, v30, v31
    v_cvt_pk_bf16_f32 v152, v32, v33
    v_cvt_pk_bf16_f32 v153, v34, v35
    v_cvt_pk_bf16_f32 v154, v36, v37
    v_cvt_pk_bf16_f32 v155, v38, v39
    v_cvt_pk_bf16_f32 v156, v40, v41
    v_cvt_pk_bf16_f32 v157, v42, v43
    v_cvt_pk_bf16_f32 v158, v44, v45
    v_cvt_pk_bf16_f32 v159, v46, v47
    s_barrier
    ds_read_b128 v[160:163], v10
    ds_read_b128 v[164:167], v10 offset:1024
    s_waitcnt lgkmcnt(0)
    v_mfma_f32_32x32x16_bf16 v[32:47], v[160:163], v[144:147], 0
    v_mfma_f32_32x32x16_bf16 v[32:47], v[164:167], v[148:151], v[32:47]
    v_mfma_f32_32x32x16_bf16 v[48:63], v[160:163], v[152:155], 0
    v_mfma_f32_32x32x16_bf16 v[48:63], v[164:167], v[156:159], v[48:63]
    s_nop 9
    v_max3_f32 v3, v32, v33, v34
    v_max_f32 v3, v3, v47
    v_max3_f32 v3, v3, v35, v36
    v_max3_f32 v3, v3, v37, v38
    v_max3_f32 v3, v3, v39, v40
    v_max3_f32 v3, v3, v41, v42
    v_max3_f32 v3, v3, v43, v44
    v_max3_f32 v3, v3, v45, v46
    v_max3_f32 v4, v48, v49, v50
    v_max_f32 v4, v4, v63
    v_max3_f32 v4, v4, v51, v52
    v_max3_f32 v4, v4, v53, v54
    v_max3_f32 v4, v4, v55, v56
    v_max3_f32 v4, v4, v57, v58
    v_max3_f32 v4, v4, v59, v60
    v_max3_f32 v4, v4, v61, v62
    v_mov_b32 v5, v3
    s_nop 1
    v_permlane32_swap_b32 v5, v3
    v_max_f32 v5, v5, v3
    v_sub_f32 v112, 0xc2700000, v5
    v_mov_b32 v113, v112
    v_mov_b32 v114, v112
    v_mov_b32 v115, v112
    v_mov_b32 v116, v112
    v_mov_b32 v117, v112
    v_mov_b32 v118, v112
    v_mov_b32 v119, v112
    v_mov_b32 v120, v112
    v_mov_b32 v121, v112
    v_mov_b32 v122, v112
    v_mov_b32 v123, v112
    v_mov_b32 v124, v112
    v_mov_b32 v125, v112
    v_mov_b32 v126, v112
    v_mov_b32 v127, v112
    v_mov_b32 v5, v4
    s_nop 1
    v_permlane32_swap_b32 v5, v4
    v_max_f32 v5, v5, v4
    v_sub_f32 v128, 0xc2700000, v5
    v_mov_b32 v129, v128
    v_mov_b32 v130, v128
    v_mov_b32 v131, v128
    v_mov_b32 v132, v128
    v_mov_b32 v133, v128
    v_mov_b32 v134, v128
    v_mov_b32 v135, v128
    v_mov_b32 v136, v128
    v_mov_b32 v137, v128
    v_mov_b32 v138, v128
    v_mov_b32 v139, v128
    v_mov_b32 v140, v128
    v_mov_b32 v141, v128
    v_mov_b32 v142, v128
    v_mov_b32 v143, v128
    v_mfma_f32_32x32x16_bf16 v[16:31], v[160:163], v[144:147], v[112:127]
    v_mfma_f32_32x32x16_bf16 v[16:31], v[164:167], v[148:151], v[16:31]
    s_mov_b32 s41, 16
    s_nop 9
    .p2align 6
.Lk3_main_11:
    v_mfma_f32_32x32x16_bf16 v[32:47], v[160:163], v[152:155], v[128:143]
    ds_read_b128 v[168:171], v10 offset:4096
    v_exp_f32 v16, v16
    v_exp_f32 v17, v17
    v_exp_f32 v18, v18
    v_mfma_f32_32x32x16_bf16 v[32:47], v[164:167], v[156:159], v[32:47]
    ds_read_b128 v[172:175], v10 offset:5120
    v_exp_f32 v19, v19
    v_exp_f32 v20, v20
    v_exp_f32 v21, v21
    v_smfmac_f32_32x32x32_bf16 v[96:111], v[184:187], v[64:71], v12
    ds_read_b128 v[176:179], v10 offset:2048
    v_exp_f32 v22, v22
    v_exp_f32 v23, v23
    v_exp_f32 v24, v24
    v_exp_f32 v25, v25
    v_smfmac_f32_16x16x64_bf16 v[196:199], v[200:203], v[64:71], v12
    ds_read_b128 v[180:183], v10 offset:3072
    v_exp_f32 v26, v26
    v_smfmac_f32_32x32x32_bf16 v[96:111], v[188:191], v[72:79], v12
    v_exp_f32 v27, v27
    v_exp_f32 v28, v28
    v_exp_f32 v29, v29
    v_smfmac_f32_16x16x64_bf16 v[196:199], v[200:203], v[72:79], v12
    s_waitcnt lgkmcnt(2)
    v_exp_f32 v30, v30
    v_exp_f32 v31, v31
    v_mfma_f32_32x32x16_bf16 v[48:63], v[168:171], v[144:147], v[112:127]
    v_exp_f32 v32, v32
    v_exp_f32 v33, v33
    v_exp_f32 v34, v34
    v_mfma_f32_32x32x16_bf16 v[48:63], v[172:175], v[148:151], v[48:63]
    s_waitcnt lgkmcnt(0)
    v_exp_f32 v35, v35
    v_exp_f32 v36, v36
    v_exp_f32 v37, v37
    v_smfmac_f32_32x32x32_bf16 v[80:95], v[176:179], v[16:23], v12
    v_exp_f32 v38, v38
    v_exp_f32 v39, v39
    v_exp_f32 v40, v40
    v_exp_f32 v41, v41
    v_smfmac_f32_16x16x64_bf16 v[192:195], v[200:203], v[16:23], v12
    v_exp_f32 v42, v42
    v_smfmac_f32_32x32x32_bf16 v[80:95], v[180:183], v[24:31], v12
    v_exp_f32 v43, v43
    v_exp_f32 v44, v44
    v_exp_f32 v45, v45
    v_smfmac_f32_16x16x64_bf16 v[192:195], v[200:203], v[24:31], v12
    v_exp_f32 v46, v46
    v_exp_f32 v47, v47
    v_mfma_f32_32x32x16_bf16 v[64:79], v[168:171], v[152:155], v[128:143]
    ds_read_b128 v[160:163], v10 offset:8192
    v_exp_f32 v48, v48
    v_exp_f32 v49, v49
    v_exp_f32 v50, v50
    v_mfma_f32_32x32x16_bf16 v[64:79], v[172:175], v[156:159], v[64:79]
    ds_read_b128 v[164:167], v10 offset:9216
    v_exp_f32 v51, v51
    v_exp_f32 v52, v52
    v_exp_f32 v53, v53
    v_smfmac_f32_32x32x32_bf16 v[96:111], v[176:179], v[32:39], v12
    ds_read_b128 v[184:187], v10 offset:6144
    v_exp_f32 v54, v54
    v_exp_f32 v55, v55
    v_exp_f32 v56, v56
    v_exp_f32 v57, v57
    v_smfmac_f32_16x16x64_bf16 v[196:199], v[200:203], v[32:39], v12
    ds_read_b128 v[188:191], v10 offset:7168
    v_exp_f32 v58, v58
    v_smfmac_f32_32x32x32_bf16 v[96:111], v[180:183], v[40:47], v12
    v_exp_f32 v59, v59
    v_exp_f32 v60, v60
    v_exp_f32 v61, v61
    v_smfmac_f32_16x16x64_bf16 v[196:199], v[200:203], v[40:47], v12
    s_waitcnt lgkmcnt(2)
    v_exp_f32 v62, v62
    v_exp_f32 v63, v63
    v_mfma_f32_32x32x16_bf16 v[16:31], v[160:163], v[144:147], v[112:127]
    v_exp_f32 v64, v64
    v_exp_f32 v65, v65
    v_exp_f32 v66, v66
    v_mfma_f32_32x32x16_bf16 v[16:31], v[164:167], v[148:151], v[16:31]
    s_waitcnt lgkmcnt(0)
    v_exp_f32 v67, v67
    v_exp_f32 v68, v68
    v_exp_f32 v69, v69
    v_smfmac_f32_32x32x32_bf16 v[80:95], v[184:187], v[48:55], v12
    v_exp_f32 v70, v70
    v_exp_f32 v71, v71
    v_exp_f32 v72, v72
    v_exp_f32 v73, v73
    v_smfmac_f32_16x16x64_bf16 v[192:195], v[200:203], v[48:55], v12
    v_exp_f32 v74, v74
    v_smfmac_f32_32x32x32_bf16 v[80:95], v[188:191], v[56:63], v12
    v_exp_f32 v75, v75
    v_exp_f32 v76, v76
    v_exp_f32 v77, v77
    v_smfmac_f32_16x16x64_bf16 v[192:195], v[200:203], v[56:63], v12
    v_exp_f32 v78, v78
    v_exp_f32 v79, v79
    v_mfma_f32_32x32x16_bf16 v[32:47], v[160:163], v[152:155], v[128:143]
    ds_read_b128 v[168:171], v10 offset:12288
    v_exp_f32 v16, v16
    v_exp_f32 v17, v17
    v_exp_f32 v18, v18
    v_mfma_f32_32x32x16_bf16 v[32:47], v[164:167], v[156:159], v[32:47]
    ds_read_b128 v[172:175], v10 offset:13312
    v_exp_f32 v19, v19
    v_exp_f32 v20, v20
    v_exp_f32 v21, v21
    v_smfmac_f32_32x32x32_bf16 v[96:111], v[184:187], v[64:71], v12
    ds_read_b128 v[176:179], v10 offset:10240
    v_exp_f32 v22, v22
    v_exp_f32 v23, v23
    v_exp_f32 v24, v24
    v_exp_f32 v25, v25
    v_smfmac_f32_16x16x64_bf16 v[196:199], v[200:203], v[64:71], v12
    ds_read_b128 v[180:183], v10 offset:11264
    v_exp_f32 v26, v26
    v_smfmac_f32_32x32x32_bf16 v[96:111], v[188:191], v[72:79], v12
    v_exp_f32 v27, v27
    v_exp_f32 v28, v28
    v_exp_f32 v29, v29
    v_smfmac_f32_16x16x64_bf16 v[196:199], v[200:203], v[72:79], v12
    s_waitcnt lgkmcnt(2)
    v_exp_f32 v30, v30
    v_exp_f32 v31, v31
    v_mfma_f32_32x32x16_bf16 v[48:63], v[168:171], v[144:147], v[112:127]
    v_exp_f32 v32, v32
    v_exp_f32 v33, v33
    v_exp_f32 v34, v34
    v_mfma_f32_32x32x16_bf16 v[48:63], v[172:175], v[148:151], v[48:63]
    s_waitcnt lgkmcnt(0)
    v_exp_f32 v35, v35
    v_exp_f32 v36, v36
    v_exp_f32 v37, v37
    v_smfmac_f32_32x32x32_bf16 v[80:95], v[176:179], v[16:23], v12
    v_exp_f32 v38, v38
    v_exp_f32 v39, v39
    v_exp_f32 v40, v40
    v_exp_f32 v41, v41
    v_smfmac_f32_16x16x64_bf16 v[192:195], v[200:203], v[16:23], v12
    v_exp_f32 v42, v42
    v_smfmac_f32_32x32x32_bf16 v[80:95], v[180:183], v[24:31], v12
    s_barrier
    v_exp_f32 v43, v43
    v_exp_f32 v44, v44
    v_exp_f32 v45, v45
    v_smfmac_f32_16x16x64_bf16 v[192:195], v[200:203], v[24:31], v12
    v_exp_f32 v46, v46
    v_exp_f32 v47, v47
    v_mfma_f32_32x32x16_bf16 v[64:79], v[168:171], v[152:155], v[128:143]
    ds_read_b128 v[160:163], v11 offset:0
    v_exp_f32 v48, v48
    v_exp_f32 v49, v49
    v_exp_f32 v50, v50
    v_mfma_f32_32x32x16_bf16 v[64:79], v[172:175], v[156:159], v[64:79]
    ds_read_b128 v[164:167], v11 offset:1024
    v_exp_f32 v51, v51
    v_exp_f32 v52, v52
    v_exp_f32 v53, v53
    v_smfmac_f32_32x32x32_bf16 v[96:111], v[176:179], v[32:39], v12
    ds_read_b128 v[184:187], v10 offset:14336
    v_exp_f32 v54, v54
    v_exp_f32 v55, v55
    v_exp_f32 v56, v56
    v_exp_f32 v57, v57
    v_smfmac_f32_16x16x64_bf16 v[196:199], v[200:203], v[32:39], v12
    ds_read_b128 v[188:191], v10 offset:15360
    v_exp_f32 v58, v58
    v_smfmac_f32_32x32x32_bf16 v[96:111], v[180:183], v[40:47], v12
    v_exp_f32 v59, v59
    v_exp_f32 v60, v60
    v_exp_f32 v61, v61
    v_smfmac_f32_16x16x64_bf16 v[196:199], v[200:203], v[40:47], v12
    s_waitcnt lgkmcnt(2)
    v_exp_f32 v62, v62
    v_exp_f32 v63, v63
    v_mfma_f32_32x32x16_bf16 v[16:31], v[160:163], v[144:147], v[112:127]
    s_add_u32 s40, s40, 16384
    s_and_b32 s40, s40, 0xffff
    v_exp_f32 v64, v64
    v_exp_f32 v65, v65
    v_exp_f32 v66, v66
    v_mfma_f32_32x32x16_bf16 v[16:31], v[164:167], v[148:151], v[16:31]
    s_waitcnt lgkmcnt(0)
    s_sub_u32 s41, s41, 1
    s_cmp_lg_u32 s41, 0
    v_mov_b32 v10, v11
    v_add_u32 v11, s40, v8
    v_exp_f32 v67, v67
    v_exp_f32 v68, v68
    v_exp_f32 v69, v69
    v_smfmac_f32_32x32x32_bf16 v[80:95], v[184:187], v[48:55], v12
    v_exp_f32 v70, v70
    v_exp_f32 v71, v71
    v_exp_f32 v72, v72
    v_exp_f32 v73, v73
    v_smfmac_f32_16x16x64_bf16 v[192:195], v[200:203], v[48:55], v12
    v_exp_f32 v74, v74
    v_smfmac_f32_32x32x32_bf16 v[80:95], v[188:191], v[56:63], v12
    v_exp_f32 v75, v75
    v_exp_f32 v76, v76
    v_exp_f32 v77, v77
    v_smfmac_f32_16x16x64_bf16 v[192:195], v[200:203], v[56:63], v12
    v_exp_f32 v78, v78
    v_exp_f32 v79, v79
    s_cbranch_scc1 .Lk3_main_11
    v_smfmac_f32_32x32x32_bf16 v[96:111], v[184:187], v[64:71], v12
    v_smfmac_f32_32x32x32_bf16 v[96:111], v[188:191], v[72:79], v12
    v_smfmac_f32_16x16x64_bf16 v[196:199], v[200:203], v[64:71], v12
    v_smfmac_f32_16x16x64_bf16 v[196:199], v[200:203], v[72:79], v12
    s_mov_b32 s47, 0
.Lk3_epi_12:
    v_rcp_f32 v3, v192
    v_mov_b32 v6, 0
    v_mov_b32 v7, 0
    v_mov_b32 v14, 0
    v_mov_b32 v15, 0
    s_mov_b32 s44, 0x71800000
    v_pk_fma_f32 v[14:15], v[80:81], 0, v[14:15]
    v_pk_fma_f32 v[6:7], v[82:83], 0, v[6:7]
    v_pk_fma_f32 v[14:15], v[84:85], 0, v[14:15]
    v_pk_fma_f32 v[6:7], v[86:87], 0, v[6:7]
    v_pk_fma_f32 v[14:15], v[88:89], 0, v[14:15]
    v_pk_fma_f32 v[6:7], v[90:91], 0, v[6:7]
    v_pk_fma_f32 v[14:15], v[92:93], 0, v[14:15]
    v_pk_fma_f32 v[6:7], v[94:95], 0, v[6:7]
    v_mul_f32 v16, v80, v3
    v_mul_f32 v17, v81, v3
    v_mul_f32 v18, v82, v3
    v_mul_f32 v19, v83, v3
    v_mul_f32 v20, v84, v3
    v_mul_f32 v21, v85, v3
    v_mul_f32 v22, v86, v3
    v_mul_f32 v23, v87, v3
    v_mul_f32 v24, v88, v3
    v_mul_f32 v25, v89, v3
    v_mul_f32 v26, v90, v3
    v_mul_f32 v27, v91, v3
    v_mul_f32 v28, v92, v3
    v_mul_f32 v29, v93, v3
    v_mul_f32 v30, v94, v3
    v_mul_f32 v31, v95, v3
    v_cvt_pk_bf16_f32 v48, v16, v17
    v_cvt_pk_bf16_f32 v49, v18, v19
    v_cvt_pk_bf16_f32 v50, v20, v21
    v_cvt_pk_bf16_f32 v51, v22, v23
    v_cvt_pk_bf16_f32 v52, v24, v25
    v_cvt_pk_bf16_f32 v53, v26, v27
    v_cvt_pk_bf16_f32 v54, v28, v29
    v_cvt_pk_bf16_f32 v55, v30, v31
    buffer_store_dwordx4 v[48:51], v13, s[24:27], s46 offen offset:0 sc1
    buffer_store_dwordx4 v[52:55], v13, s[24:27], s46 offen offset:512 sc1
    v_rcp_f32 v4, v196
    s_add_u32 s48, s46, 65536
    v_pk_fma_f32 v[14:15], v[96:97], 0, v[14:15]
    v_pk_fma_f32 v[6:7], v[98:99], 0, v[6:7]
    v_pk_fma_f32 v[14:15], v[100:101], 0, v[14:15]
    v_pk_fma_f32 v[6:7], v[102:103], 0, v[6:7]
    v_pk_fma_f32 v[14:15], v[104:105], 0, v[14:15]
    v_pk_fma_f32 v[6:7], v[106:107], 0, v[6:7]
    v_pk_fma_f32 v[14:15], v[108:109], 0, v[14:15]
    v_pk_fma_f32 v[6:7], v[110:111], 0, v[6:7]
    v_mul_f32 v32, v96, v4
    v_mul_f32 v33, v97, v4
    v_mul_f32 v34, v98, v4
    v_mul_f32 v35, v99, v4
    v_mul_f32 v36, v100, v4
    v_mul_f32 v37, v101, v4
    v_mul_f32 v38, v102, v4
    v_mul_f32 v39, v103, v4
    v_mul_f32 v40, v104, v4
    v_mul_f32 v41, v105, v4
    v_mul_f32 v42, v106, v4
    v_mul_f32 v43, v107, v4
    v_mul_f32 v44, v108, v4
    v_mul_f32 v45, v109, v4
    v_mul_f32 v46, v110, v4
    v_mul_f32 v47, v111, v4
    v_cvt_pk_bf16_f32 v56, v32, v33
    v_cvt_pk_bf16_f32 v57, v34, v35
    v_cvt_pk_bf16_f32 v58, v36, v37
    v_cvt_pk_bf16_f32 v59, v38, v39
    v_cvt_pk_bf16_f32 v60, v40, v41
    v_cvt_pk_bf16_f32 v61, v42, v43
    v_cvt_pk_bf16_f32 v62, v44, v45
    v_cvt_pk_bf16_f32 v63, v46, v47
    buffer_store_dwordx4 v[56:59], v13, s[24:27], s48 offen offset:0 sc1
    buffer_store_dwordx4 v[60:63], v13, s[24:27], s48 offen offset:512 sc1
    v_add_f32 v6, v6, v7
    v_add_f32 v14, v14, v15
    v_cmp_u_f32 s[50:51], v6, v14
    v_cmp_nge_f32 s[52:53], s44, v192
    v_cmp_nge_f32 s[54:55], s44, v196
    s_or_b64 s[50:51], s[50:51], s[52:53]
    s_or_b64 s[50:51], s[50:51], s[54:55]
    s_cbranch_scc1 .Lk3_fallback_13
.Lk3_done_14:
    s_branch .Lk3_c4_15
.Lk3_fallback_13:
    s_cmp_eq_u32 s47, 1
    s_cbranch_scc1 .Lk3_done_14
    s_mov_b32 s47, 1
    s_waitcnt vmcnt(0)
    v_mov_b32 v3, 0xff800000
    v_mov_b32 v4, 0xff800000
    s_mov_b32 s40, 0
.Lk3_f1_16:
    buffer_load_dwordx4 v[160:163], v9, s[28:31], s40 offen sc1
    buffer_load_dwordx4 v[164:167], v9, s[28:31], s40 offen offset:1024 sc1
    s_waitcnt vmcnt(0)
    v_mfma_f32_32x32x16_bf16 v[32:47], v[160:163], v[144:147], 0
    v_mfma_f32_32x32x16_bf16 v[32:47], v[164:167], v[148:151], v[32:47]
    v_mfma_f32_32x32x16_bf16 v[48:63], v[160:163], v[152:155], 0
    v_mfma_f32_32x32x16_bf16 v[48:63], v[164:167], v[156:159], v[48:63]
    s_nop 9
    v_max3_f32 v3, v3, v32, v33
    v_max3_f32 v3, v3, v34, v35
    v_max3_f32 v3, v3, v36, v37
    v_max3_f32 v3, v3, v38, v39
    v_max3_f32 v3, v3, v40, v41
    v_max3_f32 v3, v3, v42, v43
    v_max3_f32 v3, v3, v44, v45
    v_max3_f32 v3, v3, v46, v47
    v_max3_f32 v4, v4, v48, v49
    v_max3_f32 v4, v4, v50, v51
    v_max3_f32 v4, v4, v52, v53
    v_max3_f32 v4, v4, v54, v55
    v_max3_f32 v4, v4, v56, v57
    v_max3_f32 v4, v4, v58, v59
    v_max3_f32 v4, v4, v60, v61
    v_max3_f32 v4, v4, v62, v63
    s_add_u32 s40, s40, 4096
    s_cmp_lt_u32 s40, 262144
    s_cbranch_scc1 .Lk3_f1_16
    v_mov_b32 v5, v3
    s_nop 1
    v_permlane32_swap_b32 v5, v3
    v_max_f32 v5, v5, v3
    v_sub_f32 v112, 0xc1300000, v5
    v_mov_b32 v113, v112
    v_mov_b32 v114, v112
    v_mov_b32 v115, v112
    v_mov_b32 v116, v112
    v_mov_b32 v117, v112
    v_mov_b32 v118, v112
    v_mov_b32 v119, v112
    v_mov_b32 v120, v112
    v_mov_b32 v121, v112
    v_mov_b32 v122, v112
    v_mov_b32 v123, v112
    v_mov_b32 v124, v112
    v_mov_b32 v125, v112
    v_mov_b32 v126, v112
    v_mov_b32 v127, v112
    v_mov_b32 v5, v4
    s_nop 1
    v_permlane32_swap_b32 v5, v4
    v_max_f32 v5, v5, v4
    v_sub_f32 v128, 0xc1300000, v5
    v_mov_b32 v129, v128
    v_mov_b32 v130, v128
    v_mov_b32 v131, v128
    v_mov_b32 v132, v128
    v_mov_b32 v133, v128
    v_mov_b32 v134, v128
    v_mov_b32 v135, v128
    v_mov_b32 v136, v128
    v_mov_b32 v137, v128
    v_mov_b32 v138, v128
    v_mov_b32 v139, v128
    v_mov_b32 v140, v128
    v_mov_b32 v141, v128
    v_mov_b32 v142, v128
    v_mov_b32 v143, v128
    v_mov_b32 v80, 0
    v_mov_b32 v81, 0
    v_mov_b32 v82, 0
    v_mov_b32 v83, 0
    v_mov_b32 v84, 0
    v_mov_b32 v85, 0
    v_mov_b32 v86, 0
    v_mov_b32 v87, 0
    v_mov_b32 v88, 0
    v_mov_b32 v89, 0
    v_mov_b32 v90, 0
    v_mov_b32 v91, 0
    v_mov_b32 v92, 0
    v_mov_b32 v93, 0
    v_mov_b32 v94, 0
    v_mov_b32 v95, 0
    v_mov_b32 v96, 0
    v_mov_b32 v97, 0
    v_mov_b32 v98, 0
    v_mov_b32 v99, 0
    v_mov_b32 v100, 0
    v_mov_b32 v101, 0
    v_mov_b32 v102, 0
    v_mov_b32 v103, 0
    v_mov_b32 v104, 0
    v_mov_b32 v105, 0
    v_mov_b32 v106, 0
    v_mov_b32 v107, 0
    v_mov_b32 v108, 0
    v_mov_b32 v109, 0
    v_mov_b32 v110, 0
    v_mov_b32 v111, 0
    v_mov_b32 v192, 0
    v_mov_b32 v193, 0
    v_mov_b32 v194, 0
    v_mov_b32 v195, 0
    v_mov_b32 v196, 0
    v_mov_b32 v197, 0
    v_mov_b32 v198, 0
    v_mov_b32 v199, 0
    s_mov_b32 s40, 0
.Lk3_f2_17:
    buffer_load_dwordx4 v[160:163], v9, s[28:31], s40 offen offset:0 sc1
    buffer_load_dwordx4 v[176:179], v9, s[28:31], s40 offen offset:2048 sc1
    buffer_load_dwordx4 v[164:167], v9, s[28:31], s40 offen offset:1024 sc1
    buffer_load_dwordx4 v[180:183], v9, s[28:31], s40 offen offset:3072 sc1
    s_waitcnt vmcnt(0)
    v_mfma_f32_32x32x16_bf16 v[16:31], v[160:163], v[144:147], v[112:127]
    v_mfma_f32_32x32x16_bf16 v[16:31], v[164:167], v[148:151], v[16:31]
    v_mfma_f32_32x32x16_bf16 v[32:47], v[160:163], v[152:155], v[128:143]
    v_mfma_f32_32x32x16_bf16 v[32:47], v[164:167], v[156:159], v[32:47]
    s_nop 9
    v_exp_f32 v16, v16
    v_exp_f32 v17, v17
    v_exp_f32 v18, v18
    v_exp_f32 v19, v19
    v_exp_f32 v20, v20
    v_exp_f32 v21, v21
    v_exp_f32 v22, v22
    v_exp_f32 v23, v23
    v_exp_f32 v24, v24
    v_exp_f32 v25, v25
    v_exp_f32 v26, v26
    v_exp_f32 v27, v27
    v_exp_f32 v28, v28
    v_exp_f32 v29, v29
    v_exp_f32 v30, v30
    v_exp_f32 v31, v31
    v_exp_f32 v32, v32
    v_exp_f32 v33, v33
    v_exp_f32 v34, v34
    v_exp_f32 v35, v35
    v_exp_f32 v36, v36
    v_exp_f32 v37, v37
    v_exp_f32 v38, v38
    v_exp_f32 v39, v39
    v_exp_f32 v40, v40
    v_exp_f32 v41, v41
    v_exp_f32 v42, v42
    v_exp_f32 v43, v43
    v_exp_f32 v44, v44
    v_exp_f32 v45, v45
    v_exp_f32 v46, v46
    v_exp_f32 v47, v47
    v_smfmac_f32_32x32x32_bf16 v[80:95], v[176:179], v[16:23], v12
    v_smfmac_f32_32x32x32_bf16 v[80:95], v[180:183], v[24:31], v12
    v_smfmac_f32_16x16x64_bf16 v[192:195], v[200:203], v[16:23], v12
    v_smfmac_f32_16x16x64_bf16 v[192:195], v[200:203], v[24:31], v12
    v_smfmac_f32_32x32x32_bf16 v[96:111], v[176:179], v[32:39], v12
    v_smfmac_f32_32x32x32_bf16 v[96:111], v[180:183], v[40:47], v12
    v_smfmac_f32_16x16x64_bf16 v[196:199], v[200:203], v[32:39], v12
    v_smfmac_f32_16x16x64_bf16 v[196:199], v[200:203], v[40:47], v12
    s_add_u32 s40, s40, 4096
    s_cmp_lt_u32 s40, 262144
    s_cbranch_scc1 .Lk3_f2_17
    s_branch .Lk3_epi_12
.Lk3_loader_2:
    s_setprio 1
    s_sub_u32 s42, s95, 4
    v_lshlrev_b32 v11, 4, v2
    v_lshrrev_b32 v30, 3, v2
    v_and_b32 v31, 7, v2
    s_lshl_b32 s3, s95, 2
    s_and_b32 s3, s3, 4
    v_xor_b32 v31, s3, v31
    s_lshl_b32 s3, s13, 1
    s_and_b32 s3, s3, 12
    v_add_u32 v28, s3, v30
    v_and_b32 v28, 15, v28
    v_lshlrev_b32 v28, 11, v28
    v_lshl_add_u32 v28, v31, 4, v28
    v_xor_b32 v29, 16384, v28
    v_mov_b32 v9, 0
    s_lshl_b32 s43, s12, 17
    s_lshl_b32 s3, s42, 15
    s_add_u32 s43, s43, s3
    s_mov_b32 s47, s94
    s_waitcnt lgkmcnt(0)
    s_mov_b32 s20, s4
    s_mov_b32 s21, s5
    s_mov_b32 s22, 4194304
    s_mov_b32 s23, 0x20000
    s_add_u32 s32, s6, 458752
    s_addc_u32 s33, s7, 0
    s_mov_b32 s34, 37120
    s_mov_b32 s35, 0x20000
    s_load_dwordx2 s[52:53], s[0:1], 48
    s_load_dwordx2 s[54:55], s[0:1], 56
    s_load_dwordx2 s[56:57], s[0:1], 32
    s_lshr_b32 s3, s47, 21
    s_add_u32 s3, s3, s43
    s_add_u32 s47, s47, s49
    buffer_load_dwordx4 v[64:67], v28, s[20:23], s3 offen
    buffer_load_dwordx4 v[68:71], v29, s[20:23], s3 offen
    s_lshr_b32 s3, s47, 21
    s_add_u32 s3, s3, s43
    s_add_u32 s47, s47, s49
    buffer_load_dwordx4 v[72:75], v28, s[20:23], s3 offen
    buffer_load_dwordx4 v[76:79], v29, s[20:23], s3 offen
    s_mov_b32 s3, 36864
    buffer_load_dword v10, v9, s[32:35], s3 offen sc1
    s_lshr_b32 s3, s47, 21
    s_add_u32 s3, s3, s43
    s_add_u32 s47, s47, s49
    buffer_load_dwordx4 v[80:83], v28, s[20:23], s3 offen
    buffer_load_dwordx4 v[84:87], v29, s[20:23], s3 offen
    s_lshr_b32 s3, s47, 21
    s_add_u32 s3, s3, s43
    s_add_u32 s47, s47, s49
    buffer_load_dwordx4 v[88:91], v28, s[20:23], s3 offen
    buffer_load_dwordx4 v[92:95], v29, s[20:23], s3 offen
    s_lshr_b32 s3, s47, 21
    s_add_u32 s3, s3, s43
    s_add_u32 s47, s47, s49
    buffer_load_dwordx4 v[96:99], v28, s[20:23], s3 offen
    buffer_load_dwordx4 v[100:103], v29, s[20:23], s3 offen
    s_lshr_b32 s3, s47, 21
    s_add_u32 s3, s3, s43
    s_add_u32 s47, s47, s49
    buffer_load_dwordx4 v[104:107], v28, s[20:23], s3 offen
    buffer_load_dwordx4 v[108:111], v29, s[20:23], s3 offen
    s_lshr_b32 s3, s47, 21
    s_add_u32 s3, s3, s43
    s_add_u32 s47, s47, s49
    buffer_load_dwordx4 v[112:115], v28, s[20:23], s3 offen
    buffer_load_dwordx4 v[116:119], v29, s[20:23], s3 offen
    s_lshr_b32 s3, s47, 21
    s_add_u32 s3, s3, s43
    s_add_u32 s47, s47, s49
    buffer_load_dwordx4 v[120:123], v28, s[20:23], s3 offen
    buffer_load_dwordx4 v[124:127], v29, s[20:23], s3 offen
    s_lshr_b32 s3, s47, 21
    s_add_u32 s3, s3, s43
    s_add_u32 s47, s47, s49
    buffer_load_dwordx4 v[128:131], v28, s[20:23], s3 offen
    buffer_load_dwordx4 v[132:135], v29, s[20:23], s3 offen
    s_lshr_b32 s3, s47, 21
    s_add_u32 s3, s3, s43
    s_add_u32 s47, s47, s49
    buffer_load_dwordx4 v[136:139], v28, s[20:23], s3 offen
    buffer_load_dwordx4 v[140:143], v29, s[20:23], s3 offen
    s_lshr_b32 s3, s47, 21
    s_add_u32 s3, s3, s43
    s_add_u32 s47, s47, s49
    buffer_load_dwordx4 v[144:147], v28, s[20:23], s3 offen
    buffer_load_dwordx4 v[148:151], v29, s[20:23], s3 offen
    s_lshr_b32 s3, s47, 21
    s_add_u32 s3, s3, s43
    s_add_u32 s47, s47, s49
    buffer_load_dwordx4 v[152:155], v28, s[20:23], s3 offen
    buffer_load_dwordx4 v[156:159], v29, s[20:23], s3 offen
    s_lshr_b32 s3, s47, 21
    s_add_u32 s3, s3, s43
    s_add_u32 s47, s47, s49
    buffer_load_dwordx4 v[160:163], v28, s[20:23], s3 offen
    buffer_load_dwordx4 v[164:167], v29, s[20:23], s3 offen
    s_lshr_b32 s3, s47, 21
    s_add_u32 s3, s3, s43
    s_add_u32 s47, s47, s49
    buffer_load_dwordx4 v[168:171], v28, s[20:23], s3 offen
    buffer_load_dwordx4 v[172:175], v29, s[20:23], s3 offen
    s_lshr_b32 s3, s47, 21
    s_add_u32 s3, s3, s43
    s_add_u32 s47, s47, s49
    buffer_load_dwordx4 v[176:179], v28, s[20:23], s3 offen
    buffer_load_dwordx4 v[180:183], v29, s[20:23], s3 offen
    s_lshr_b32 s3, s47, 21
    s_add_u32 s3, s3, s43
    s_add_u32 s47, s47, s49
    buffer_load_dwordx4 v[184:187], v28, s[20:23], s3 offen
    buffer_load_dwordx4 v[188:191], v29, s[20:23], s3 offen
    s_lshl_b32 s40, s42, 11
    s_add_u32 s41, s40, 8192
    s_add_u32 s44, s40, 16384
    s_add_u32 s45, s40, 24576
    s_mov_b32 s24, s8
    s_mov_b32 s25, s9
    s_mov_b32 s26, 2048
    s_mov_b32 s27, 0x20000
    v_lshlrev_b32 v3, 3, v2
    s_lshr_b32 s3, s2, 6
    s_lshl_b32 s3, s3, 9
    buffer_load_dwordx2 v[0:1], v3, s[24:27], s3 offen
    s_mov_b32 s16, s70
    s_mov_b32 s17, s71
    s_mov_b32 s18, 2097152
    s_mov_b32 s19, 0x20000
    v_lshlrev_b32 v3, 5, v31
    v_add_u32 v3, 24576, v3
    s_lshl_b32 s3, s42, 2
    v_add_u32 v9, s3, v30
    v_xor_b32 v9, v9, v31
    v_lshlrev_b32 v9, 4, v9
    v_lshl_add_u32 v9, v31, 8, v9
    v_add_u32 v9, 65536, v9
    s_lshl_b32 m0, s42, 11
    v_bfe_u32 v5, v2, 3, 1
    v_bfe_u32 v6, v2, 4, 1
    v_lshl_add_u32 v5, v6, 3, v5
    v_lshlrev_b32 v6, 2, v6
    v_and_b32 v12, 7, v2
    v_xor_b32 v6, v6, v12
    v_lshrrev_b32 v12, 5, v2
    v_lshlrev_b32 v5, 11, v5
    v_lshl_add_u32 v5, v12, 7, v5
    v_lshl_add_u32 v5, v6, 4, v5
    v_add_u32 v6, 31744, v5
    v_add_u32 v7, 63488, v5
    v_add_u32 v8, 95232, v5
    s_lshl_b32 s98, s42, 12
    s_lshl_b32 s97, s13, 8
    s_add_u32 s97, s97, s98
    s_mov_b32 s60, 0x04000c0c
    s_mov_b32 s50, 0x0706000c
    s_lshr_b32 s3, s94, 20
    s_sub_u32 s3, s40, s3
    v_add_u32 v16, s3, v11
    v_add_u32 v19, 1024, v16
    v_and_b32 v16, 0xfff, v16
    v_and_b32 v19, 0xfff, v19
    s_lshr_b32 s3, s42, 1
    s_lshl_b32 s3, s3, 12
    s_add_u32 s3, s3, 24576
    v_add_u32 v16, s3, v16
    v_add_u32 v19, s3, v19
    s_mov_b32 s46, 0x3f803f80
    s_mov_b32 s51, 0x9e3779b1
    s_lshl_b32 s3, s42, 2
    s_add_u32 s3, s3, 16384
    v_mov_b32 v18, s3
    v_mov_b32 v17, 0
    ds_write_b32 v18, v17
    v_mov_b32 v20, 0
    v_mov_b32 v21, 0
    v_mov_b32 v22, 0
    v_mov_b32 v23, 0
    v_mov_b32 v24, 0
    v_mov_b32 v25, 0
    v_mov_b32 v26, 0
    v_mov_b32 v27, 0
    s_waitcnt vmcnt(32)
    v_dot2c_f32_bf16 v20, s46, v64
    v_dot2c_f32_bf16 v24, v64, v64
    v_dot2c_f32_bf16 v22, s46, v68
    v_dot2c_f32_bf16 v26, v68, v68
    v_dot2c_f32_bf16 v21, s46, v65
    v_dot2c_f32_bf16 v25, v65, v65
    v_dot2c_f32_bf16 v23, s46, v69
    v_dot2c_f32_bf16 v27, v69, v69
    v_dot2c_f32_bf16 v20, s46, v66
    v_dot2c_f32_bf16 v24, v66, v66
    v_dot2c_f32_bf16 v22, s46, v70
    v_dot2c_f32_bf16 v26, v70, v70
    v_dot2c_f32_bf16 v21, s46, v67
    v_dot2c_f32_bf16 v25, v67, v67
    v_dot2c_f32_bf16 v23, s46, v71
    v_dot2c_f32_bf16 v27, v71, v71
    s_waitcnt vmcnt(30)
    v_dot2c_f32_bf16 v20, s46, v72
    v_dot2c_f32_bf16 v24, v72, v72
    v_dot2c_f32_bf16 v22, s46, v76
    v_dot2c_f32_bf16 v26, v76, v76
    v_dot2c_f32_bf16 v21, s46, v73
    v_dot2c_f32_bf16 v25, v73, v73
    v_dot2c_f32_bf16 v23, s46, v77
    v_dot2c_f32_bf16 v27, v77, v77
    v_dot2c_f32_bf16 v20, s46, v74
    v_dot2c_f32_bf16 v24, v74, v74
    v_dot2c_f32_bf16 v22, s46, v78
    v_dot2c_f32_bf16 v26, v78, v78
    v_dot2c_f32_bf16 v21, s46, v75
    v_dot2c_f32_bf16 v25, v75, v75
    v_dot2c_f32_bf16 v23, s46, v79
    v_dot2c_f32_bf16 v27, v79, v79
    s_waitcnt vmcnt(27)
    v_mul_lo_u32 v10, v10, s51
    v_add_u32 v10, 0x7f4a7c15, v10
    v_dot2c_f32_bf16 v20, s46, v80
    v_dot2c_f32_bf16 v24, v80, v80
    v_dot2c_f32_bf16 v22, s46, v84
    v_dot2c_f32_bf16 v26, v84, v84
    v_dot2c_f32_bf16 v21, s46, v81
    v_dot2c_f32_bf16 v25, v81, v81
    v_dot2c_f32_bf16 v23, s46, v85
    v_dot2c_f32_bf16 v27, v85, v85
    v_dot2c_f32_bf16 v20, s46, v82
    v_dot2c_f32_bf16 v24, v82, v82
    v_dot2c_f32_bf16 v22, s46, v86
    v_dot2c_f32_bf16 v26, v86, v86
    v_dot2c_f32_bf16 v21, s46, v83
    v_dot2c_f32_bf16 v25, v83, v83
    v_dot2c_f32_bf16 v23, s46, v87
    v_dot2c_f32_bf16 v27, v87, v87
    s_waitcnt vmcnt(25)
    v_readfirstlane_b32 s100, v10
    v_dot2c_f32_bf16 v20, s46, v88
    v_dot2c_f32_bf16 v24, v88, v88
    v_dot2c_f32_bf16 v22, s46, v92
    v_dot2c_f32_bf16 v26, v92, v92
    v_dot2c_f32_bf16 v21, s46, v89
    v_dot2c_f32_bf16 v25, v89, v89
    v_dot2c_f32_bf16 v23, s46, v93
    v_dot2c_f32_bf16 v27, v93, v93
    v_dot2c_f32_bf16 v20, s46, v90
    v_dot2c_f32_bf16 v24, v90, v90
    v_dot2c_f32_bf16 v22, s46, v94
    v_dot2c_f32_bf16 v26, v94, v94
    v_dot2c_f32_bf16 v21, s46, v91
    v_dot2c_f32_bf16 v25, v91, v91
    v_dot2c_f32_bf16 v23, s46, v95
    v_dot2c_f32_bf16 v27, v95, v95
    s_waitcnt vmcnt(23)
    v_dot2c_f32_bf16 v20, s46, v96
    v_dot2c_f32_bf16 v24, v96, v96
    v_dot2c_f32_bf16 v22, s46, v100
    v_dot2c_f32_bf16 v26, v100, v100
    v_dot2c_f32_bf16 v21, s46, v97
    v_dot2c_f32_bf16 v25, v97, v97
    v_dot2c_f32_bf16 v23, s46, v101
    v_dot2c_f32_bf16 v27, v101, v101
    v_dot2c_f32_bf16 v20, s46, v98
    v_dot2c_f32_bf16 v24, v98, v98
    v_dot2c_f32_bf16 v22, s46, v102
    v_dot2c_f32_bf16 v26, v102, v102
    v_dot2c_f32_bf16 v21, s46, v99
    v_dot2c_f32_bf16 v25, v99, v99
    v_dot2c_f32_bf16 v23, s46, v103
    v_dot2c_f32_bf16 v27, v103, v103
    s_waitcnt vmcnt(21)
    v_dot2c_f32_bf16 v20, s46, v104
    v_dot2c_f32_bf16 v24, v104, v104
    v_dot2c_f32_bf16 v22, s46, v108
    v_dot2c_f32_bf16 v26, v108, v108
    v_dot2c_f32_bf16 v21, s46, v105
    v_dot2c_f32_bf16 v25, v105, v105
    v_dot2c_f32_bf16 v23, s46, v109
    v_dot2c_f32_bf16 v27, v109, v109
    v_dot2c_f32_bf16 v20, s46, v106
    v_dot2c_f32_bf16 v24, v106, v106
    v_dot2c_f32_bf16 v22, s46, v110
    v_dot2c_f32_bf16 v26, v110, v110
    v_dot2c_f32_bf16 v21, s46, v107
    v_dot2c_f32_bf16 v25, v107, v107
    v_dot2c_f32_bf16 v23, s46, v111
    v_dot2c_f32_bf16 v27, v111, v111
    s_waitcnt vmcnt(19)
    v_dot2c_f32_bf16 v20, s46, v112
    v_dot2c_f32_bf16 v24, v112, v112
    v_dot2c_f32_bf16 v22, s46, v116
    v_dot2c_f32_bf16 v26, v116, v116
    v_dot2c_f32_bf16 v21, s46, v113
    v_dot2c_f32_bf16 v25, v113, v113
    v_dot2c_f32_bf16 v23, s46, v117
    v_dot2c_f32_bf16 v27, v117, v117
    v_dot2c_f32_bf16 v20, s46, v114
    v_dot2c_f32_bf16 v24, v114, v114
    v_dot2c_f32_bf16 v22, s46, v118
    v_dot2c_f32_bf16 v26, v118, v118
    v_dot2c_f32_bf16 v21, s46, v115
    v_dot2c_f32_bf16 v25, v115, v115
    v_dot2c_f32_bf16 v23, s46, v119
    v_dot2c_f32_bf16 v27, v119, v119
    s_waitcnt vmcnt(17)
    v_dot2c_f32_bf16 v20, s46, v120
    v_dot2c_f32_bf16 v24, v120, v120
    v_dot2c_f32_bf16 v22, s46, v124
    v_dot2c_f32_bf16 v26, v124, v124
    v_dot2c_f32_bf16 v21, s46, v121
    v_dot2c_f32_bf16 v25, v121, v121
    v_dot2c_f32_bf16 v23, s46, v125
    v_dot2c_f32_bf16 v27, v125, v125
    v_dot2c_f32_bf16 v20, s46, v122
    v_dot2c_f32_bf16 v24, v122, v122
    v_dot2c_f32_bf16 v22, s46, v126
    v_dot2c_f32_bf16 v26, v126, v126
    v_dot2c_f32_bf16 v21, s46, v123
    v_dot2c_f32_bf16 v25, v123, v123
    v_dot2c_f32_bf16 v23, s46, v127
    v_dot2c_f32_bf16 v27, v127, v127
    s_waitcnt vmcnt(15)
    v_dot2c_f32_bf16 v20, s46, v128
    v_dot2c_f32_bf16 v24, v128, v128
    v_dot2c_f32_bf16 v22, s46, v132
    v_dot2c_f32_bf16 v26, v132, v132
    v_dot2c_f32_bf16 v21, s46, v129
    v_dot2c_f32_bf16 v25, v129, v129
    v_dot2c_f32_bf16 v23, s46, v133
    v_dot2c_f32_bf16 v27, v133, v133
    v_dot2c_f32_bf16 v20, s46, v130
    v_dot2c_f32_bf16 v24, v130, v130
    v_dot2c_f32_bf16 v22, s46, v134
    v_dot2c_f32_bf16 v26, v134, v134
    v_dot2c_f32_bf16 v21, s46, v131
    v_dot2c_f32_bf16 v25, v131, v131
    v_dot2c_f32_bf16 v23, s46, v135
    v_dot2c_f32_bf16 v27, v135, v135
    buffer_load_dwordx4 v[32:35], v11, s[32:35], s40 offen offset:0 sc1
    buffer_load_dwordx4 v[36:39], v11, s[32:35], s41 offen offset:0 sc1
    buffer_load_dwordx4 v[40:43], v11, s[32:35], s44 offen offset:0 sc1
    buffer_load_dwordx4 v[44:47], v11, s[32:35], s45 offen offset:0 sc1
    buffer_load_dwordx4 v[48:51], v11, s[32:35], s40 offen offset:1024 sc1
    buffer_load_dwordx4 v[52:55], v11, s[32:35], s41 offen offset:1024 sc1
    buffer_load_dwordx4 v[56:59], v11, s[32:35], s44 offen offset:1024 sc1
    buffer_load_dwordx4 v[60:63], v11, s[32:35], s45 offen offset:1024 sc1
    s_waitcnt lgkmcnt(0)
    s_barrier
    s_waitcnt vmcnt(21)
    v_dot2c_f32_bf16 v20, s46, v136
    v_dot2c_f32_bf16 v24, v136, v136
    v_dot2c_f32_bf16 v22, s46, v140
    v_dot2c_f32_bf16 v26, v140, v140
    v_dot2c_f32_bf16 v21, s46, v137
    v_dot2c_f32_bf16 v25, v137, v137
    v_dot2c_f32_bf16 v23, s46, v141
    v_dot2c_f32_bf16 v27, v141, v141
    v_dot2c_f32_bf16 v20, s46, v138
    v_dot2c_f32_bf16 v24, v138, v138
    v_dot2c_f32_bf16 v22, s46, v142
    v_dot2c_f32_bf16 v26, v142, v142
    v_dot2c_f32_bf16 v21, s46, v139
    v_dot2c_f32_bf16 v25, v139, v139
    v_dot2c_f32_bf16 v23, s46, v143
    v_dot2c_f32_bf16 v27, v143, v143
    s_waitcnt vmcnt(19)
    v_dot2c_f32_bf16 v20, s46, v144
    v_dot2c_f32_bf16 v24, v144, v144
    v_dot2c_f32_bf16 v22, s46, v148
    v_dot2c_f32_bf16 v26, v148, v148
    v_dot2c_f32_bf16 v21, s46, v145
    v_dot2c_f32_bf16 v25, v145, v145
    v_dot2c_f32_bf16 v23, s46, v149
    v_dot2c_f32_bf16 v27, v149, v149
    v_dot2c_f32_bf16 v20, s46, v146
    v_dot2c_f32_bf16 v24, v146, v146
    v_dot2c_f32_bf16 v22, s46, v150
    v_dot2c_f32_bf16 v26, v150, v150
    v_dot2c_f32_bf16 v21, s46, v147
    v_dot2c_f32_bf16 v25, v147, v147
    v_dot2c_f32_bf16 v23, s46, v151
    v_dot2c_f32_bf16 v27, v151, v151
    s_waitcnt vmcnt(17)
    v_dot2c_f32_bf16 v20, s46, v152
    v_dot2c_f32_bf16 v24, v152, v152
    v_dot2c_f32_bf16 v22, s46, v156
    v_dot2c_f32_bf16 v26, v156, v156
    v_dot2c_f32_bf16 v21, s46, v153
    v_dot2c_f32_bf16 v25, v153, v153
    v_dot2c_f32_bf16 v23, s46, v157
    v_dot2c_f32_bf16 v27, v157, v157
    v_dot2c_f32_bf16 v20, s46, v154
    v_dot2c_f32_bf16 v24, v154, v154
    v_dot2c_f32_bf16 v22, s46, v158
    v_dot2c_f32_bf16 v26, v158, v158
    v_dot2c_f32_bf16 v21, s46, v155
    v_dot2c_f32_bf16 v25, v155, v155
    v_dot2c_f32_bf16 v23, s46, v159
    v_dot2c_f32_bf16 v27, v159, v159
    s_waitcnt vmcnt(15)
    v_dot2c_f32_bf16 v20, s46, v160
    v_dot2c_f32_bf16 v24, v160, v160
    v_dot2c_f32_bf16 v22, s46, v164
    v_dot2c_f32_bf16 v26, v164, v164
    v_dot2c_f32_bf16 v21, s46, v161
    v_dot2c_f32_bf16 v25, v161, v161
    v_dot2c_f32_bf16 v23, s46, v165
    v_dot2c_f32_bf16 v27, v165, v165
    v_dot2c_f32_bf16 v20, s46, v162
    v_dot2c_f32_bf16 v24, v162, v162
    v_dot2c_f32_bf16 v22, s46, v166
    v_dot2c_f32_bf16 v26, v166, v166
    v_dot2c_f32_bf16 v21, s46, v163
    v_dot2c_f32_bf16 v25, v163, v163
    v_dot2c_f32_bf16 v23, s46, v167
    v_dot2c_f32_bf16 v27, v167, v167
    s_waitcnt vmcnt(13)
    v_dot2c_f32_bf16 v20, s46, v168
    v_dot2c_f32_bf16 v24, v168, v168
    v_dot2c_f32_bf16 v22, s46, v172
    v_dot2c_f32_bf16 v26, v172, v172
    v_dot2c_f32_bf16 v21, s46, v169
    v_dot2c_f32_bf16 v25, v169, v169
    v_dot2c_f32_bf16 v23, s46, v173
    v_dot2c_f32_bf16 v27, v173, v173
    v_dot2c_f32_bf16 v20, s46, v170
    v_dot2c_f32_bf16 v24, v170, v170
    v_dot2c_f32_bf16 v22, s46, v174
    v_dot2c_f32_bf16 v26, v174, v174
    v_dot2c_f32_bf16 v21, s46, v171
    v_dot2c_f32_bf16 v25, v171, v171
    v_dot2c_f32_bf16 v23, s46, v175
    v_dot2c_f32_bf16 v27, v175, v175
    s_waitcnt vmcnt(11)
    v_dot2c_f32_bf16 v20, s46, v176
    v_dot2c_f32_bf16 v24, v176, v176
    v_dot2c_f32_bf16 v22, s46, v180
    v_dot2c_f32_bf16 v26, v180, v180
    v_dot2c_f32_bf16 v21, s46, v177
    v_dot2c_f32_bf16 v25, v177, v177
    v_dot2c_f32_bf16 v23, s46, v181
    v_dot2c_f32_bf16 v27, v181, v181
    v_dot2c_f32_bf16 v20, s46, v178
    v_dot2c_f32_bf16 v24, v178, v178
    v_dot2c_f32_bf16 v22, s46, v182
    v_dot2c_f32_bf16 v26, v182, v182
    v_dot2c_f32_bf16 v21, s46, v179
    v_dot2c_f32_bf16 v25, v179, v179
    v_dot2c_f32_bf16 v23, s46, v183
    v_dot2c_f32_bf16 v27, v183, v183
    s_waitcnt vmcnt(9)
    v_dot2c_f32_bf16 v20, s46, v184
    v_dot2c_f32_bf16 v24, v184, v184
    v_dot2c_f32_bf16 v22, s46, v188
    v_dot2c_f32_bf16 v26, v188, v188
    v_dot2c_f32_bf16 v21, s46, v185
    v_dot2c_f32_bf16 v25, v185, v185
    v_dot2c_f32_bf16 v23, s46, v189
    v_dot2c_f32_bf16 v27, v189, v189
    v_dot2c_f32_bf16 v20, s46, v186
    v_dot2c_f32_bf16 v24, v186, v186
    v_dot2c_f32_bf16 v22, s46, v190
    v_dot2c_f32_bf16 v26, v190, v190
    v_dot2c_f32_bf16 v21, s46, v187
    v_dot2c_f32_bf16 v25, v187, v187
    v_dot2c_f32_bf16 v23, s46, v191
    v_dot2c_f32_bf16 v27, v191, v191
    s_mul_i32 s3, s49, 12
    s_add_u32 s47, s47, s3
    v_add_f32 v20, v20, v21
    v_add_f32 v22, v22, v23
    v_add_f32 v24, v24, v25
    v_add_f32 v26, v26, v27
    v_add_f32_dpp v20, v20, v20 quad_perm:[1,0,3,2] row_mask:0xf bank_mask:0xf
    v_add_f32_dpp v22, v22, v22 quad_perm:[1,0,3,2] row_mask:0xf bank_mask:0xf
    v_add_f32_dpp v24, v24, v24 quad_perm:[1,0,3,2] row_mask:0xf bank_mask:0xf
    v_add_f32_dpp v26, v26, v26 quad_perm:[1,0,3,2] row_mask:0xf bank_mask:0xf
    v_add_f32_dpp v20, v20, v20 quad_perm:[2,3,0,1] row_mask:0xf bank_mask:0xf
    v_add_f32_dpp v22, v22, v22 quad_perm:[2,3,0,1] row_mask:0xf bank_mask:0xf
    v_add_f32_dpp v24, v24, v24 quad_perm:[2,3,0,1] row_mask:0xf bank_mask:0xf
    v_add_f32_dpp v26, v26, v26 quad_perm:[2,3,0,1] row_mask:0xf bank_mask:0xf
    v_add_f32_dpp v20, v20, v20 row_half_mirror row_mask:0xf bank_mask:0xf
    v_add_f32_dpp v22, v22, v22 row_half_mirror row_mask:0xf bank_mask:0xf
    v_add_f32_dpp v24, v24, v24 row_half_mirror row_mask:0xf bank_mask:0xf
    v_add_f32_dpp v26, v26, v26 row_half_mirror row_mask:0xf bank_mask:0xf
    v_mul_f32 v21, 0xba800000, v20
    v_mul_f32 v25, 0x3a800000, v24
    v_mul_f32 v23, 0xba800000, v22
    v_mul_f32 v27, 0x3a800000, v26
    v_fma_f32 v25, -v21, v21, v25
    v_max_f32 v25, 0, v25
    v_add_f32 v25, 0x3727c5ac, v25
    v_fma_f32 v27, -v23, v23, v27
    v_max_f32 v27, 0, v27
    v_add_f32 v27, 0x3727c5ac, v27
    v_rsq_f32 v12, v25
    v_rsq_f32 v14, v27
    v_mul_f32 v13, v21, v12
    v_mul_f32 v15, v23, v14
    s_mov_b32 s59, 0x100000
    s_waitcnt vmcnt(0)
.Lk3_sw_18:
    v_xor_b32 v17, v35, v10
    v_bitop3_b32 v17, v17, v39, v10 bitop3:0xf6
    v_bitop3_b32 v17, v17, v43, v10 bitop3:0xf6
    v_bitop3_b32 v17, v17, v47, v10 bitop3:0xf6
    v_bitop3_b32 v17, v17, v51, v10 bitop3:0xf6
    v_bitop3_b32 v17, v17, v55, v10 bitop3:0xf6
    v_bitop3_b32 v17, v17, v59, v10 bitop3:0xf6
    v_bitop3_b32 v17, v17, v63, v10 bitop3:0xf6
    v_cmp_ne_u32 vcc, 0, v17
    s_cbranch_vccz .Lk3_swo_19
    v_cmp_ne_u32 vcc, v35, v10
    s_nop 0
    s_mov_b64 exec, vcc
    buffer_load_dwordx4 v[32:35], v11, s[32:35], s40 offen offset:0 sc1
    s_mov_b64 exec, -1
    v_cmp_ne_u32 vcc, v39, v10
    s_nop 0
    s_mov_b64 exec, vcc
    buffer_load_dwordx4 v[36:39], v11, s[32:35], s41 offen offset:0 sc1
    s_mov_b64 exec, -1
    v_cmp_ne_u32 vcc, v43, v10
    s_nop 0
    s_mov_b64 exec, vcc
    buffer_load_dwordx4 v[40:43], v11, s[32:35], s44 offen offset:0 sc1
    s_mov_b64 exec, -1
    v_cmp_ne_u32 vcc, v47, v10
    s_nop 0
    s_mov_b64 exec, vcc
    buffer_load_dwordx4 v[44:47], v11, s[32:35], s45 offen offset:0 sc1
    s_mov_b64 exec, -1
    v_cmp_ne_u32 vcc, v51, v10
    s_nop 0
    s_mov_b64 exec, vcc
    buffer_load_dwordx4 v[48:51], v11, s[32:35], s40 offen offset:1024 sc1
    s_mov_b64 exec, -1
    v_cmp_ne_u32 vcc, v55, v10
    s_nop 0
    s_mov_b64 exec, vcc
    buffer_load_dwordx4 v[52:55], v11, s[32:35], s41 offen offset:1024 sc1
    s_mov_b64 exec, -1
    v_cmp_ne_u32 vcc, v59, v10
    s_nop 0
    s_mov_b64 exec, vcc
    buffer_load_dwordx4 v[56:59], v11, s[32:35], s44 offen offset:1024 sc1
    s_mov_b64 exec, -1
    v_cmp_ne_u32 vcc, v63, v10
    s_nop 0
    s_mov_b64 exec, vcc
    buffer_load_dwordx4 v[60:63], v11, s[32:35], s45 offen offset:1024 sc1
    s_mov_b64 exec, -1
    s_waitcnt vmcnt(0)
    s_sub_u32 s59, s59, 1
    s_cbranch_scc0 .Lk3_sw_18
.Lk3_swo_19:
    v_perm_b32 v35, v32, v33, s60
    v_perm_b32 v35, v35, v34, s50
    v_perm_b32 v39, v36, v37, s60
    v_perm_b32 v39, v39, v38, s50
    v_perm_b32 v43, v40, v41, s60
    v_perm_b32 v43, v43, v42, s50
    v_perm_b32 v47, v44, v45, s60
    v_perm_b32 v47, v47, v46, s50
    v_pk_add_f32 v[32:33], v[32:33], v[36:37]
    v_pk_add_f32 v[34:35], v[34:35], v[38:39]
    v_pk_add_f32 v[40:41], v[40:41], v[44:45]
    v_pk_add_f32 v[42:43], v[42:43], v[46:47]
    v_pk_add_f32 v[32:33], v[32:33], v[40:41]
    v_pk_add_f32 v[34:35], v[34:35], v[42:43]
    v_perm_b32 v51, v48, v49, s60
    v_perm_b32 v51, v51, v50, s50
    v_perm_b32 v55, v52, v53, s60
    v_perm_b32 v55, v55, v54, s50
    v_perm_b32 v59, v56, v57, s60
    v_perm_b32 v59, v59, v58, s50
    v_perm_b32 v63, v60, v61, s60
    v_perm_b32 v63, v63, v62, s50
    v_pk_add_f32 v[48:49], v[48:49], v[52:53]
    v_pk_add_f32 v[50:51], v[50:51], v[54:55]
    v_pk_add_f32 v[56:57], v[56:57], v[60:61]
    v_pk_add_f32 v[58:59], v[58:59], v[62:63]
    v_pk_add_f32 v[48:49], v[48:49], v[56:57]
    v_pk_add_f32 v[50:51], v[50:51], v[58:59]
    v_cvt_pk_bf16_f32 v36, v32, v33
    v_lshlrev_b32 v32, 16, v36
    v_and_b32 v33, s96, v36
    v_cvt_pk_bf16_f32 v38, v34, v35
    v_lshlrev_b32 v34, 16, v38
    v_and_b32 v35, s96, v38
    v_cvt_pk_bf16_f32 v52, v48, v49
    v_lshlrev_b32 v48, 16, v52
    v_and_b32 v49, s96, v52
    v_cvt_pk_bf16_f32 v54, v50, v51
    v_lshlrev_b32 v50, 16, v54
    v_and_b32 v51, s96, v54
    s_cmp_lt_u32 s42, 2
    s_cbranch_scc1 .Lk3_ng_20
    v_pk_add_f32 v[32:33], v[32:33], 1.0 op_sel_hi:[1,0]
    v_pk_add_f32 v[34:35], v[34:35], 1.0 op_sel_hi:[1,0]
    v_pk_add_f32 v[48:49], v[48:49], 1.0 op_sel_hi:[1,0]
    v_pk_add_f32 v[50:51], v[50:51], 1.0 op_sel_hi:[1,0]
    v_cvt_pk_bf16_f32 v36, v32, v33
    v_lshlrev_b32 v32, 16, v36
    v_and_b32 v33, s96, v36
    v_cvt_pk_bf16_f32 v38, v34, v35
    v_lshlrev_b32 v34, 16, v38
    v_and_b32 v35, s96, v38
    v_cvt_pk_bf16_f32 v52, v48, v49
    v_lshlrev_b32 v48, 16, v52
    v_and_b32 v49, s96, v52
    v_cvt_pk_bf16_f32 v54, v50, v51
    v_lshlrev_b32 v50, 16, v54
    v_and_b32 v51, s96, v54
.Lk3_ng_20:
    ds_write_b128 v16, v[32:35]
    ds_write_b128 v19, v[48:51]
    v_mov_b32 v17, -1
    ds_write_b32 v18, v17
    v_mov_b32 v18, 16384
    v_lshlrev_b32 v192, 16, v64
    v_and_b32 v193, s96, v64
    v_lshlrev_b32 v194, 16, v65
    v_and_b32 v195, s96, v65
    v_lshlrev_b32 v196, 16, v66
    v_and_b32 v197, s96, v66
    v_lshlrev_b32 v198, 16, v67
    v_and_b32 v199, s96, v67
    v_lshlrev_b32 v200, 16, v68
    v_and_b32 v201, s96, v68
    v_lshlrev_b32 v202, 16, v69
    v_and_b32 v203, s96, v69
    v_lshlrev_b32 v204, 16, v70
    v_and_b32 v205, s96, v70
    v_lshlrev_b32 v206, 16, v71
    v_and_b32 v207, s96, v71
    v_pk_fma_f32 v[192:193], v[192:193], v[12:13], v[12:13] op_sel:[0,0,1] op_sel_hi:[1,0,1]
    v_pk_fma_f32 v[194:195], v[194:195], v[12:13], v[12:13] op_sel:[0,0,1] op_sel_hi:[1,0,1]
    v_pk_fma_f32 v[196:197], v[196:197], v[12:13], v[12:13] op_sel:[0,0,1] op_sel_hi:[1,0,1]
    v_pk_fma_f32 v[198:199], v[198:199], v[12:13], v[12:13] op_sel:[0,0,1] op_sel_hi:[1,0,1]
    v_pk_fma_f32 v[200:201], v[200:201], v[14:15], v[14:15] op_sel:[0,0,1] op_sel_hi:[1,0,1]
    v_pk_fma_f32 v[202:203], v[202:203], v[14:15], v[14:15] op_sel:[0,0,1] op_sel_hi:[1,0,1]
    v_pk_fma_f32 v[204:205], v[204:205], v[14:15], v[14:15] op_sel:[0,0,1] op_sel_hi:[1,0,1]
    v_pk_fma_f32 v[206:207], v[206:207], v[14:15], v[14:15] op_sel:[0,0,1] op_sel_hi:[1,0,1]
    s_mov_b32 s59, 0x100000
.Lk3_fw_21:
    ds_read_b128 v[20:23], v18
    ds_read_b128 v[32:35], v3 offset:4096
    ds_read_b128 v[36:39], v3 offset:4112
    ds_read_b128 v[40:43], v3 offset:0
    ds_read_b128 v[44:47], v3 offset:16
    ds_read_b128 v[48:51], v3 offset:4352
    ds_read_b128 v[52:55], v3 offset:4368
    ds_read_b128 v[56:59], v3 offset:256
    ds_read_b128 v[60:63], v3 offset:272
    s_waitcnt lgkmcnt(8)
    v_and_b32 v20, v20, v21
    v_and_b32 v22, v22, v23
    v_and_b32 v20, v20, v22
    v_cmp_ne_u32 vcc, -1, v20
    s_cbranch_vccz .Lk3_fo_22
    s_waitcnt lgkmcnt(0)
    s_sub_u32 s59, s59, 1
    s_cbranch_scc0 .Lk3_fw_21
.Lk3_fo_22:
    s_waitcnt lgkmcnt(4)
    v_pk_fma_f32 v[192:193], v[192:193], v[32:33], v[40:41]
    v_pk_fma_f32 v[194:195], v[194:195], v[34:35], v[42:43]
    v_pk_fma_f32 v[196:197], v[196:197], v[36:37], v[44:45]
    v_pk_fma_f32 v[198:199], v[198:199], v[38:39], v[46:47]
    v_pk_fma_f32 v[200:201], v[200:201], v[32:33], v[40:41]
    v_pk_fma_f32 v[202:203], v[202:203], v[34:35], v[42:43]
    v_pk_fma_f32 v[204:205], v[204:205], v[36:37], v[44:45]
    v_pk_fma_f32 v[206:207], v[206:207], v[38:39], v[46:47]
    v_cvt_pk_bf16_f32 v64, v192, v193
    v_cvt_pk_bf16_f32 v65, v194, v195
    ds_read_b128 v[32:35], v3 offset:4608
    v_cvt_pk_bf16_f32 v66, v196, v197
    v_cvt_pk_bf16_f32 v67, v198, v199
    ds_read_b128 v[36:39], v3 offset:4624
    v_cvt_pk_bf16_f32 v68, v200, v201
    v_cvt_pk_bf16_f32 v69, v202, v203
    ds_read_b128 v[40:43], v3 offset:512
    v_cvt_pk_bf16_f32 v70, v204, v205
    v_cvt_pk_bf16_f32 v71, v206, v207
    ds_read_b128 v[44:47], v3 offset:528
    v_lshlrev_b32 v192, 16, v72
    v_and_b32 v193, s96, v72
    v_lshlrev_b32 v194, 16, v73
    v_and_b32 v195, s96, v73
    v_lshlrev_b32 v196, 16, v74
    ds_write_addtid_b32 v64 offset:0
    ds_write_addtid_b32 v65 offset:256
    ds_write_addtid_b32 v66 offset:512
    ds_write_addtid_b32 v67 offset:768
    v_and_b32 v197, s96, v74
    v_lshlrev_b32 v198, 16, v75
    v_and_b32 v199, s96, v75
    v_lshlrev_b32 v200, 16, v76
    v_and_b32 v201, s96, v76
    v_lshlrev_b32 v202, 16, v77
    v_and_b32 v203, s96, v77
    ds_write_addtid_b32 v68 offset:1024
    ds_write_addtid_b32 v69 offset:1280
    ds_write_addtid_b32 v70 offset:1536
    ds_write_addtid_b32 v71 offset:1792
    v_lshlrev_b32 v204, 16, v78
    v_and_b32 v205, s96, v78
    v_lshlrev_b32 v206, 16, v79
    v_and_b32 v207, s96, v79
    v_pk_fma_f32 v[192:193], v[192:193], v[12:13], v[12:13] op_sel:[0,0,1] op_sel_hi:[1,0,1]
    v_pk_fma_f32 v[194:195], v[194:195], v[12:13], v[12:13] op_sel:[0,0,1] op_sel_hi:[1,0,1]
    v_pk_fma_f32 v[196:197], v[196:197], v[12:13], v[12:13] op_sel:[0,0,1] op_sel_hi:[1,0,1]
    v_pk_fma_f32 v[198:199], v[198:199], v[12:13], v[12:13] op_sel:[0,0,1] op_sel_hi:[1,0,1]
    v_pk_fma_f32 v[200:201], v[200:201], v[14:15], v[14:15] op_sel:[0,0,1] op_sel_hi:[1,0,1]
    v_pk_fma_f32 v[202:203], v[202:203], v[14:15], v[14:15] op_sel:[0,0,1] op_sel_hi:[1,0,1]
    v_pk_fma_f32 v[204:205], v[204:205], v[14:15], v[14:15] op_sel:[0,0,1] op_sel_hi:[1,0,1]
    v_pk_fma_f32 v[206:207], v[206:207], v[14:15], v[14:15] op_sel:[0,0,1] op_sel_hi:[1,0,1]
    s_waitcnt lgkmcnt(4)
    v_pk_fma_f32 v[192:193], v[192:193], v[48:49], v[56:57]
    v_pk_fma_f32 v[194:195], v[194:195], v[50:51], v[58:59]
    v_pk_fma_f32 v[196:197], v[196:197], v[52:53], v[60:61]
    v_pk_fma_f32 v[198:199], v[198:199], v[54:55], v[62:63]
    v_pk_fma_f32 v[200:201], v[200:201], v[48:49], v[56:57]
    v_pk_fma_f32 v[202:203], v[202:203], v[50:51], v[58:59]
    v_pk_fma_f32 v[204:205], v[204:205], v[52:53], v[60:61]
    v_pk_fma_f32 v[206:207], v[206:207], v[54:55], v[62:63]
    v_cvt_pk_bf16_f32 v72, v192, v193
    v_cvt_pk_bf16_f32 v73, v194, v195
    ds_read_b128 v[48:51], v3 offset:4864
    v_cvt_pk_bf16_f32 v74, v196, v197
    v_cvt_pk_bf16_f32 v75, v198, v199
    ds_read_b128 v[52:55], v3 offset:4880
    v_cvt_pk_bf16_f32 v76, v200, v201
    v_cvt_pk_bf16_f32 v77, v202, v203
    ds_read_b128 v[56:59], v3 offset:768
    v_cvt_pk_bf16_f32 v78, v204, v205
    v_cvt_pk_bf16_f32 v79, v206, v207
    ds_read_b128 v[60:63], v3 offset:784
    v_lshlrev_b32 v192, 16, v80
    v_and_b32 v193, s96, v80
    v_lshlrev_b32 v194, 16, v81
    v_and_b32 v195, s96, v81
    v_lshlrev_b32 v196, 16, v82
    ds_write_addtid_b32 v72 offset:8192
    ds_write_addtid_b32 v73 offset:8448
    ds_write_addtid_b32 v74 offset:8704
    ds_write_addtid_b32 v75 offset:8960
    v_and_b32 v197, s96, v82
    v_lshlrev_b32 v198, 16, v83
    v_and_b32 v199, s96, v83
    v_lshlrev_b32 v200, 16, v84
    v_and_b32 v201, s96, v84
    v_lshlrev_b32 v202, 16, v85
    v_and_b32 v203, s96, v85
    ds_write_addtid_b32 v76 offset:9216
    ds_write_addtid_b32 v77 offset:9472
    ds_write_addtid_b32 v78 offset:9728
    ds_write_addtid_b32 v79 offset:9984
    v_lshlrev_b32 v204, 16, v86
    v_and_b32 v205, s96, v86
    v_lshlrev_b32 v206, 16, v87
    v_and_b32 v207, s96, v87
    v_pk_fma_f32 v[192:193], v[192:193], v[12:13], v[12:13] op_sel:[0,0,1] op_sel_hi:[1,0,1]
    v_pk_fma_f32 v[194:195], v[194:195], v[12:13], v[12:13] op_sel:[0,0,1] op_sel_hi:[1,0,1]
    v_pk_fma_f32 v[196:197], v[196:197], v[12:13], v[12:13] op_sel:[0,0,1] op_sel_hi:[1,0,1]
    v_pk_fma_f32 v[198:199], v[198:199], v[12:13], v[12:13] op_sel:[0,0,1] op_sel_hi:[1,0,1]
    v_pk_fma_f32 v[200:201], v[200:201], v[14:15], v[14:15] op_sel:[0,0,1] op_sel_hi:[1,0,1]
    v_pk_fma_f32 v[202:203], v[202:203], v[14:15], v[14:15] op_sel:[0,0,1] op_sel_hi:[1,0,1]
    v_pk_fma_f32 v[204:205], v[204:205], v[14:15], v[14:15] op_sel:[0,0,1] op_sel_hi:[1,0,1]
    v_pk_fma_f32 v[206:207], v[206:207], v[14:15], v[14:15] op_sel:[0,0,1] op_sel_hi:[1,0,1]
    s_waitcnt lgkmcnt(4)
    v_pk_fma_f32 v[192:193], v[192:193], v[32:33], v[40:41]
    v_pk_fma_f32 v[194:195], v[194:195], v[34:35], v[42:43]
    v_pk_fma_f32 v[196:197], v[196:197], v[36:37], v[44:45]
    v_pk_fma_f32 v[198:199], v[198:199], v[38:39], v[46:47]
    v_pk_fma_f32 v[200:201], v[200:201], v[32:33], v[40:41]
    v_pk_fma_f32 v[202:203], v[202:203], v[34:35], v[42:43]
    v_pk_fma_f32 v[204:205], v[204:205], v[36:37], v[44:45]
    v_pk_fma_f32 v[206:207], v[206:207], v[38:39], v[46:47]
    v_cvt_pk_bf16_f32 v80, v192, v193
    v_cvt_pk_bf16_f32 v81, v194, v195
    ds_read_b128 v[32:35], v3 offset:5120
    v_cvt_pk_bf16_f32 v82, v196, v197
    v_cvt_pk_bf16_f32 v83, v198, v199
    ds_read_b128 v[36:39], v3 offset:5136
    v_cvt_pk_bf16_f32 v84, v200, v201
    v_cvt_pk_bf16_f32 v85, v202, v203
    ds_read_b128 v[40:43], v3 offset:1024
    v_cvt_pk_bf16_f32 v86, v204, v205
    v_cvt_pk_bf16_f32 v87, v206, v207
    ds_read_b128 v[44:47], v3 offset:1040
    v_lshlrev_b32 v192, 16, v88
    v_and_b32 v193, s96, v88
    v_lshlrev_b32 v194, 16, v89
    v_and_b32 v195, s96, v89
    v_lshlrev_b32 v196, 16, v90
    v_and_b32 v197, s96, v90
    v_lshlrev_b32 v198, 16, v91
    v_and_b32 v199, s96, v91
    v_lshlrev_b32 v200, 16, v92
    v_and_b32 v201, s96, v92
    v_lshlrev_b32 v202, 16, v93
    v_and_b32 v203, s96, v93
    v_lshlrev_b32 v204, 16, v94
    v_and_b32 v205, s96, v94
    v_lshlrev_b32 v206, 16, v95
    v_and_b32 v207, s96, v95
    v_pk_fma_f32 v[192:193], v[192:193], v[12:13], v[12:13] op_sel:[0,0,1] op_sel_hi:[1,0,1]
    v_pk_fma_f32 v[194:195], v[194:195], v[12:13], v[12:13] op_sel:[0,0,1] op_sel_hi:[1,0,1]
    v_pk_fma_f32 v[196:197], v[196:197], v[12:13], v[12:13] op_sel:[0,0,1] op_sel_hi:[1,0,1]
    v_pk_fma_f32 v[198:199], v[198:199], v[12:13], v[12:13] op_sel:[0,0,1] op_sel_hi:[1,0,1]
    v_pk_fma_f32 v[200:201], v[200:201], v[14:15], v[14:15] op_sel:[0,0,1] op_sel_hi:[1,0,1]
    v_pk_fma_f32 v[202:203], v[202:203], v[14:15], v[14:15] op_sel:[0,0,1] op_sel_hi:[1,0,1]
    v_pk_fma_f32 v[204:205], v[204:205], v[14:15], v[14:15] op_sel:[0,0,1] op_sel_hi:[1,0,1]
    v_pk_fma_f32 v[206:207], v[206:207], v[14:15], v[14:15] op_sel:[0,0,1] op_sel_hi:[1,0,1]
    s_waitcnt lgkmcnt(4)
    v_pk_fma_f32 v[192:193], v[192:193], v[48:49], v[56:57]
    v_pk_fma_f32 v[194:195], v[194:195], v[50:51], v[58:59]
    v_pk_fma_f32 v[196:197], v[196:197], v[52:53], v[60:61]
    v_pk_fma_f32 v[198:199], v[198:199], v[54:55], v[62:63]
    v_pk_fma_f32 v[200:201], v[200:201], v[48:49], v[56:57]
    v_pk_fma_f32 v[202:203], v[202:203], v[50:51], v[58:59]
    v_pk_fma_f32 v[204:205], v[204:205], v[52:53], v[60:61]
    v_pk_fma_f32 v[206:207], v[206:207], v[54:55], v[62:63]
    v_cvt_pk_bf16_f32 v88, v192, v193
    v_cvt_pk_bf16_f32 v89, v194, v195
    ds_read_b128 v[48:51], v3 offset:5376
    v_cvt_pk_bf16_f32 v90, v196, v197
    v_cvt_pk_bf16_f32 v91, v198, v199
    ds_read_b128 v[52:55], v3 offset:5392
    v_cvt_pk_bf16_f32 v92, v200, v201
    v_cvt_pk_bf16_f32 v93, v202, v203
    ds_read_b128 v[56:59], v3 offset:1280
    v_cvt_pk_bf16_f32 v94, v204, v205
    v_cvt_pk_bf16_f32 v95, v206, v207
    ds_read_b128 v[60:63], v3 offset:1296
    s_barrier
    v_lshlrev_b32 v192, 16, v96
    v_and_b32 v193, s96, v96
    s_mov_b32 exec_hi, 0
    ds_write_b128 v9, v[64:67] offset:0
    s_mov_b32 exec_hi, -1
    v_lshlrev_b32 v194, 16, v97
    v_and_b32 v195, s96, v97
    v_lshlrev_b32 v196, 16, v98
    v_and_b32 v197, s96, v98
    v_lshlrev_b32 v198, 16, v99
    v_and_b32 v199, s96, v99
    v_lshlrev_b32 v200, 16, v100
    s_mov_b32 exec_hi, 0
    ds_write_b128 v9, v[72:75] offset:2048
    s_mov_b32 exec_hi, -1
    v_and_b32 v201, s96, v100
    v_lshlrev_b32 v202, 16, v101
    v_and_b32 v203, s96, v101
    v_lshlrev_b32 v204, 16, v102
    v_and_b32 v205, s96, v102
    v_lshlrev_b32 v206, 16, v103
    v_and_b32 v207, s96, v103
    s_mov_b32 exec_hi, 0
    ds_write_b128 v9, v[80:83] offset:4096
    s_mov_b32 exec_hi, -1
    v_pk_fma_f32 v[192:193], v[192:193], v[12:13], v[12:13] op_sel:[0,0,1] op_sel_hi:[1,0,1]
    v_pk_fma_f32 v[194:195], v[194:195], v[12:13], v[12:13] op_sel:[0,0,1] op_sel_hi:[1,0,1]
    v_pk_fma_f32 v[196:197], v[196:197], v[12:13], v[12:13] op_sel:[0,0,1] op_sel_hi:[1,0,1]
    v_pk_fma_f32 v[198:199], v[198:199], v[12:13], v[12:13] op_sel:[0,0,1] op_sel_hi:[1,0,1]
    v_pk_fma_f32 v[200:201], v[200:201], v[14:15], v[14:15] op_sel:[0,0,1] op_sel_hi:[1,0,1]
    v_pk_fma_f32 v[202:203], v[202:203], v[14:15], v[14:15] op_sel:[0,0,1] op_sel_hi:[1,0,1]
    v_pk_fma_f32 v[204:205], v[204:205], v[14:15], v[14:15] op_sel:[0,0,1] op_sel_hi:[1,0,1]
    v_pk_fma_f32 v[206:207], v[206:207], v[14:15], v[14:15] op_sel:[0,0,1] op_sel_hi:[1,0,1]
    s_waitcnt lgkmcnt(4)
    v_pk_fma_f32 v[192:193], v[192:193], v[32:33], v[40:41]
    v_pk_fma_f32 v[194:195], v[194:195], v[34:35], v[42:43]
    v_pk_fma_f32 v[196:197], v[196:197], v[36:37], v[44:45]
    ds_write_addtid_b32 v80 offset:16384
    ds_write_addtid_b32 v81 offset:16640
    ds_write_addtid_b32 v82 offset:16896
    ds_write_addtid_b32 v83 offset:17152
    v_pk_fma_f32 v[198:199], v[198:199], v[38:39], v[46:47]
    v_pk_fma_f32 v[200:201], v[200:201], v[32:33], v[40:41]
    v_pk_fma_f32 v[202:203], v[202:203], v[34:35], v[42:43]
    v_pk_fma_f32 v[204:205], v[204:205], v[36:37], v[44:45]
    v_pk_fma_f32 v[206:207], v[206:207], v[38:39], v[46:47]
    v_cvt_pk_bf16_f32 v96, v192, v193
    v_cvt_pk_bf16_f32 v97, v194, v195
    ds_read_b128 v[32:35], v3 offset:5632
    v_cvt_pk_bf16_f32 v98, v196, v197
    v_cvt_pk_bf16_f32 v99, v198, v199
    ds_read_b128 v[36:39], v3 offset:5648
    v_cvt_pk_bf16_f32 v100, v200, v201
    v_cvt_pk_bf16_f32 v101, v202, v203
    ds_read_b128 v[40:43], v3 offset:1536
    v_cvt_pk_bf16_f32 v102, v204, v205
    v_cvt_pk_bf16_f32 v103, v206, v207
    ds_read_b128 v[44:47], v3 offset:1552
    v_lshlrev_b32 v192, 16, v104
    v_and_b32 v193, s96, v104
    ds_write_addtid_b32 v84 offset:17408
    ds_write_addtid_b32 v85 offset:17664
    ds_write_addtid_b32 v86 offset:17920
    ds_write_addtid_b32 v87 offset:18176
    v_lshlrev_b32 v194, 16, v105
    v_and_b32 v195, s96, v105
    v_lshlrev_b32 v196, 16, v106
    v_and_b32 v197, s96, v106
    v_lshlrev_b32 v198, 16, v107
    v_and_b32 v199, s96, v107
    v_lshlrev_b32 v200, 16, v108
    s_mov_b32 exec_hi, 0
    ds_write_b128 v9, v[88:91] offset:6144
    s_mov_b32 exec_hi, -1
    v_and_b32 v201, s96, v108
    v_lshlrev_b32 v202, 16, v109
    v_and_b32 v203, s96, v109
    v_lshlrev_b32 v204, 16, v110
    v_and_b32 v205, s96, v110
    v_lshlrev_b32 v206, 16, v111
    v_and_b32 v207, s96, v111
    s_mov_b32 exec_hi, 0
    ds_write_b128 v9, v[96:99] offset:8192
    s_mov_b32 exec_hi, -1
    v_pk_fma_f32 v[192:193], v[192:193], v[12:13], v[12:13] op_sel:[0,0,1] op_sel_hi:[1,0,1]
    v_pk_fma_f32 v[194:195], v[194:195], v[12:13], v[12:13] op_sel:[0,0,1] op_sel_hi:[1,0,1]
    v_pk_fma_f32 v[196:197], v[196:197], v[12:13], v[12:13] op_sel:[0,0,1] op_sel_hi:[1,0,1]
    v_pk_fma_f32 v[198:199], v[198:199], v[12:13], v[12:13] op_sel:[0,0,1] op_sel_hi:[1,0,1]
    v_pk_fma_f32 v[200:201], v[200:201], v[14:15], v[14:15] op_sel:[0,0,1] op_sel_hi:[1,0,1]
    v_pk_fma_f32 v[202:203], v[202:203], v[14:15], v[14:15] op_sel:[0,0,1] op_sel_hi:[1,0,1]
    v_pk_fma_f32 v[204:205], v[204:205], v[14:15], v[14:15] op_sel:[0,0,1] op_sel_hi:[1,0,1]
    v_pk_fma_f32 v[206:207], v[206:207], v[14:15], v[14:15] op_sel:[0,0,1] op_sel_hi:[1,0,1]
    s_waitcnt lgkmcnt(4)
    v_pk_fma_f32 v[192:193], v[192:193], v[48:49], v[56:57]
    v_pk_fma_f32 v[194:195], v[194:195], v[50:51], v[58:59]
    v_pk_fma_f32 v[196:197], v[196:197], v[52:53], v[60:61]
    v_pk_fma_f32 v[198:199], v[198:199], v[54:55], v[62:63]
    v_pk_fma_f32 v[200:201], v[200:201], v[48:49], v[56:57]
    v_pk_fma_f32 v[202:203], v[202:203], v[50:51], v[58:59]
    v_pk_fma_f32 v[204:205], v[204:205], v[52:53], v[60:61]
    v_pk_fma_f32 v[206:207], v[206:207], v[54:55], v[62:63]
    v_cvt_pk_bf16_f32 v104, v192, v193
    v_cvt_pk_bf16_f32 v105, v194, v195
    ds_read_b128 v[48:51], v3 offset:5888
    v_cvt_pk_bf16_f32 v106, v196, v197
    v_cvt_pk_bf16_f32 v107, v198, v199
    ds_read_b128 v[52:55], v3 offset:5904
    v_cvt_pk_bf16_f32 v108, v200, v201
    v_cvt_pk_bf16_f32 v109, v202, v203
    ds_read_b128 v[56:59], v3 offset:1792
    v_cvt_pk_bf16_f32 v110, v204, v205
    v_cvt_pk_bf16_f32 v111, v206, v207
    ds_read_b128 v[60:63], v3 offset:1808
    v_lshlrev_b32 v192, 16, v112
    v_and_b32 v193, s96, v112
    v_lshlrev_b32 v194, 16, v113
    v_and_b32 v195, s96, v113
    v_lshlrev_b32 v196, 16, v114
    s_mov_b32 exec_hi, 0
    ds_write_b128 v9, v[104:107] offset:10240
    s_mov_b32 exec_hi, -1
    v_and_b32 v197, s96, v114
    v_lshlrev_b32 v198, 16, v115
    v_and_b32 v199, s96, v115
    v_lshlrev_b32 v200, 16, v116
    v_and_b32 v201, s96, v116
    v_lshlrev_b32 v202, 16, v117
    v_and_b32 v203, s96, v117
    v_lshlrev_b32 v204, 16, v118
    v_and_b32 v205, s96, v118
    v_lshlrev_b32 v206, 16, v119
    v_and_b32 v207, s96, v119
    v_pk_fma_f32 v[192:193], v[192:193], v[12:13], v[12:13] op_sel:[0,0,1] op_sel_hi:[1,0,1]
    v_pk_fma_f32 v[194:195], v[194:195], v[12:13], v[12:13] op_sel:[0,0,1] op_sel_hi:[1,0,1]
    v_pk_fma_f32 v[196:197], v[196:197], v[12:13], v[12:13] op_sel:[0,0,1] op_sel_hi:[1,0,1]
    v_pk_fma_f32 v[198:199], v[198:199], v[12:13], v[12:13] op_sel:[0,0,1] op_sel_hi:[1,0,1]
    v_pk_fma_f32 v[200:201], v[200:201], v[14:15], v[14:15] op_sel:[0,0,1] op_sel_hi:[1,0,1]
    v_pk_fma_f32 v[202:203], v[202:203], v[14:15], v[14:15] op_sel:[0,0,1] op_sel_hi:[1,0,1]
    v_pk_fma_f32 v[204:205], v[204:205], v[14:15], v[14:15] op_sel:[0,0,1] op_sel_hi:[1,0,1]
    v_pk_fma_f32 v[206:207], v[206:207], v[14:15], v[14:15] op_sel:[0,0,1] op_sel_hi:[1,0,1]
    s_waitcnt lgkmcnt(4)
    v_pk_fma_f32 v[192:193], v[192:193], v[32:33], v[40:41]
    v_pk_fma_f32 v[194:195], v[194:195], v[34:35], v[42:43]
    v_pk_fma_f32 v[196:197], v[196:197], v[36:37], v[44:45]
    v_pk_fma_f32 v[198:199], v[198:199], v[38:39], v[46:47]
    v_pk_fma_f32 v[200:201], v[200:201], v[32:33], v[40:41]
    v_pk_fma_f32 v[202:203], v[202:203], v[34:35], v[42:43]
    v_pk_fma_f32 v[204:205], v[204:205], v[36:37], v[44:45]
    v_pk_fma_f32 v[206:207], v[206:207], v[38:39], v[46:47]
    v_cvt_pk_bf16_f32 v112, v192, v193
    v_cvt_pk_bf16_f32 v113, v194, v195
    ds_read_b128 v[32:35], v3 offset:6144
    v_cvt_pk_bf16_f32 v114, v196, v197
    v_cvt_pk_bf16_f32 v115, v198, v199
    ds_read_b128 v[36:39], v3 offset:6160
    v_cvt_pk_bf16_f32 v116, v200, v201
    v_cvt_pk_bf16_f32 v117, v202, v203
    ds_read_b128 v[40:43], v3 offset:2048
    v_cvt_pk_bf16_f32 v118, v204, v205
    v_cvt_pk_bf16_f32 v119, v206, v207
    ds_read_b128 v[44:47], v3 offset:2064
    s_barrier
    v_lshlrev_b32 v192, 16, v120
    v_and_b32 v193, s96, v120
    v_lshlrev_b32 v194, 16, v121
    v_and_b32 v195, s96, v121
    v_lshlrev_b32 v196, 16, v122
    s_mov_b32 exec_hi, 0
    ds_write_b128 v9, v[112:115] offset:12288
    s_mov_b32 exec_hi, -1
    v_and_b32 v197, s96, v122
    v_lshlrev_b32 v198, 16, v123
    v_and_b32 v199, s96, v123
    v_lshlrev_b32 v200, 16, v124
    v_and_b32 v201, s96, v124
    v_lshlrev_b32 v202, 16, v125
    v_and_b32 v203, s96, v125
    v_lshlrev_b32 v204, 16, v126
    v_and_b32 v205, s96, v126
    v_lshlrev_b32 v206, 16, v127
    v_and_b32 v207, s96, v127
    v_pk_fma_f32 v[192:193], v[192:193], v[12:13], v[12:13] op_sel:[0,0,1] op_sel_hi:[1,0,1]
    v_pk_fma_f32 v[194:195], v[194:195], v[12:13], v[12:13] op_sel:[0,0,1] op_sel_hi:[1,0,1]
    v_pk_fma_f32 v[196:197], v[196:197], v[12:13], v[12:13] op_sel:[0,0,1] op_sel_hi:[1,0,1]
    v_pk_fma_f32 v[198:199], v[198:199], v[12:13], v[12:13] op_sel:[0,0,1] op_sel_hi:[1,0,1]
    v_pk_fma_f32 v[200:201], v[200:201], v[14:15], v[14:15] op_sel:[0,0,1] op_sel_hi:[1,0,1]
    v_pk_fma_f32 v[202:203], v[202:203], v[14:15], v[14:15] op_sel:[0,0,1] op_sel_hi:[1,0,1]
    v_pk_fma_f32 v[204:205], v[204:205], v[14:15], v[14:15] op_sel:[0,0,1] op_sel_hi:[1,0,1]
    v_pk_fma_f32 v[206:207], v[206:207], v[14:15], v[14:15] op_sel:[0,0,1] op_sel_hi:[1,0,1]
    s_waitcnt lgkmcnt(4)
    v_pk_fma_f32 v[192:193], v[192:193], v[48:49], v[56:57]
    v_pk_fma_f32 v[194:195], v[194:195], v[50:51], v[58:59]
    v_pk_fma_f32 v[196:197], v[196:197], v[52:53], v[60:61]
    v_pk_fma_f32 v[198:199], v[198:199], v[54:55], v[62:63]
    v_pk_fma_f32 v[200:201], v[200:201], v[48:49], v[56:57]
    v_pk_fma_f32 v[202:203], v[202:203], v[50:51], v[58:59]
    v_pk_fma_f32 v[204:205], v[204:205], v[52:53], v[60:61]
    v_pk_fma_f32 v[206:207], v[206:207], v[54:55], v[62:63]
    v_cvt_pk_bf16_f32 v120, v192, v193
    v_cvt_pk_bf16_f32 v121, v194, v195
    ds_read_b128 v[48:51], v3 offset:6400
    v_cvt_pk_bf16_f32 v122, v196, v197
    v_cvt_pk_bf16_f32 v123, v198, v199
    ds_read_b128 v[52:55], v3 offset:6416
    v_cvt_pk_bf16_f32 v124, v200, v201
    v_cvt_pk_bf16_f32 v125, v202, v203
    ds_read_b128 v[56:59], v3 offset:2304
    v_cvt_pk_bf16_f32 v126, v204, v205
    v_cvt_pk_bf16_f32 v127, v206, v207
    ds_read_b128 v[60:63], v3 offset:2320
    v_lshlrev_b32 v192, 16, v128
    v_and_b32 v193, s96, v128
    v_lshlrev_b32 v194, 16, v129
    v_and_b32 v195, s96, v129
    v_lshlrev_b32 v196, 16, v130
    s_mov_b32 exec_hi, 0
    ds_write_b128 v9, v[120:123] offset:14336
    s_mov_b32 exec_hi, -1
    v_and_b32 v197, s96, v130
    v_lshlrev_b32 v198, 16, v131
    v_and_b32 v199, s96, v131
    v_lshlrev_b32 v200, 16, v132
    v_and_b32 v201, s96, v132
    v_lshlrev_b32 v202, 16, v133
    v_and_b32 v203, s96, v133
    v_lshlrev_b32 v204, 16, v134
    v_and_b32 v205, s96, v134
    v_lshlrev_b32 v206, 16, v135
    v_and_b32 v207, s96, v135
    v_pk_fma_f32 v[192:193], v[192:193], v[12:13], v[12:13] op_sel:[0,0,1] op_sel_hi:[1,0,1]
    v_pk_fma_f32 v[194:195], v[194:195], v[12:13], v[12:13] op_sel:[0,0,1] op_sel_hi:[1,0,1]
    v_pk_fma_f32 v[196:197], v[196:197], v[12:13], v[12:13] op_sel:[0,0,1] op_sel_hi:[1,0,1]
    v_pk_fma_f32 v[198:199], v[198:199], v[12:13], v[12:13] op_sel:[0,0,1] op_sel_hi:[1,0,1]
    v_pk_fma_f32 v[200:201], v[200:201], v[14:15], v[14:15] op_sel:[0,0,1] op_sel_hi:[1,0,1]
    v_pk_fma_f32 v[202:203], v[202:203], v[14:15], v[14:15] op_sel:[0,0,1] op_sel_hi:[1,0,1]
    v_pk_fma_f32 v[204:205], v[204:205], v[14:15], v[14:15] op_sel:[0,0,1] op_sel_hi:[1,0,1]
    v_pk_fma_f32 v[206:207], v[206:207], v[14:15], v[14:15] op_sel:[0,0,1] op_sel_hi:[1,0,1]
    s_waitcnt lgkmcnt(4)
    v_pk_fma_f32 v[192:193], v[192:193], v[32:33], v[40:41]
    v_pk_fma_f32 v[194:195], v[194:195], v[34:35], v[42:43]
    v_pk_fma_f32 v[196:197], v[196:197], v[36:37], v[44:45]
    v_pk_fma_f32 v[198:199], v[198:199], v[38:39], v[46:47]
    v_pk_fma_f32 v[200:201], v[200:201], v[32:33], v[40:41]
    v_pk_fma_f32 v[202:203], v[202:203], v[34:35], v[42:43]
    v_pk_fma_f32 v[204:205], v[204:205], v[36:37], v[44:45]
    v_pk_fma_f32 v[206:207], v[206:207], v[38:39], v[46:47]
    v_cvt_pk_bf16_f32 v128, v192, v193
    v_cvt_pk_bf16_f32 v129, v194, v195
    ds_read_b128 v[32:35], v3 offset:6656
    v_cvt_pk_bf16_f32 v130, v196, v197
    v_cvt_pk_bf16_f32 v131, v198, v199
    ds_read_b128 v[36:39], v3 offset:6672
    v_cvt_pk_bf16_f32 v132, v200, v201
    v_cvt_pk_bf16_f32 v133, v202, v203
    ds_read_b128 v[40:43], v3 offset:2560
    v_cvt_pk_bf16_f32 v134, v204, v205
    v_cvt_pk_bf16_f32 v135, v206, v207
    ds_read_b128 v[44:47], v3 offset:2576
    v_lshlrev_b32 v192, 16, v136
    v_and_b32 v193, s96, v136
    v_lshlrev_b32 v194, 16, v137
    v_and_b32 v195, s96, v137
    v_lshlrev_b32 v196, 16, v138
    s_mov_b32 exec_hi, 0
    ds_write_b128 v9, v[128:131] offset:16384
    s_mov_b32 exec_hi, -1
    v_and_b32 v197, s96, v138
    v_lshlrev_b32 v198, 16, v139
    v_and_b32 v199, s96, v139
    v_lshlrev_b32 v200, 16, v140
    v_and_b32 v201, s96, v140
    v_lshlrev_b32 v202, 16, v141
    v_and_b32 v203, s96, v141
    v_lshlrev_b32 v204, 16, v142
    v_and_b32 v205, s96, v142
    v_lshlrev_b32 v206, 16, v143
    v_and_b32 v207, s96, v143
    v_pk_fma_f32 v[192:193], v[192:193], v[12:13], v[12:13] op_sel:[0,0,1] op_sel_hi:[1,0,1]
    v_pk_fma_f32 v[194:195], v[194:195], v[12:13], v[12:13] op_sel:[0,0,1] op_sel_hi:[1,0,1]
    v_pk_fma_f32 v[196:197], v[196:197], v[12:13], v[12:13] op_sel:[0,0,1] op_sel_hi:[1,0,1]
    v_pk_fma_f32 v[198:199], v[198:199], v[12:13], v[12:13] op_sel:[0,0,1] op_sel_hi:[1,0,1]
    v_pk_fma_f32 v[200:201], v[200:201], v[14:15], v[14:15] op_sel:[0,0,1] op_sel_hi:[1,0,1]
    v_pk_fma_f32 v[202:203], v[202:203], v[14:15], v[14:15] op_sel:[0,0,1] op_sel_hi:[1,0,1]
    v_pk_fma_f32 v[204:205], v[204:205], v[14:15], v[14:15] op_sel:[0,0,1] op_sel_hi:[1,0,1]
    v_pk_fma_f32 v[206:207], v[206:207], v[14:15], v[14:15] op_sel:[0,0,1] op_sel_hi:[1,0,1]
    s_waitcnt lgkmcnt(4)
    v_pk_fma_f32 v[192:193], v[192:193], v[48:49], v[56:57]
    v_pk_fma_f32 v[194:195], v[194:195], v[50:51], v[58:59]
    v_pk_fma_f32 v[196:197], v[196:197], v[52:53], v[60:61]
    v_pk_fma_f32 v[198:199], v[198:199], v[54:55], v[62:63]
    v_pk_fma_f32 v[200:201], v[200:201], v[48:49], v[56:57]
    v_pk_fma_f32 v[202:203], v[202:203], v[50:51], v[58:59]
    v_pk_fma_f32 v[204:205], v[204:205], v[52:53], v[60:61]
    v_pk_fma_f32 v[206:207], v[206:207], v[54:55], v[62:63]
    v_cvt_pk_bf16_f32 v136, v192, v193
    v_cvt_pk_bf16_f32 v137, v194, v195
    ds_read_b128 v[48:51], v3 offset:6912
    v_cvt_pk_bf16_f32 v138, v196, v197
    v_cvt_pk_bf16_f32 v139, v198, v199
    ds_read_b128 v[52:55], v3 offset:6928
    v_cvt_pk_bf16_f32 v140, v200, v201
    v_cvt_pk_bf16_f32 v141, v202, v203
    ds_read_b128 v[56:59], v3 offset:2816
    v_cvt_pk_bf16_f32 v142, v204, v205
    v_cvt_pk_bf16_f32 v143, v206, v207
    ds_read_b128 v[60:63], v3 offset:2832
    s_barrier
    v_lshlrev_b32 v192, 16, v144
    v_and_b32 v193, s96, v144
    v_lshlrev_b32 v194, 16, v145
    v_and_b32 v195, s96, v145
    v_lshlrev_b32 v196, 16, v146
    s_mov_b32 exec_hi, 0
    ds_write_b128 v9, v[136:139] offset:18432
    s_mov_b32 exec_hi, -1
    v_and_b32 v197, s96, v146
    v_lshlrev_b32 v198, 16, v147
    v_and_b32 v199, s96, v147
    v_lshlrev_b32 v200, 16, v148
    v_and_b32 v201, s96, v148
    v_lshlrev_b32 v202, 16, v149
    v_and_b32 v203, s96, v149
    v_lshlrev_b32 v204, 16, v150
    v_and_b32 v205, s96, v150
    v_lshlrev_b32 v206, 16, v151
    v_and_b32 v207, s96, v151
    v_pk_fma_f32 v[192:193], v[192:193], v[12:13], v[12:13] op_sel:[0,0,1] op_sel_hi:[1,0,1]
    v_pk_fma_f32 v[194:195], v[194:195], v[12:13], v[12:13] op_sel:[0,0,1] op_sel_hi:[1,0,1]
    v_pk_fma_f32 v[196:197], v[196:197], v[12:13], v[12:13] op_sel:[0,0,1] op_sel_hi:[1,0,1]
    v_pk_fma_f32 v[198:199], v[198:199], v[12:13], v[12:13] op_sel:[0,0,1] op_sel_hi:[1,0,1]
    v_pk_fma_f32 v[200:201], v[200:201], v[14:15], v[14:15] op_sel:[0,0,1] op_sel_hi:[1,0,1]
    v_pk_fma_f32 v[202:203], v[202:203], v[14:15], v[14:15] op_sel:[0,0,1] op_sel_hi:[1,0,1]
    v_pk_fma_f32 v[204:205], v[204:205], v[14:15], v[14:15] op_sel:[0,0,1] op_sel_hi:[1,0,1]
    v_pk_fma_f32 v[206:207], v[206:207], v[14:15], v[14:15] op_sel:[0,0,1] op_sel_hi:[1,0,1]
    s_waitcnt lgkmcnt(4)
    v_pk_fma_f32 v[192:193], v[192:193], v[32:33], v[40:41]
    v_pk_fma_f32 v[194:195], v[194:195], v[34:35], v[42:43]
    v_pk_fma_f32 v[196:197], v[196:197], v[36:37], v[44:45]
    v_pk_fma_f32 v[198:199], v[198:199], v[38:39], v[46:47]
    v_pk_fma_f32 v[200:201], v[200:201], v[32:33], v[40:41]
    v_pk_fma_f32 v[202:203], v[202:203], v[34:35], v[42:43]
    v_pk_fma_f32 v[204:205], v[204:205], v[36:37], v[44:45]
    v_pk_fma_f32 v[206:207], v[206:207], v[38:39], v[46:47]
    v_cvt_pk_bf16_f32 v144, v192, v193
    v_cvt_pk_bf16_f32 v145, v194, v195
    ds_read_b128 v[32:35], v3 offset:7168
    v_cvt_pk_bf16_f32 v146, v196, v197
    v_cvt_pk_bf16_f32 v147, v198, v199
    ds_read_b128 v[36:39], v3 offset:7184
    v_cvt_pk_bf16_f32 v148, v200, v201
    v_cvt_pk_bf16_f32 v149, v202, v203
    ds_read_b128 v[40:43], v3 offset:3072
    v_cvt_pk_bf16_f32 v150, v204, v205
    v_cvt_pk_bf16_f32 v151, v206, v207
    ds_read_b128 v[44:47], v3 offset:3088
    v_lshlrev_b32 v192, 16, v152
    v_and_b32 v193, s96, v152
    v_lshlrev_b32 v194, 16, v153
    v_and_b32 v195, s96, v153
    v_lshlrev_b32 v196, 16, v154
    s_mov_b32 exec_hi, 0
    ds_write_b128 v9, v[144:147] offset:20480
    s_mov_b32 exec_hi, -1
    v_and_b32 v197, s96, v154
    v_lshlrev_b32 v198, 16, v155
    v_and_b32 v199, s96, v155
    v_lshlrev_b32 v200, 16, v156
    v_and_b32 v201, s96, v156
    v_lshlrev_b32 v202, 16, v157
    v_and_b32 v203, s96, v157
    v_lshlrev_b32 v204, 16, v158
    v_and_b32 v205, s96, v158
    v_lshlrev_b32 v206, 16, v159
    v_and_b32 v207, s96, v159
    v_pk_fma_f32 v[192:193], v[192:193], v[12:13], v[12:13] op_sel:[0,0,1] op_sel_hi:[1,0,1]
    v_pk_fma_f32 v[194:195], v[194:195], v[12:13], v[12:13] op_sel:[0,0,1] op_sel_hi:[1,0,1]
    v_pk_fma_f32 v[196:197], v[196:197], v[12:13], v[12:13] op_sel:[0,0,1] op_sel_hi:[1,0,1]
    v_pk_fma_f32 v[198:199], v[198:199], v[12:13], v[12:13] op_sel:[0,0,1] op_sel_hi:[1,0,1]
    v_pk_fma_f32 v[200:201], v[200:201], v[14:15], v[14:15] op_sel:[0,0,1] op_sel_hi:[1,0,1]
    v_pk_fma_f32 v[202:203], v[202:203], v[14:15], v[14:15] op_sel:[0,0,1] op_sel_hi:[1,0,1]
    v_pk_fma_f32 v[204:205], v[204:205], v[14:15], v[14:15] op_sel:[0,0,1] op_sel_hi:[1,0,1]
    v_pk_fma_f32 v[206:207], v[206:207], v[14:15], v[14:15] op_sel:[0,0,1] op_sel_hi:[1,0,1]
    s_waitcnt lgkmcnt(4)
    v_pk_fma_f32 v[192:193], v[192:193], v[48:49], v[56:57]
    v_pk_fma_f32 v[194:195], v[194:195], v[50:51], v[58:59]
    v_pk_fma_f32 v[196:197], v[196:197], v[52:53], v[60:61]
    v_pk_fma_f32 v[198:199], v[198:199], v[54:55], v[62:63]
    v_pk_fma_f32 v[200:201], v[200:201], v[48:49], v[56:57]
    v_pk_fma_f32 v[202:203], v[202:203], v[50:51], v[58:59]
    v_pk_fma_f32 v[204:205], v[204:205], v[52:53], v[60:61]
    v_pk_fma_f32 v[206:207], v[206:207], v[54:55], v[62:63]
    v_cvt_pk_bf16_f32 v152, v192, v193
    v_cvt_pk_bf16_f32 v153, v194, v195
    ds_read_b128 v[48:51], v3 offset:7424
    v_cvt_pk_bf16_f32 v154, v196, v197
    v_cvt_pk_bf16_f32 v155, v198, v199
    ds_read_b128 v[52:55], v3 offset:7440
    v_cvt_pk_bf16_f32 v156, v200, v201
    v_cvt_pk_bf16_f32 v157, v202, v203
    ds_read_b128 v[56:59], v3 offset:3328
    v_cvt_pk_bf16_f32 v158, v204, v205
    v_cvt_pk_bf16_f32 v159, v206, v207
    ds_read_b128 v[60:63], v3 offset:3344
    v_lshlrev_b32 v192, 16, v160
    v_and_b32 v193, s96, v160
    v_lshlrev_b32 v194, 16, v161
    v_and_b32 v195, s96, v161
    v_lshlrev_b32 v196, 16, v162
    s_mov_b32 exec_hi, 0
    ds_write_b128 v9, v[152:155] offset:22528
    s_mov_b32 exec_hi, -1
    v_and_b32 v197, s96, v162
    v_lshlrev_b32 v198, 16, v163
    v_and_b32 v199, s96, v163
    v_lshlrev_b32 v200, 16, v164
    v_and_b32 v201, s96, v164
    v_lshlrev_b32 v202, 16, v165
    v_and_b32 v203, s96, v165
    v_lshlrev_b32 v204, 16, v166
    v_and_b32 v205, s96, v166
    v_lshlrev_b32 v206, 16, v167
    v_and_b32 v207, s96, v167
    v_pk_fma_f32 v[192:193], v[192:193], v[12:13], v[12:13] op_sel:[0,0,1] op_sel_hi:[1,0,1]
    v_pk_fma_f32 v[194:195], v[194:195], v[12:13], v[12:13] op_sel:[0,0,1] op_sel_hi:[1,0,1]
    v_pk_fma_f32 v[196:197], v[196:197], v[12:13], v[12:13] op_sel:[0,0,1] op_sel_hi:[1,0,1]
    v_pk_fma_f32 v[198:199], v[198:199], v[12:13], v[12:13] op_sel:[0,0,1] op_sel_hi:[1,0,1]
    v_pk_fma_f32 v[200:201], v[200:201], v[14:15], v[14:15] op_sel:[0,0,1] op_sel_hi:[1,0,1]
    v_pk_fma_f32 v[202:203], v[202:203], v[14:15], v[14:15] op_sel:[0,0,1] op_sel_hi:[1,0,1]
    v_pk_fma_f32 v[204:205], v[204:205], v[14:15], v[14:15] op_sel:[0,0,1] op_sel_hi:[1,0,1]
    v_pk_fma_f32 v[206:207], v[206:207], v[14:15], v[14:15] op_sel:[0,0,1] op_sel_hi:[1,0,1]
    s_waitcnt lgkmcnt(4)
    v_pk_fma_f32 v[192:193], v[192:193], v[32:33], v[40:41]
    v_pk_fma_f32 v[194:195], v[194:195], v[34:35], v[42:43]
    v_pk_fma_f32 v[196:197], v[196:197], v[36:37], v[44:45]
    v_pk_fma_f32 v[198:199], v[198:199], v[38:39], v[46:47]
    v_pk_fma_f32 v[200:201], v[200:201], v[32:33], v[40:41]
    v_pk_fma_f32 v[202:203], v[202:203], v[34:35], v[42:43]
    v_pk_fma_f32 v[204:205], v[204:205], v[36:37], v[44:45]
    v_pk_fma_f32 v[206:207], v[206:207], v[38:39], v[46:47]
    v_cvt_pk_bf16_f32 v160, v192, v193
    v_cvt_pk_bf16_f32 v161, v194, v195
    ds_read_b128 v[32:35], v3 offset:7680
    v_cvt_pk_bf16_f32 v162, v196, v197
    v_cvt_pk_bf16_f32 v163, v198, v199
    ds_read_b128 v[36:39], v3 offset:7696
    v_cvt_pk_bf16_f32 v164, v200, v201
    v_cvt_pk_bf16_f32 v165, v202, v203
    ds_read_b128 v[40:43], v3 offset:3584
    v_cvt_pk_bf16_f32 v166, v204, v205
    v_cvt_pk_bf16_f32 v167, v206, v207
    ds_read_b128 v[44:47], v3 offset:3600
    v_lshlrev_b32 v192, 16, v168
    v_and_b32 v193, s96, v168
    v_lshlrev_b32 v194, 16, v169
    v_and_b32 v195, s96, v169
    v_lshlrev_b32 v196, 16, v170
    s_mov_b32 exec_hi, 0
    ds_write_b128 v9, v[160:163] offset:24576
    s_mov_b32 exec_hi, -1
    v_and_b32 v197, s96, v170
    v_lshlrev_b32 v198, 16, v171
    v_and_b32 v199, s96, v171
    v_lshlrev_b32 v200, 16, v172
    v_and_b32 v201, s96, v172
    v_lshlrev_b32 v202, 16, v173
    v_and_b32 v203, s96, v173
    v_lshlrev_b32 v204, 16, v174
    v_and_b32 v205, s96, v174
    v_lshlrev_b32 v206, 16, v175
    v_and_b32 v207, s96, v175
    v_pk_fma_f32 v[192:193], v[192:193], v[12:13], v[12:13] op_sel:[0,0,1] op_sel_hi:[1,0,1]
    v_pk_fma_f32 v[194:195], v[194:195], v[12:13], v[12:13] op_sel:[0,0,1] op_sel_hi:[1,0,1]
    v_pk_fma_f32 v[196:197], v[196:197], v[12:13], v[12:13] op_sel:[0,0,1] op_sel_hi:[1,0,1]
    v_pk_fma_f32 v[198:199], v[198:199], v[12:13], v[12:13] op_sel:[0,0,1] op_sel_hi:[1,0,1]
    v_pk_fma_f32 v[200:201], v[200:201], v[14:15], v[14:15] op_sel:[0,0,1] op_sel_hi:[1,0,1]
    v_pk_fma_f32 v[202:203], v[202:203], v[14:15], v[14:15] op_sel:[0,0,1] op_sel_hi:[1,0,1]
    v_pk_fma_f32 v[204:205], v[204:205], v[14:15], v[14:15] op_sel:[0,0,1] op_sel_hi:[1,0,1]
    v_pk_fma_f32 v[206:207], v[206:207], v[14:15], v[14:15] op_sel:[0,0,1] op_sel_hi:[1,0,1]
    s_waitcnt lgkmcnt(4)
    v_pk_fma_f32 v[192:193], v[192:193], v[48:49], v[56:57]
    v_pk_fma_f32 v[194:195], v[194:195], v[50:51], v[58:59]
    v_pk_fma_f32 v[196:197], v[196:197], v[52:53], v[60:61]
    v_pk_fma_f32 v[198:199], v[198:199], v[54:55], v[62:63]
    v_pk_fma_f32 v[200:201], v[200:201], v[48:49], v[56:57]
    v_pk_fma_f32 v[202:203], v[202:203], v[50:51], v[58:59]
    v_pk_fma_f32 v[204:205], v[204:205], v[52:53], v[60:61]
    v_pk_fma_f32 v[206:207], v[206:207], v[54:55], v[62:63]
    v_cvt_pk_bf16_f32 v168, v192, v193
    v_cvt_pk_bf16_f32 v169, v194, v195
    ds_read_b128 v[48:51], v3 offset:7936
    v_cvt_pk_bf16_f32 v170, v196, v197
    v_cvt_pk_bf16_f32 v171, v198, v199
    ds_read_b128 v[52:55], v3 offset:7952
    v_cvt_pk_bf16_f32 v172, v200, v201
    v_cvt_pk_bf16_f32 v173, v202, v203
    ds_read_b128 v[56:59], v3 offset:3840
    v_cvt_pk_bf16_f32 v174, v204, v205
    v_cvt_pk_bf16_f32 v175, v206, v207
    ds_read_b128 v[60:63], v3 offset:3856
    v_lshlrev_b32 v192, 16, v176
    v_and_b32 v193, s96, v176
    v_lshlrev_b32 v194, 16, v177
    v_and_b32 v195, s96, v177
    v_lshlrev_b32 v196, 16, v178
    s_mov_b32 exec_hi, 0
    ds_write_b128 v9, v[168:171] offset:26624
    s_mov_b32 exec_hi, -1
    v_and_b32 v197, s96, v178
    v_lshlrev_b32 v198, 16, v179
    v_and_b32 v199, s96, v179
    v_lshlrev_b32 v200, 16, v180
    v_and_b32 v201, s96, v180
    v_lshlrev_b32 v202, 16, v181
    v_and_b32 v203, s96, v181
    v_lshlrev_b32 v204, 16, v182
    v_and_b32 v205, s96, v182
    v_lshlrev_b32 v206, 16, v183
    v_and_b32 v207, s96, v183
    v_pk_fma_f32 v[192:193], v[192:193], v[12:13], v[12:13] op_sel:[0,0,1] op_sel_hi:[1,0,1]
    v_pk_fma_f32 v[194:195], v[194:195], v[12:13], v[12:13] op_sel:[0,0,1] op_sel_hi:[1,0,1]
    v_pk_fma_f32 v[196:197], v[196:197], v[12:13], v[12:13] op_sel:[0,0,1] op_sel_hi:[1,0,1]
    v_pk_fma_f32 v[198:199], v[198:199], v[12:13], v[12:13] op_sel:[0,0,1] op_sel_hi:[1,0,1]
    v_pk_fma_f32 v[200:201], v[200:201], v[14:15], v[14:15] op_sel:[0,0,1] op_sel_hi:[1,0,1]
    v_pk_fma_f32 v[202:203], v[202:203], v[14:15], v[14:15] op_sel:[0,0,1] op_sel_hi:[1,0,1]
    v_pk_fma_f32 v[204:205], v[204:205], v[14:15], v[14:15] op_sel:[0,0,1] op_sel_hi:[1,0,1]
    v_pk_fma_f32 v[206:207], v[206:207], v[14:15], v[14:15] op_sel:[0,0,1] op_sel_hi:[1,0,1]
    s_waitcnt lgkmcnt(4)
    v_pk_fma_f32 v[192:193], v[192:193], v[32:33], v[40:41]
    v_pk_fma_f32 v[194:195], v[194:195], v[34:35], v[42:43]
    v_pk_fma_f32 v[196:197], v[196:197], v[36:37], v[44:45]
    v_pk_fma_f32 v[198:199], v[198:199], v[38:39], v[46:47]
    v_pk_fma_f32 v[200:201], v[200:201], v[32:33], v[40:41]
    v_pk_fma_f32 v[202:203], v[202:203], v[34:35], v[42:43]
    v_pk_fma_f32 v[204:205], v[204:205], v[36:37], v[44:45]
    v_pk_fma_f32 v[206:207], v[206:207], v[38:39], v[46:47]
    v_cvt_pk_bf16_f32 v176, v192, v193
    v_cvt_pk_bf16_f32 v177, v194, v195
    v_cvt_pk_bf16_f32 v178, v196, v197
    v_cvt_pk_bf16_f32 v179, v198, v199
    v_cvt_pk_bf16_f32 v180, v200, v201
    v_cvt_pk_bf16_f32 v181, v202, v203
    v_cvt_pk_bf16_f32 v182, v204, v205
    v_cvt_pk_bf16_f32 v183, v206, v207
    v_lshlrev_b32 v192, 16, v184
    v_and_b32 v193, s96, v184
    v_lshlrev_b32 v194, 16, v185
    v_and_b32 v195, s96, v185
    v_lshlrev_b32 v196, 16, v186
    s_mov_b32 exec_hi, 0
    ds_write_b128 v9, v[176:179] offset:28672
    s_mov_b32 exec_hi, -1
    v_and_b32 v197, s96, v186
    v_lshlrev_b32 v198, 16, v187
    v_and_b32 v199, s96, v187
    v_lshlrev_b32 v200, 16, v188
    v_and_b32 v201, s96, v188
    v_lshlrev_b32 v202, 16, v189
    v_and_b32 v203, s96, v189
    v_lshlrev_b32 v204, 16, v190
    v_and_b32 v205, s96, v190
    v_lshlrev_b32 v206, 16, v191
    v_and_b32 v207, s96, v191
    v_pk_fma_f32 v[192:193], v[192:193], v[12:13], v[12:13] op_sel:[0,0,1] op_sel_hi:[1,0,1]
    v_pk_fma_f32 v[194:195], v[194:195], v[12:13], v[12:13] op_sel:[0,0,1] op_sel_hi:[1,0,1]
    v_pk_fma_f32 v[196:197], v[196:197], v[12:13], v[12:13] op_sel:[0,0,1] op_sel_hi:[1,0,1]
    v_pk_fma_f32 v[198:199], v[198:199], v[12:13], v[12:13] op_sel:[0,0,1] op_sel_hi:[1,0,1]
    v_pk_fma_f32 v[200:201], v[200:201], v[14:15], v[14:15] op_sel:[0,0,1] op_sel_hi:[1,0,1]
    v_pk_fma_f32 v[202:203], v[202:203], v[14:15], v[14:15] op_sel:[0,0,1] op_sel_hi:[1,0,1]
    v_pk_fma_f32 v[204:205], v[204:205], v[14:15], v[14:15] op_sel:[0,0,1] op_sel_hi:[1,0,1]
    v_pk_fma_f32 v[206:207], v[206:207], v[14:15], v[14:15] op_sel:[0,0,1] op_sel_hi:[1,0,1]
    s_waitcnt lgkmcnt(0)
    v_pk_fma_f32 v[192:193], v[192:193], v[48:49], v[56:57]
    v_pk_fma_f32 v[194:195], v[194:195], v[50:51], v[58:59]
    v_pk_fma_f32 v[196:197], v[196:197], v[52:53], v[60:61]
    v_pk_fma_f32 v[198:199], v[198:199], v[54:55], v[62:63]
    v_pk_fma_f32 v[200:201], v[200:201], v[48:49], v[56:57]
    v_pk_fma_f32 v[202:203], v[202:203], v[50:51], v[58:59]
    v_pk_fma_f32 v[204:205], v[204:205], v[52:53], v[60:61]
    v_pk_fma_f32 v[206:207], v[206:207], v[54:55], v[62:63]
    v_cvt_pk_bf16_f32 v184, v192, v193
    v_cvt_pk_bf16_f32 v185, v194, v195
    v_cvt_pk_bf16_f32 v186, v196, v197
    v_cvt_pk_bf16_f32 v187, v198, v199
    v_cvt_pk_bf16_f32 v188, v200, v201
    v_cvt_pk_bf16_f32 v189, v202, v203
    v_cvt_pk_bf16_f32 v190, v204, v205
    v_cvt_pk_bf16_f32 v191, v206, v207
    s_mov_b32 exec_hi, 0
    ds_write_b128 v9, v[184:187] offset:30720
    s_mov_b32 exec_hi, -1
    s_waitcnt lgkmcnt(0)
    s_barrier
    s_setprio 0
    s_add_u32 s28, s6, 131072
    s_addc_u32 s29, s7, 0
    s_mov_b32 s30, 262144
    s_mov_b32 s31, 0x20000
    v_add_u32 v28, s98, v11
    v_add_u32 v29, 98304, v28
    v_add_u32 v28, 32768, v28
    s_mov_b32 s44, 32768
    s_mov_b32 s46, 0
    ds_write_addtid_b32 v88 offset:24576
    ds_write_addtid_b32 v89 offset:24832
    ds_write_addtid_b32 v90 offset:25088
    ds_write_addtid_b32 v91 offset:25344
    ds_write_addtid_b32 v92 offset:25600
    ds_write_addtid_b32 v93 offset:25856
    ds_write_addtid_b32 v94 offset:26112
    ds_write_addtid_b32 v95 offset:26368
    s_lshr_b32 s99, s47, 11
    s_add_u32 s99, s99, s97
    s_add_u32 s47, s47, s49
    buffer_load_dwordx4 v[192:195], v5, s[16:19], s99 offen offset:0
    buffer_load_dwordx4 v[196:199], v6, s[16:19], s99 offen offset:1024
    buffer_load_dwordx4 v[200:203], v7, s[16:19], s99 offen offset:2048
    buffer_load_dwordx4 v[204:207], v8, s[16:19], s99 offen offset:3072
    s_waitcnt lgkmcnt(8)
    s_barrier
    ds_write_addtid_b32 v96 offset:0
    ds_write_addtid_b32 v97 offset:256
    ds_write_addtid_b32 v98 offset:512
    ds_write_addtid_b32 v99 offset:768
    ds_write_addtid_b32 v100 offset:1024
    ds_write_addtid_b32 v101 offset:1280
    ds_write_addtid_b32 v102 offset:1536
    ds_write_addtid_b32 v103 offset:1792
    s_lshr_b32 s99, s47, 11
    s_add_u32 s99, s99, s97
    s_add_u32 s47, s47, s49
    buffer_load_dwordx4 v[208:211], v5, s[16:19], s99 offen offset:0
    buffer_load_dwordx4 v[212:215], v6, s[16:19], s99 offen offset:1024
    buffer_load_dwordx4 v[216:219], v7, s[16:19], s99 offen offset:2048
    buffer_load_dwordx4 v[220:223], v8, s[16:19], s99 offen offset:3072
    s_waitcnt lgkmcnt(8)
    s_barrier
    ds_write_addtid_b32 v104 offset:8192
    ds_write_addtid_b32 v105 offset:8448
    ds_write_addtid_b32 v106 offset:8704
    ds_write_addtid_b32 v107 offset:8960
    ds_write_addtid_b32 v108 offset:9216
    ds_write_addtid_b32 v109 offset:9472
    ds_write_addtid_b32 v110 offset:9728
    ds_write_addtid_b32 v111 offset:9984
    s_lshr_b32 s99, s47, 11
    s_add_u32 s99, s99, s97
    s_add_u32 s47, s47, s49
    buffer_load_dwordx4 v[224:227], v5, s[16:19], s99 offen offset:0
    buffer_load_dwordx4 v[228:231], v6, s[16:19], s99 offen offset:1024
    buffer_load_dwordx4 v[232:235], v7, s[16:19], s99 offen offset:2048
    buffer_load_dwordx4 v[236:239], v8, s[16:19], s99 offen offset:3072
    s_waitcnt lgkmcnt(8)
    s_barrier
    ds_write_addtid_b32 v112 offset:16384
    ds_write_addtid_b32 v113 offset:16640
    ds_write_addtid_b32 v114 offset:16896
    ds_write_addtid_b32 v115 offset:17152
    ds_write_addtid_b32 v116 offset:17408
    ds_write_addtid_b32 v117 offset:17664
    ds_write_addtid_b32 v118 offset:17920
    ds_write_addtid_b32 v119 offset:18176
    s_waitcnt vmcnt(8)
    ds_write_b128 v28, v[192:195] offset:32768
    ds_write_b128 v28, v[196:199] offset:33792
    s_lshr_b32 s99, s47, 11
    s_add_u32 s99, s99, s97
    s_add_u32 s47, s47, s49
    buffer_load_dwordx4 v[64:67], v5, s[16:19], s99 offen offset:0
    buffer_load_dwordx4 v[68:71], v6, s[16:19], s99 offen offset:1024
    buffer_load_dwordx4 v[72:75], v7, s[16:19], s99 offen offset:2048
    buffer_load_dwordx4 v[76:79], v8, s[16:19], s99 offen offset:3072
    s_waitcnt lgkmcnt(10)
    s_barrier
    ds_write_addtid_b32 v120 offset:24576
    ds_write_addtid_b32 v121 offset:24832
    ds_write_addtid_b32 v122 offset:25088
    ds_write_addtid_b32 v123 offset:25344
    ds_write_addtid_b32 v124 offset:25600
    ds_write_addtid_b32 v125 offset:25856
    ds_write_addtid_b32 v126 offset:26112
    ds_write_addtid_b32 v127 offset:26368
    ds_write_b128 v28, v[200:203] offset:34816
    ds_write_b128 v28, v[204:207] offset:35840
    s_waitcnt lgkmcnt(10)
    s_barrier
    ds_write_addtid_b32 v128 offset:0
    ds_write_addtid_b32 v129 offset:256
    ds_write_addtid_b32 v130 offset:512
    ds_write_addtid_b32 v131 offset:768
    ds_write_addtid_b32 v132 offset:1024
    ds_write_addtid_b32 v133 offset:1280
    ds_write_addtid_b32 v134 offset:1536
    ds_write_addtid_b32 v135 offset:1792
    s_waitcnt vmcnt(8)
    ds_write_b128 v28, v[208:211] offset:49152
    ds_write_b128 v28, v[212:215] offset:50176
    s_waitcnt lgkmcnt(10)
    s_barrier
    ds_write_addtid_b32 v136 offset:8192
    ds_write_addtid_b32 v137 offset:8448
    ds_write_addtid_b32 v138 offset:8704
    ds_write_addtid_b32 v139 offset:8960
    ds_write_addtid_b32 v140 offset:9216
    ds_write_addtid_b32 v141 offset:9472
    ds_write_addtid_b32 v142 offset:9728
    ds_write_addtid_b32 v143 offset:9984
    ds_write_b128 v28, v[216:219] offset:51200
    ds_write_b128 v28, v[220:223] offset:52224
    s_waitcnt lgkmcnt(10)
    s_barrier
    ds_write_addtid_b32 v144 offset:16384
    ds_write_addtid_b32 v145 offset:16640
    ds_write_addtid_b32 v146 offset:16896
    ds_write_addtid_b32 v147 offset:17152
    ds_write_addtid_b32 v148 offset:17408
    ds_write_addtid_b32 v149 offset:17664
    ds_write_addtid_b32 v150 offset:17920
    ds_write_addtid_b32 v151 offset:18176
    s_waitcnt vmcnt(4)
    ds_write_b128 v29, v[224:227] offset:0
    ds_write_b128 v29, v[228:231] offset:1024
    s_waitcnt lgkmcnt(10)
    s_barrier
    ds_write_addtid_b32 v152 offset:24576
    ds_write_addtid_b32 v153 offset:24832
    ds_write_addtid_b32 v154 offset:25088
    ds_write_addtid_b32 v155 offset:25344
    ds_write_addtid_b32 v156 offset:25600
    ds_write_addtid_b32 v157 offset:25856
    ds_write_addtid_b32 v158 offset:26112
    ds_write_addtid_b32 v159 offset:26368
    ds_write_b128 v29, v[232:235] offset:2048
    ds_write_b128 v29, v[236:239] offset:3072
    s_waitcnt lgkmcnt(10)
    s_barrier
    ds_write_addtid_b32 v160 offset:0
    ds_write_addtid_b32 v161 offset:256
    ds_write_addtid_b32 v162 offset:512
    ds_write_addtid_b32 v163 offset:768
    ds_write_addtid_b32 v164 offset:1024
    ds_write_addtid_b32 v165 offset:1280
    ds_write_addtid_b32 v166 offset:1536
    ds_write_addtid_b32 v167 offset:1792
    s_waitcnt vmcnt(0)
    ds_write_b128 v29, v[64:67] offset:16384
    ds_write_b128 v29, v[68:71] offset:17408
    s_waitcnt lgkmcnt(10)
    s_barrier
    ds_write_addtid_b32 v168 offset:8192
    ds_write_addtid_b32 v169 offset:8448
    ds_write_addtid_b32 v170 offset:8704
    ds_write_addtid_b32 v171 offset:8960
    ds_write_addtid_b32 v172 offset:9216
    ds_write_addtid_b32 v173 offset:9472
    ds_write_addtid_b32 v174 offset:9728
    ds_write_addtid_b32 v175 offset:9984
    ds_write_b128 v29, v[72:75] offset:18432
    ds_write_b128 v29, v[76:79] offset:19456
    s_waitcnt lgkmcnt(10)
    s_barrier
    ds_write_addtid_b32 v176 offset:16384
    ds_write_addtid_b32 v177 offset:16640
    ds_write_addtid_b32 v178 offset:16896
    ds_write_addtid_b32 v179 offset:17152
    ds_write_addtid_b32 v180 offset:17408
    ds_write_addtid_b32 v181 offset:17664
    ds_write_addtid_b32 v182 offset:17920
    ds_write_addtid_b32 v183 offset:18176
    s_add_u32 s36, s6, 458752
    s_addc_u32 s37, s7, 0
    s_mov_b32 s38, 37120
    s_mov_b32 s39, 0x20000
    buffer_load_dword v40, v11, s[36:39], s44 offen offset:0 sc1
    buffer_load_dword v41, v11, s[36:39], s44 offen offset:1024 sc1
    buffer_load_dword v42, v11, s[36:39], s44 offen offset:2048 sc1
    buffer_load_dword v43, v11, s[36:39], s44 offen offset:3072 sc1
    s_waitcnt lgkmcnt(8)
    s_barrier
    ds_write_addtid_b32 v184 offset:24576
    ds_write_addtid_b32 v185 offset:24832
    ds_write_addtid_b32 v186 offset:25088
    ds_write_addtid_b32 v187 offset:25344
    ds_write_addtid_b32 v188 offset:25600
    ds_write_addtid_b32 v189 offset:25856
    ds_write_addtid_b32 v190 offset:26112
    ds_write_addtid_b32 v191 offset:26368
    s_waitcnt lgkmcnt(8)
    s_barrier
    s_waitcnt lgkmcnt(0)
    s_barrier
    s_cmp_eq_u32 s46, 1
    s_cbranch_scc1 .Lk3_kvd_23
    s_mov_b32 s46, 0x100000
.Lk3_p0_24:
    s_waitcnt vmcnt(0)
    v_xor_b32 v40, v40, v10
    v_bitop3_b32 v40, v40, v41, v10 bitop3:0xf6
    v_bitop3_b32 v40, v40, v42, v10 bitop3:0xf6
    v_bitop3_b32 v40, v40, v43, v10 bitop3:0xf6
    v_cmp_ne_u32 vcc, 0, v40
    s_cbranch_vccz .Lk3_p1_25
    buffer_load_dword v40, v11, s[36:39], s44 offen offset:0 sc1
    buffer_load_dword v41, v11, s[36:39], s44 offen offset:1024 sc1
    buffer_load_dword v42, v11, s[36:39], s44 offen offset:2048 sc1
    buffer_load_dword v43, v11, s[36:39], s44 offen offset:3072 sc1
    s_sub_u32 s46, s46, 1
    s_cbranch_scc0 .Lk3_p0_24
.Lk3_p1_25:
    s_add_u32 m0, s98, 131072
    s_nop 0
    buffer_load_dwordx4 v11, s[28:31], s98 offen offset:0 sc1 lds
    buffer_load_dwordx4 v11, s[28:31], s98 offen offset:1024 sc1 lds
    buffer_load_dwordx4 v11, s[28:31], s98 offen offset:2048 sc1 lds
    buffer_load_dwordx4 v11, s[28:31], s98 offen offset:3072 sc1 lds
    s_lshl_b32 m0, s42, 11
    s_mov_b32 s46, 1
.Lk3_kvd_23:
    s_lshl_b32 s3, s2, 2
    s_add_u32 s3, s3, s42
    s_cmp_lg_u32 s3, 0
    s_cbranch_scc1 .Lk3_nt_26
    s_mov_b32 s3, 36864
    s_mov_b64 exec, 1
    buffer_store_dword v10, v11, s[36:39], s3 offen sc1
    s_mov_b64 exec, -1
.Lk3_nt_26:
    s_cmp_ge_u32 s42, 2
    s_cbranch_scc1 .Lk3_pf_27
    s_lshl_b32 s46, s42, 13
    s_add_u32 s47, s46, 49152
    s_add_u32 s46, s46, 16384
    s_mov_b32 s41, 15
    s_branch .Lk3_kv1_29
.Lk3_kvl_28:
    s_waitcnt vmcnt(8)
    s_barrier
.Lk3_kv1_29:
    s_add_u32 m0, s47, 98304
    s_nop 0
    buffer_load_dwordx4 v11, s[28:31], s46 offen offset:0 sc1 lds
    buffer_load_dwordx4 v11, s[28:31], s46 offen offset:1024 sc1 lds
    buffer_load_dwordx4 v11, s[28:31], s46 offen offset:2048 sc1 lds
    buffer_load_dwordx4 v11, s[28:31], s46 offen offset:3072 sc1 lds
    s_add_u32 s46, s46, 4096
    s_add_u32 m0, s47, 102400
    s_nop 0
    buffer_load_dwordx4 v11, s[28:31], s46 offen offset:0 sc1 lds
    buffer_load_dwordx4 v11, s[28:31], s46 offen offset:1024 sc1 lds
    buffer_load_dwordx4 v11, s[28:31], s46 offen offset:2048 sc1 lds
    buffer_load_dwordx4 v11, s[28:31], s46 offen offset:3072 sc1 lds
    s_add_u32 s46, s46, 12288
    s_add_u32 s47, s47, 16384
    s_and_b32 s47, s47, 0xffff
    s_sub_u32 s41, s41, 1
    s_cmp_lg_u32 s41, 0
    s_cbranch_scc1 .Lk3_kvl_28
    s_branch .Lk3_t14_30
.Lk3_pf_27:
    s_lshr_b32 s3, s2, 3
    s_lshl_b32 s3, s3, 1
    s_and_b32 s43, s42, 1
    s_add_u32 s3, s3, s43
    s_lshl_b32 s3, s3, 12
    buffer_load_dwordx4 v[40:43], v11, s[28:31], s3 offen offset:0 sc1
    buffer_load_dwordx4 v[44:47], v11, s[28:31], s3 offen offset:1024 sc1
    buffer_load_dwordx4 v[48:51], v11, s[28:31], s3 offen offset:2048 sc1
    buffer_load_dwordx4 v[52:55], v11, s[28:31], s3 offen offset:3072 sc1
    s_mov_b32 s16, s52
    s_mov_b32 s17, s53
    s_mov_b32 s18, 7340032
    s_mov_b32 s19, 0x20000
    s_add_u32 s28, s6, 37748736
    s_addc_u32 s29, s7, 0
    s_mov_b32 s30, 7340032
    s_mov_b32 s31, 0x20000
    s_mov_b32 s50, 0xbfb8aa3b
    v_lshlrev_b32 v32, 16, v0
    v_and_b32 v33, 0xffff0000, v0
    v_lshlrev_b32 v34, 16, v1
    v_and_b32 v35, 0xffff0000, v1
    v_mul_f32 v36, s50, v32
    v_mul_f32 v37, s50, v33
    v_mul_f32 v38, s50, v34
    v_mul_f32 v39, s50, v35
    v_exp_f32 v36, v36
    v_exp_f32 v37, v37
    v_exp_f32 v38, v38
    v_exp_f32 v39, v39
    v_add_f32 v36, 1.0, v36
    v_add_f32 v37, 1.0, v37
    v_add_f32 v38, 1.0, v38
    v_add_f32 v39, 1.0, v39
    v_rcp_f32 v36, v36
    v_rcp_f32 v37, v37
    v_rcp_f32 v38, v38
    v_rcp_f32 v39, v39
    v_mul_f32 v32, v32, v36
    v_mul_f32 v33, v33, v37
    v_mul_f32 v34, v34, v38
    v_mul_f32 v35, v35, v39
    v_cvt_pk_bf16_f32 v0, v32, v33
    v_cvt_pk_bf16_f32 v1, v34, v35
    s_waitcnt vmcnt(4)
    s_barrier
    s_and_b32 s48, s42, 1
    v_and_b32 v32, 15, v2
    v_lshrrev_b32 v33, 4, v2
    v_lshrrev_b32 v34, 2, v2
    v_and_b32 v34, 3, v34
    v_and_b32 v35, 3, v2
    s_mov_b32 s43, 7168
    v_add_u32 v36, 0, v33
    v_mul_u32_u24 v37, 9363, v36
    v_lshrrev_b32 v37, 16, v37
    v_mul_u32_u24 v38, 7, v37
    v_sub_u32 v38, v36, v38
    v_and_b32 v36, 1, v37
    v_lshlrev_b32 v36, 1, v36
    v_xor_b32 v36, v36, v35
    v_lshl_add_u32 v37, v37, 2, v34
    v_mul_u32_u24 v37, s43, v37
    v_lshl_add_u32 v37, v38, 6, v37
    v_lshl_add_u32 v12, v36, 4, v37
    v_add_u32 v36, 4, v33
    v_mul_u32_u24 v37, 9363, v36
    v_lshrrev_b32 v37, 16, v37
    v_mul_u32_u24 v38, 7, v37
    v_sub_u32 v38, v36, v38
    v_and_b32 v36, 1, v37
    v_lshlrev_b32 v36, 1, v36
    v_xor_b32 v36, v36, v35
    v_lshl_add_u32 v37, v37, 2, v34
    v_mul_u32_u24 v37, s43, v37
    v_lshl_add_u32 v37, v38, 6, v37
    v_lshl_add_u32 v13, v36, 4, v37
    v_add_u32 v36, 8, v33
    v_mul_u32_u24 v37, 9363, v36
    v_lshrrev_b32 v37, 16, v37
    v_mul_u32_u24 v38, 7, v37
    v_sub_u32 v38, v36, v38
    v_and_b32 v36, 1, v37
    v_lshlrev_b32 v36, 1, v36
    v_xor_b32 v36, v36, v35
    v_lshl_add_u32 v37, v37, 2, v34
    v_mul_u32_u24 v37, s43, v37
    v_lshl_add_u32 v37, v38, 6, v37
    v_lshl_add_u32 v14, v36, 4, v37
    v_add_u32 v36, 12, v33
    v_mul_u32_u24 v37, 9363, v36
    v_lshrrev_b32 v37, 16, v37
    v_mul_u32_u24 v38, 7, v37
    v_sub_u32 v38, v36, v38
    v_and_b32 v36, 1, v37
    v_lshlrev_b32 v36, 1, v36
    v_xor_b32 v36, v36, v35
    v_lshl_add_u32 v37, v37, 2, v34
    v_mul_u32_u24 v37, s43, v37
    v_lshl_add_u32 v37, v38, 6, v37
    v_lshl_add_u32 v15, v36, 4, v37
    v_add_u32 v36, 16, v33
    v_mul_u32_u24 v37, 9363, v36
    v_lshrrev_b32 v37, 16, v37
    v_mul_u32_u24 v38, 7, v37
    v_sub_u32 v38, v36, v38
    v_and_b32 v36, 1, v37
    v_lshlrev_b32 v36, 1, v36
    v_xor_b32 v36, v36, v35
    v_lshl_add_u32 v37, v37, 2, v34
    v_mul_u32_u24 v37, s43, v37
    v_lshl_add_u32 v37, v38, 6, v37
    v_lshl_add_u32 v16, v36, 4, v37
    v_add_u32 v36, 20, v33
    v_mul_u32_u24 v37, 9363, v36
    v_lshrrev_b32 v37, 16, v37
    v_mul_u32_u24 v38, 7, v37
    v_sub_u32 v38, v36, v38
    v_and_b32 v36, 1, v37
    v_lshlrev_b32 v36, 1, v36
    v_xor_b32 v36, v36, v35
    v_lshl_add_u32 v37, v37, 2, v34
    v_mul_u32_u24 v37, s43, v37
    v_lshl_add_u32 v37, v38, 6, v37
    v_lshl_add_u32 v17, v36, 4, v37
    v_add_u32 v36, 24, v33
    v_mul_u32_u24 v37, 9363, v36
    v_lshrrev_b32 v37, 16, v37
    v_mul_u32_u24 v38, 7, v37
    v_sub_u32 v38, v36, v38
    v_and_b32 v36, 1, v37
    v_lshlrev_b32 v36, 1, v36
    v_xor_b32 v36, v36, v35
    v_lshl_add_u32 v37, v37, 2, v34
    v_mul_u32_u24 v37, s43, v37
    v_lshl_add_u32 v37, v38, 6, v37
    v_lshl_add_u32 v18, v36, 4, v37
    s_lshl_b32 s3, s2, 1
    s_and_b32 s3, s3, 128
    v_lshlrev_b32 v20, 11, v34
    v_lshl_add_u32 v20, v33, 6, v20
    v_lshl_add_u32 v20, v35, 4, v20
    v_xor_b32 v20, s3, v20
    s_mul_i32 s3, s48, 12
    s_and_b32 s3, s3, 1
    s_lshl_b32 s3, s3, 5
    v_xor_b32 v20, s3, v20
    v_xor_b32 v21, 32, v20
    v_lshrrev_b32 v36, 1, v33
    v_lshl_add_u32 v38, v36, 2, v34
    v_and_b32 v37, 1, v33
    v_lshlrev_b32 v37, 6, v37
    v_lshl_add_u32 v22, v38, 11, v37
    v_lshlrev_b32 v36, 1, v36
    v_xor_b32 v36, v36, v35
    v_lshl_add_u32 v22, v36, 4, v22
    s_mov_b32 s43, 12288
    v_mul_u32_u24 v23, s43, v38
    v_add_u32 v23, v23, v37
    v_lshl_add_u32 v23, v35, 4, v23
    v_xor_b32 v24, 32, v23
    v_lshlrev_b32 v37, 10, v33
    v_lshl_add_u32 v37, v34, 6, v37
    v_lshl_add_u32 v37, v35, 3, v37
    v_and_b32 v36, 1, v33
    v_lshl_add_u32 v37, v36, 5, v37
    s_lshl_b32 s3, s48, 8
    s_add_u32 s3, s3, 32768
    v_add_u32 v25, s3, v37
    v_xor_b32 v26, 32, v25
    v_lshlrev_b32 v27, 4, v33
    s_lshl_b32 s3, s48, 9
    s_add_u32 s3, s3, 0
    v_add_u32 v31, s3, v27
    v_lshlrev_b32 v30, 3, v2
    v_add_u32 v30, s3, v30
    v_mov_b32 v36, 0x7ff00000
    v_cmp_eq_u32 vcc, 0, v32
    s_nop 1
    v_cndmask_b32 v27, v36, v27, vcc
    s_lshr_b32 s58, s2, 4
    s_and_b32 s59, s2, 15
    s_mul_i32 s60, s58, 458752
    s_mul_i32 s3, s48, 229376
    s_add_u32 s60, s60, s3
    s_mul_i32 s3, s59, 448
    s_add_u32 s60, s60, s3
    s_lshl_b32 s61, s59, 4
    s_add_u32 s61, s61, s58
    s_lshl_b32 s61, s61, 1
    s_add_u32 s61, s61, s48
    s_mul_i32 s61, s61, 14336
    s_lshr_b32 s3, s2, 3
    s_lshl_b32 s3, s3, 1
    s_add_u32 s3, s3, s48
    s_and_b32 s62, s3, 15
    s_mul_i32 s62, s62, 12
    s_mul_i32 s3, s3, 12
    s_and_b32 s43, s2, 7
    s_mul_i32 s63, s43, 768
    s_add_u32 s63, s63, s3
    s_lshl_b32 s63, s63, 10
    s_lshr_b32 s46, s2, 6
    s_mul_i32 s46, s46, 1835008
    s_lshl_b32 s43, s43, 8
    s_add_u32 s46, s46, s43
    s_mul_i32 s64, s58, 458752
    s_lshl_b32 s3, s48, 14
    s_add_u32 s64, s64, s3
    s_lshl_b32 s3, s59, 7
    s_add_u32 s64, s64, s3
    s_add_u32 s64, s64, 196608
    s_lshl_b32 s43, s58, 1
    s_add_u32 s43, s43, s48
    s_lshl_b32 s65, s59, 5
    s_add_u32 s65, s65, s43
    s_lshl_b32 s65, s65, 11
    s_add_u32 s65, s65, 6291456
    s_lshl_b32 s66, s43, 16
    s_lshl_b32 s3, s59, 7
    s_add_u32 s66, s66, s3
    s_lshl_b32 s67, s59, 5
    s_add_u32 s67, s67, s43
    s_lshl_b32 s67, s67, 12
    s_lshr_b32 s58, s2, 6
    s_and_b32 s59, s2, 63
    s_lshl_b32 s3, s58, 1
    s_add_u32 s3, s3, s48
    s_mul_i32 s68, s3, 1572864
    s_lshl_b32 s3, s59, 7
    s_add_u32 s68, s68, s3
    s_add_u32 s68, s68, 4096
    s_lshl_b32 s69, s48, 14
    s_add_u32 s69, s69, 32768
    s_mul_i32 s51, s58, 24576
    s_lshl_b32 s3, s59, 8
    s_add_u32 s51, s51, s3
    s_lshl_b32 s3, s48, 7
    s_add_u32 s51, s51, s3
    s_add_u32 s51, s51, 8192
    s_mov_b32 s24, s56
    s_mov_b32 s25, s57
    s_mov_b32 s26, 2097152
    s_mov_b32 s27, 0x20000
    s_add_u32 s32, s6, 45088768
    s_addc_u32 s33, s7, 0
    s_mov_b32 s34, 7340032
    s_mov_b32 s35, 0x20000
    s_mov_b32 s72, s10
    s_mov_b32 s73, s11
    s_mov_b32 s74, 12582912
    s_mov_b32 s75, 0x20000
    s_add_u32 s80, s6, 0
    s_addc_u32 s81, s7, 0
    s_mov_b32 s82, 98304
    s_mov_b32 s83, 0x20000
    s_mov_b32 s20, s54
    s_mov_b32 s21, s55
    s_mov_b32 s22, 7340032
    s_mov_b32 s23, 0x20000
    s_add_u32 s76, s6, 35651584
    s_addc_u32 s77, s7, 0
    s_mov_b32 s78, 2097152
    s_mov_b32 s79, 0x20000
    ds_write_b64 v30, v[0:1]
    ds_read_b128 v[96:99], v31 offset:0
    ds_read_b128 v[100:103], v31 offset:64
    ds_read_b128 v[104:107], v31 offset:128
    ds_read_b128 v[108:111], v31 offset:192
    ds_read_b128 v[112:115], v31 offset:256
    ds_read_b128 v[116:119], v31 offset:320
    ds_read_b128 v[120:123], v31 offset:384
    ds_read_b128 v[124:127], v31 offset:448
    s_add_u32 s96, s6, 67108864
    s_addc_u32 s97, s7, 0
    s_mov_b32 s98, 12582912
    s_mov_b32 s99, 0x20000
    s_mul_i32 s3, s2, 49152
    s_add_u32 s96, s96, s3
    s_addc_u32 s97, s97, 0
    s_mul_i32 s3, s48, 8192
    s_add_u32 s96, s96, s3
    s_addc_u32 s97, s97, 0
    s_mov_b32 s98, 8192
    v_mov_b32 v200, -1
    v_mov_b32 v201, -1
    v_mov_b32 v202, -1
    v_mov_b32 v203, -1
    s_add_u32 m0, s69, 0
    s_nop 0
    buffer_load_dwordx4 v23, s[72:75], s68 offen nt lds
    s_add_u32 s68, s68, 98304
    s_add_u32 m0, s69, 1024
    s_nop 0
    buffer_load_dwordx4 v24, s[72:75], s68 offen nt lds
    s_add_u32 s68, s68, 98304
    buffer_load_dwordx4 v[32:35], v22, s[24:27], s66 offen nt
    s_add_u32 s66, s66, 16384
    buffer_load_dwordx4 v[36:39], v22, s[24:27], s66 offen nt
    s_add_u32 s66, s66, 16384
    buffer_load_dwordx4 v[40:43], v22, s[24:27], s66 offen nt
    s_add_u32 s66, s66, 16384
    buffer_load_dwordx4 v[44:47], v22, s[24:27], s66 offen nt
    s_add_u32 s66, s66, 16384
    s_mov_b32 s3, 0
    buffer_store_dwordx4 v[200:203], v11, s[96:99], s3 offen offset:0 sc1
    s_barrier
    s_add_u32 m0, s69, 2048
    s_nop 0
    buffer_load_dwordx4 v23, s[72:75], s68 offen nt lds
    s_add_u32 s68, s68, 98304
    s_add_u32 m0, s69, 3072
    s_nop 0
    buffer_load_dwordx4 v24, s[72:75], s68 offen nt lds
    s_add_u32 s68, s68, 98304
    buffer_load_dwordx4 v[48:51], v12, s[16:19], s60 offen nt
    buffer_load_dwordx4 v[52:55], v13, s[16:19], s60 offen nt
    buffer_load_dwordx4 v[56:59], v14, s[16:19], s60 offen nt
    buffer_load_dwordx4 v[60:63], v15, s[16:19], s60 offen nt
    s_mov_b32 s3, 0
    buffer_store_dwordx4 v[200:203], v11, s[96:99], s3 offen offset:1024 sc1
    s_barrier
    s_waitcnt vmcnt(8)
    buffer_store_dwordx4 v[32:35], v11, s[76:79], s67 offen sc1
    s_add_u32 s67, s67, 1024
    buffer_store_dwordx4 v[36:39], v11, s[76:79], s67 offen sc1
    s_add_u32 s67, s67, 1024
    buffer_store_dwordx4 v[40:43], v11, s[76:79], s67 offen sc1
    s_add_u32 s67, s67, 1024
    buffer_store_dwordx4 v[44:47], v11, s[76:79], s67 offen sc1
    s_add_u32 s67, s67, 1024
    s_add_u32 m0, s69, 4096
    s_nop 0
    buffer_load_dwordx4 v23, s[72:75], s68 offen nt lds
    s_add_u32 s68, s68, 98304
    s_add_u32 m0, s69, 5120
    s_nop 0
    buffer_load_dwordx4 v24, s[72:75], s68 offen nt lds
    s_add_u32 s68, s68, 98304
    buffer_load_dwordx4 v[64:67], v16, s[16:19], s60 offen nt
    buffer_load_dwordx4 v[68:71], v17, s[16:19], s60 offen nt
    buffer_load_dwordx4 v[72:75], v18, s[16:19], s60 offen nt
    s_add_u32 s60, s60, 114688
    s_mov_b32 s3, 0
    buffer_store_dwordx4 v[200:203], v11, s[96:99], s3 offen offset:2048 sc1
    s_barrier
    s_waitcnt vmcnt(11)
    buffer_store_dwordx4 v[48:51], v11, s[28:31], s61 offen sc1
    s_add_u32 s61, s61, 1024
    buffer_store_dwordx4 v[52:55], v11, s[28:31], s61 offen sc1
    s_add_u32 s61, s61, 1024
    buffer_store_dwordx4 v[56:59], v11, s[28:31], s61 offen sc1
    s_add_u32 s61, s61, 1024
    buffer_store_dwordx4 v[60:63], v11, s[28:31], s61 offen sc1
    s_add_u32 s61, s61, 1024
    s_add_u32 m0, s69, 6144
    s_nop 0
    buffer_load_dwordx4 v23, s[72:75], s68 offen nt lds
    s_add_u32 s68, s68, 98304
    s_add_u32 m0, s69, 7168
    s_nop 0
    buffer_load_dwordx4 v24, s[72:75], s68 offen nt lds
    s_add_u32 s68, s68, 98304
    buffer_load_dwordx4 v[76:79], v12, s[16:19], s60 offen nt
    buffer_load_dwordx4 v[80:83], v13, s[16:19], s60 offen nt
    buffer_load_dwordx4 v[84:87], v14, s[16:19], s60 offen nt
    buffer_load_dwordx4 v[88:91], v15, s[16:19], s60 offen nt
    s_mov_b32 s3, 0
    buffer_store_dwordx4 v[200:203], v11, s[96:99], s3 offen offset:3072 sc1
    s_barrier
    s_waitcnt vmcnt(12)
    buffer_store_dwordx4 v[64:67], v11, s[28:31], s61 offen sc1
    s_add_u32 s61, s61, 1024
    buffer_store_dwordx4 v[68:71], v11, s[28:31], s61 offen sc1
    s_add_u32 s61, s61, 1024
    buffer_store_dwordx4 v[72:75], v11, s[28:31], s61 offen sc1
    s_add_u32 s61, s61, 1024
    s_add_u32 m0, s69, 8192
    s_nop 0
    buffer_load_dwordx4 v23, s[72:75], s68 offen nt lds
    s_add_u32 s68, s68, 98304
    buffer_load_dwordx4 v[92:95], v16, s[16:19], s60 offen nt
    buffer_load_dwordx4 v[128:131], v17, s[16:19], s60 offen nt
    buffer_load_dwordx4 v[132:135], v18, s[16:19], s60 offen nt
    s_mov_b32 s3, 4096
    buffer_store_dwordx4 v[200:203], v11, s[96:99], s3 offen offset:0 sc1
    s_barrier
    s_waitcnt vmcnt(9)
    buffer_store_dwordx4 v[76:79], v11, s[28:31], s61 offen sc1
    s_add_u32 s61, s61, 1024
    buffer_store_dwordx4 v[80:83], v11, s[28:31], s61 offen sc1
    s_add_u32 s61, s61, 1024
    buffer_store_dwordx4 v[84:87], v11, s[28:31], s61 offen sc1
    s_add_u32 s61, s61, 1024
    buffer_store_dwordx4 v[88:91], v11, s[28:31], s61 offen sc1
    s_add_u32 s61, s61, 1024
    s_add_u32 m0, s69, 9216
    s_nop 0
    buffer_load_dwordx4 v24, s[72:75], s68 offen nt lds
    s_add_u32 s68, s68, 98304
    s_add_u32 m0, s69, 10240
    s_nop 0
    buffer_load_dwordx4 v23, s[72:75], s68 offen nt lds
    s_add_u32 s68, s68, 98304
    s_bfe_u32 s44, s62, 0x20004
    s_mul_i32 s44, s44, 458752
    s_lshr_b32 s45, s62, 6
    s_lshl_b32 s45, s45, 16
    s_add_u32 s44, s44, s45
    s_and_b32 s45, s62, 8
    s_lshl_b32 s45, s45, 15
    s_add_u32 s44, s44, s45
    s_and_b32 s45, s62, 7
    s_lshl_b32 s45, s45, 13
    s_add_u32 s44, s44, s45
    s_add_u32 s45, s44, s46
    buffer_load_dwordx4 v[136:139], v20, s[20:23], s45 offen nt
    s_add_u32 s62, s62, 1
    s_bfe_u32 s44, s62, 0x20004
    s_mul_i32 s44, s44, 458752
    s_lshr_b32 s45, s62, 6
    s_lshl_b32 s45, s45, 16
    s_add_u32 s44, s44, s45
    s_and_b32 s45, s62, 8
    s_lshl_b32 s45, s45, 15
    s_add_u32 s44, s44, s45
    s_and_b32 s45, s62, 7
    s_lshl_b32 s45, s45, 13
    s_add_u32 s44, s44, s45
    s_add_u32 s45, s44, s46
    buffer_load_dwordx4 v[140:143], v21, s[20:23], s45 offen nt
    s_add_u32 s62, s62, 1
    s_bfe_u32 s44, s62, 0x20004
    s_mul_i32 s44, s44, 458752
    s_lshr_b32 s45, s62, 6
    s_lshl_b32 s45, s45, 16
    s_add_u32 s44, s44, s45
    s_and_b32 s45, s62, 8
    s_lshl_b32 s45, s45, 15
    s_add_u32 s44, s44, s45
    s_and_b32 s45, s62, 7
    s_lshl_b32 s45, s45, 13
    s_add_u32 s44, s44, s45
    s_add_u32 s45, s44, s46
    buffer_load_dwordx4 v[144:147], v20, s[20:23], s45 offen nt
    s_add_u32 s62, s62, 1
    s_bfe_u32 s44, s62, 0x20004
    s_mul_i32 s44, s44, 458752
    s_lshr_b32 s45, s62, 6
    s_lshl_b32 s45, s45, 16
    s_add_u32 s44, s44, s45
    s_and_b32 s45, s62, 8
    s_lshl_b32 s45, s45, 15
    s_add_u32 s44, s44, s45
    s_and_b32 s45, s62, 7
    s_lshl_b32 s45, s45, 13
    s_add_u32 s44, s44, s45
    s_add_u32 s45, s44, s46
    buffer_load_dwordx4 v[148:151], v21, s[20:23], s45 offen nt
    s_add_u32 s62, s62, 1
    s_mov_b32 s3, 4096
    buffer_store_dwordx4 v[200:203], v11, s[96:99], s3 offen offset:1024 sc1
    s_barrier
    s_waitcnt vmcnt(12)
    buffer_store_dwordx4 v[92:95], v11, s[28:31], s61 offen sc1
    s_add_u32 s61, s61, 1024
    buffer_store_dwordx4 v[128:131], v11, s[28:31], s61 offen sc1
    s_add_u32 s61, s61, 1024
    buffer_store_dwordx4 v[132:135], v11, s[28:31], s61 offen sc1
    s_add_u32 s61, s61, 1024
    s_add_u32 m0, s69, 11264
    s_nop 0
    buffer_load_dwordx4 v24, s[72:75], s68 offen nt lds
    s_add_u32 s68, s68, 98304
    s_add_u32 m0, s69, 12288
    s_nop 0
    buffer_load_dwordx4 v23, s[72:75], s68 offen nt lds
    s_add_u32 s68, s68, 98304
    s_bfe_u32 s44, s62, 0x20004
    s_mul_i32 s44, s44, 458752
    s_lshr_b32 s45, s62, 6
    s_lshl_b32 s45, s45, 16
    s_add_u32 s44, s44, s45
    s_and_b32 s45, s62, 8
    s_lshl_b32 s45, s45, 15
    s_add_u32 s44, s44, s45
    s_and_b32 s45, s62, 7
    s_lshl_b32 s45, s45, 13
    s_add_u32 s44, s44, s45
    s_add_u32 s45, s44, s46
    buffer_load_dwordx4 v[152:155], v20, s[20:23], s45 offen nt
    s_add_u32 s62, s62, 1
    s_bfe_u32 s44, s62, 0x20004
    s_mul_i32 s44, s44, 458752
    s_lshr_b32 s45, s62, 6
    s_lshl_b32 s45, s45, 16
    s_add_u32 s44, s44, s45
    s_and_b32 s45, s62, 8
    s_lshl_b32 s45, s45, 15
    s_add_u32 s44, s44, s45
    s_and_b32 s45, s62, 7
    s_lshl_b32 s45, s45, 13
    s_add_u32 s44, s44, s45
    s_add_u32 s45, s44, s46
    buffer_load_dwordx4 v[156:159], v21, s[20:23], s45 offen nt
    s_add_u32 s62, s62, 1
    s_bfe_u32 s44, s62, 0x20004
    s_mul_i32 s44, s44, 458752
    s_lshr_b32 s45, s62, 6
    s_lshl_b32 s45, s45, 16
    s_add_u32 s44, s44, s45
    s_and_b32 s45, s62, 8
    s_lshl_b32 s45, s45, 15
    s_add_u32 s44, s44, s45
    s_and_b32 s45, s62, 7
    s_lshl_b32 s45, s45, 13
    s_add_u32 s44, s44, s45
    s_add_u32 s45, s44, s46
    buffer_load_dwordx4 v[160:163], v20, s[20:23], s45 offen nt
    s_add_u32 s62, s62, 1
    s_mov_b32 s3, 4096
    buffer_store_dwordx4 v[200:203], v11, s[96:99], s3 offen offset:2048 sc1
    s_barrier
    s_waitcnt vmcnt(10)
    buffer_store_dwordx4 v[136:139], v11, s[32:35], s63 offen sc1
    s_add_u32 s63, s63, 1024
    buffer_store_dwordx4 v[140:143], v11, s[32:35], s63 offen sc1
    s_add_u32 s63, s63, 1024
    buffer_store_dwordx4 v[144:147], v11, s[32:35], s63 offen sc1
    s_add_u32 s63, s63, 1024
    buffer_store_dwordx4 v[148:151], v11, s[32:35], s63 offen sc1
    s_add_u32 s63, s63, 1024
    s_add_u32 m0, s69, 13312
    s_nop 0
    buffer_load_dwordx4 v24, s[72:75], s68 offen nt lds
    s_add_u32 s68, s68, 98304
    s_add_u32 m0, s69, 14336
    s_nop 0
    buffer_load_dwordx4 v23, s[72:75], s68 offen nt lds
    s_add_u32 s68, s68, 98304
    s_bfe_u32 s44, s62, 0x20004
    s_mul_i32 s44, s44, 458752
    s_lshr_b32 s45, s62, 6
    s_lshl_b32 s45, s45, 16
    s_add_u32 s44, s44, s45
    s_and_b32 s45, s62, 8
    s_lshl_b32 s45, s45, 15
    s_add_u32 s44, s44, s45
    s_and_b32 s45, s62, 7
    s_lshl_b32 s45, s45, 13
    s_add_u32 s44, s44, s45
    s_add_u32 s45, s44, s46
    buffer_load_dwordx4 v[164:167], v21, s[20:23], s45 offen nt
    s_add_u32 s62, s62, 1
    s_bfe_u32 s44, s62, 0x20004
    s_mul_i32 s44, s44, 458752
    s_lshr_b32 s45, s62, 6
    s_lshl_b32 s45, s45, 16
    s_add_u32 s44, s44, s45
    s_and_b32 s45, s62, 8
    s_lshl_b32 s45, s45, 15
    s_add_u32 s44, s44, s45
    s_and_b32 s45, s62, 7
    s_lshl_b32 s45, s45, 13
    s_add_u32 s44, s44, s45
    s_add_u32 s45, s44, s46
    buffer_load_dwordx4 v[168:171], v20, s[20:23], s45 offen nt
    s_add_u32 s62, s62, 1
    s_bfe_u32 s44, s62, 0x20004
    s_mul_i32 s44, s44, 458752
    s_lshr_b32 s45, s62, 6
    s_lshl_b32 s45, s45, 16
    s_add_u32 s44, s44, s45
    s_and_b32 s45, s62, 8
    s_lshl_b32 s45, s45, 15
    s_add_u32 s44, s44, s45
    s_and_b32 s45, s62, 7
    s_lshl_b32 s45, s45, 13
    s_add_u32 s44, s44, s45
    s_add_u32 s45, s44, s46
    buffer_load_dwordx4 v[172:175], v21, s[20:23], s45 offen nt
    s_add_u32 s62, s62, 1
    s_bfe_u32 s44, s62, 0x20004
    s_mul_i32 s44, s44, 458752
    s_lshr_b32 s45, s62, 6
    s_lshl_b32 s45, s45, 16
    s_add_u32 s44, s44, s45
    s_and_b32 s45, s62, 8
    s_lshl_b32 s45, s45, 15
    s_add_u32 s44, s44, s45
    s_and_b32 s45, s62, 7
    s_lshl_b32 s45, s45, 13
    s_add_u32 s44, s44, s45
    s_add_u32 s45, s44, s46
    buffer_load_dwordx4 v[176:179], v20, s[20:23], s45 offen nt
    s_add_u32 s62, s62, 1
    s_mov_b32 s3, 4096
    buffer_store_dwordx4 v[200:203], v11, s[96:99], s3 offen offset:3072 sc1
    s_barrier
    s_waitcnt vmcnt(12)
    buffer_store_dwordx4 v[152:155], v11, s[32:35], s63 offen sc1
    s_add_u32 s63, s63, 1024
    buffer_store_dwordx4 v[156:159], v11, s[32:35], s63 offen sc1
    s_add_u32 s63, s63, 1024
    buffer_store_dwordx4 v[160:163], v11, s[32:35], s63 offen sc1
    s_add_u32 s63, s63, 1024
    s_add_u32 m0, s69, 15360
    s_nop 0
    buffer_load_dwordx4 v24, s[72:75], s68 offen nt lds
    s_add_u32 s68, s68, 98304
    s_bfe_u32 s44, s62, 0x20004
    s_mul_i32 s44, s44, 458752
    s_lshr_b32 s45, s62, 6
    s_lshl_b32 s45, s45, 16
    s_add_u32 s44, s44, s45
    s_and_b32 s45, s62, 8
    s_lshl_b32 s45, s45, 15
    s_add_u32 s44, s44, s45
    s_and_b32 s45, s62, 7
    s_lshl_b32 s45, s45, 13
    s_add_u32 s44, s44, s45
    s_add_u32 s45, s44, s46
    buffer_load_dwordx4 v[180:183], v21, s[20:23], s45 offen nt
    s_add_u32 s62, s62, 1
    buffer_load_dwordx4 v[184:187], v22, s[20:23], s64 offen nt
    s_add_u32 s64, s64, 32768
    buffer_load_dwordx4 v[188:191], v22, s[20:23], s64 offen nt
    s_add_u32 s64, s64, 32768
    s_barrier
    s_waitcnt vmcnt(8)
    buffer_store_dwordx4 v[164:167], v11, s[32:35], s63 offen sc1
    s_add_u32 s63, s63, 1024
    buffer_store_dwordx4 v[168:171], v11, s[32:35], s63 offen sc1
    s_add_u32 s63, s63, 1024
    buffer_store_dwordx4 v[172:175], v11, s[32:35], s63 offen sc1
    s_add_u32 s63, s63, 1024
    buffer_store_dwordx4 v[176:179], v11, s[32:35], s63 offen sc1
    s_add_u32 s63, s63, 1024
    s_barrier
    s_waitcnt vmcnt(4)
    buffer_store_dwordx4 v[180:183], v11, s[32:35], s63 offen sc1
    s_add_u32 s63, s63, 1024
    buffer_store_dwordx4 v[184:187], v11, s[32:35], s65 offen sc1
    s_add_u32 s65, s65, 1024
    buffer_store_dwordx4 v[188:191], v11, s[32:35], s65 offen sc1
    s_add_u32 s65, s65, 1024
    s_barrier
    s_setprio 2
    ds_read_b64_tr_b16 v[128:129], v25 offset:0
    ds_read_b64_tr_b16 v[130:131], v25 offset:512
    ds_read_b64_tr_b16 v[132:133], v26 offset:0
    ds_read_b64_tr_b16 v[134:135], v26 offset:512
    ds_read_b64_tr_b16 v[136:137], v25 offset:4096
    ds_read_b64_tr_b16 v[138:139], v25 offset:4608
    ds_read_b64_tr_b16 v[140:141], v26 offset:4096
    ds_read_b64_tr_b16 v[142:143], v26 offset:4608
    ds_read_b64_tr_b16 v[144:145], v25 offset:8192
    ds_read_b64_tr_b16 v[146:147], v25 offset:8704
    ds_read_b64_tr_b16 v[148:149], v26 offset:8192
    ds_read_b64_tr_b16 v[150:151], v26 offset:8704
    ds_read_b64_tr_b16 v[152:153], v25 offset:12288
    ds_read_b64_tr_b16 v[154:155], v25 offset:12800
    ds_read_b64_tr_b16 v[156:157], v26 offset:12288
    ds_read_b64_tr_b16 v[158:159], v26 offset:12800
    ds_read_b64_tr_b16 v[160:161], v25 offset:16384
    ds_read_b64_tr_b16 v[162:163], v25 offset:16896
    ds_read_b64_tr_b16 v[164:165], v26 offset:16384
    ds_read_b64_tr_b16 v[166:167], v26 offset:16896
    ds_read_b64_tr_b16 v[168:169], v25 offset:20480
    ds_read_b64_tr_b16 v[170:171], v25 offset:20992
    ds_read_b64_tr_b16 v[172:173], v26 offset:20480
    ds_read_b64_tr_b16 v[174:175], v26 offset:20992
    ds_read_b64_tr_b16 v[176:177], v25 offset:24576
    ds_read_b64_tr_b16 v[178:179], v25 offset:25088
    ds_read_b64_tr_b16 v[180:181], v26 offset:24576
    ds_read_b64_tr_b16 v[182:183], v26 offset:25088
    ds_read_b64_tr_b16 v[184:185], v25 offset:28672
    ds_read_b64_tr_b16 v[186:187], v25 offset:29184
    ds_read_b64_tr_b16 v[188:189], v26 offset:28672
    ds_read_b64_tr_b16 v[190:191], v26 offset:29184
    s_waitcnt lgkmcnt(15)
    v_mfma_f32_16x16x32_bf16 v[192:195], v[128:131], v[96:99], 0
    v_mfma_f32_16x16x32_bf16 v[196:199], v[132:135], v[96:99], 0
    s_waitcnt lgkmcnt(15)
    v_mfma_f32_16x16x32_bf16 v[192:195], v[136:139], v[100:103], v[192:195]
    v_mfma_f32_16x16x32_bf16 v[196:199], v[140:143], v[100:103], v[196:199]
    s_waitcnt lgkmcnt(15)
    v_mfma_f32_16x16x32_bf16 v[192:195], v[144:147], v[104:107], v[192:195]
    v_mfma_f32_16x16x32_bf16 v[196:199], v[148:151], v[104:107], v[196:199]
    s_waitcnt lgkmcnt(15)
    v_mfma_f32_16x16x32_bf16 v[192:195], v[152:155], v[108:111], v[192:195]
    v_mfma_f32_16x16x32_bf16 v[196:199], v[156:159], v[108:111], v[196:199]
    s_waitcnt lgkmcnt(12)
    v_mfma_f32_16x16x32_bf16 v[192:195], v[160:163], v[112:115], v[192:195]
    v_mfma_f32_16x16x32_bf16 v[196:199], v[164:167], v[112:115], v[196:199]
    s_waitcnt lgkmcnt(8)
    v_mfma_f32_16x16x32_bf16 v[192:195], v[168:171], v[116:119], v[192:195]
    v_mfma_f32_16x16x32_bf16 v[196:199], v[172:175], v[116:119], v[196:199]
    s_waitcnt lgkmcnt(4)
    v_mfma_f32_16x16x32_bf16 v[192:195], v[176:179], v[120:123], v[192:195]
    v_mfma_f32_16x16x32_bf16 v[196:199], v[180:183], v[120:123], v[196:199]
    s_waitcnt lgkmcnt(0)
    v_mfma_f32_16x16x32_bf16 v[192:195], v[184:187], v[124:127], v[192:195]
    v_mfma_f32_16x16x32_bf16 v[196:199], v[188:191], v[124:127], v[196:199]
    s_nop 6
    buffer_store_dwordx4 v[192:195], v27, s[80:83], s51 offen offset:0 sc1
    buffer_store_dwordx4 v[196:199], v27, s[80:83], s51 offen offset:64 sc1
    s_setprio 0
    s_add_u32 s32, s6, 62914560
    s_addc_u32 s33, s7, 0
    s_mov_b32 s34, 786432
    s_mov_b32 s35, 0x20000
    s_barrier
    s_lshl_b32 s3, s2, 1
    s_add_u32 s3, s3, s48
    s_lshl_b32 s44, s3, 2
    s_waitcnt vmcnt(0)
    v_mov_b32 v1, s100
    v_mov_b32 v3, 0
    s_mov_b64 exec, 1
    buffer_store_dword v1, v3, s[32:35], s44 offen sc1
    s_mov_b64 exec, -1
    s_getpc_b64 s[64:65]
.Lk3_here_31:
    s_sub_u32 s64, s64, .Lk3_here_31-k3_attn_kernel
    s_subb_u32 s65, s65, 0
    s_mov_b32 s66, .Lk3_end_1-k3_attn_kernel
    s_mov_b32 s67, 0x20000
    s_lshr_b32 s3, s2, 3
    s_lshl_b32 s3, s3, 1
    s_add_u32 s3, s3, s48
    s_lshl_b32 s3, s3, 10
    buffer_load_dwordx4 v[32:35], v11, s[64:67], s3 offen
    s_barrier
.Lk3_t14_30:
    s_add_u32 s32, s6, 62914560
    s_addc_u32 s33, s7, 0
    s_mov_b32 s34, 786432
    s_mov_b32 s35, 0x20000
    s_load_dwordx2 s[8:9], s[0:1], 0
    buffer_load_dwordx4 v[32:35], v11, s[32:35], 0 offen sc1
    buffer_load_dwordx4 v[36:39], v11, s[32:35], 0 offen offset:1024 sc1
    s_and_b32 s14, s2, 7
    s_lshr_b32 s15, s2, 3
    s_lshr_b32 s12, s14, 1
    s_lshl_b32 s12, s12, 2
    s_and_b32 s3, s15, 3
    s_add_u32 s12, s12, s3
    s_and_b32 s13, s14, 1
    s_lshl_b32 s13, s13, 3
    s_lshr_b32 s3, s15, 2
    s_add_u32 s13, s13, s3
    s_lshl_b32 s37, s12, 18
    s_sub_u32 s42, s95, 4
    v_lshlrev_b32 v11, 4, v2
    s_mul_i32 s43, s42, 65536
    s_add_u32 s46, s37, s43
    s_add_u32 s47, s46, 32768
    s_lshl_b32 s45, s42, 12
    s_add_u32 s45, s45, 0
    s_lshl_b32 s44, s42, 11
    s_lshl_b32 s48, s13, 17
    s_add_u32 s48, s48, s44
    s_add_u32 s16, s6, 35651584
    s_addc_u32 s17, s7, 0
    s_mov_b32 s18, 2097152
    s_mov_b32 s19, 0x20000
    s_add_u32 s20, s6, 5242880
    s_addc_u32 s21, s7, 0
    s_mov_b32 s22, 4194304
    s_mov_b32 s23, 0x20000
    s_lshl_b32 s74, s13, 8
    v_lshrrev_b32 v12, 3, v2
    v_mul_u32_u24 v12, 1920, v12
    v_add_u32 v12, v12, v11
    v_lshlrev_b32 v10, 4, v2
    s_lshl_b32 s50, s12, 18
    s_lshl_b32 s3, s42, 16
    s_add_u32 s50, s50, s3
    s_lshl_b32 s3, s13, 7
    s_add_u32 s50, s50, s3
    s_lshl_b32 s51, s42, 12
    s_add_u32 s51, s51, 81920
    s_lshl_b32 s63, s12, 10
    s_add_u32 s63, s63, 98304
    s_waitcnt lgkmcnt(0)
    s_mov_b32 s24, s8
    s_mov_b32 s25, s9
    s_mov_b32 s26, 4194304
    s_mov_b32 s27, 0x20000
    s_add_u32 m0, s51, 0
    s_nop 0
    buffer_load_dwordx4 v12, s[24:27], s50 offen lds
    s_add_u32 s50, s50, 16384
    s_add_u32 m0, s51, 1024
    s_nop 0
    buffer_load_dwordx4 v12, s[24:27], s50 offen lds
    s_add_u32 s50, s50, 16384
    s_add_u32 m0, s51, 2048
    s_nop 0
    buffer_load_dwordx4 v12, s[24:27], s50 offen lds
    s_add_u32 s50, s50, 16384
    s_add_u32 m0, s51, 3072
    s_nop 0
    buffer_load_dwordx4 v12, s[24:27], s50 offen lds
    s_waitcnt vmcnt(14)
    s_barrier
    s_waitcnt vmcnt(4)
    v_xor_b32 v32, s100, v32
    v_bitop3_b32 v32, v32, v33, s100 bitop3:0xf6
    v_bitop3_b32 v32, v32, v34, s100 bitop3:0xf6
    v_bitop3_b32 v32, v32, v35, s100 bitop3:0xf6
    v_bitop3_b32 v32, v32, v36, s100 bitop3:0xf6
    v_bitop3_b32 v32, v32, v37, s100 bitop3:0xf6
    v_bitop3_b32 v32, v32, v38, s100 bitop3:0xf6
    v_bitop3_b32 v32, v32, v39, s100 bitop3:0xf6
    v_cmp_ne_u32 vcc, 0, v32
    s_cbranch_vccnz .Lk3_late_32
    s_add_u32 s43, s44, 16384
    s_add_u32 m0, s43, 0
    s_nop 0
    buffer_load_dwordx4 v11, s[16:19], s48 offen offset:0 sc1 lds
    buffer_load_dwordx4 v11, s[16:19], s48 offen offset:1024 sc1 lds
    s_add_u32 s48, s48, 8192
    s_add_u32 s43, s44, 24576
    s_add_u32 m0, s43, 0
    s_nop 0
    buffer_load_dwordx4 v11, s[16:19], s48 offen offset:0 sc1 lds
    buffer_load_dwordx4 v11, s[16:19], s48 offen offset:1024 sc1 lds
    s_add_u32 s48, s48, 8192
    s_add_u32 s43, s44, 32768
    s_add_u32 m0, s43, 0
    s_nop 0
    buffer_load_dwordx4 v11, s[16:19], s48 offen offset:0 sc1 lds
    buffer_load_dwordx4 v11, s[16:19], s48 offen offset:1024 sc1 lds
    s_add_u32 s48, s48, 8192
    s_add_u32 s43, s44, 40960
    s_add_u32 m0, s43, 0
    s_nop 0
    buffer_load_dwordx4 v11, s[16:19], s48 offen offset:0 sc1 lds
    buffer_load_dwordx4 v11, s[16:19], s48 offen offset:1024 sc1 lds
    s_add_u32 s48, s48, 8192
    s_add_u32 s43, s44, 49152
    s_add_u32 m0, s43, 0
    s_nop 0
    buffer_load_dwordx4 v11, s[16:19], s48 offen offset:0 sc1 lds
    buffer_load_dwordx4 v11, s[16:19], s48 offen offset:1024 sc1 lds
    s_add_u32 s48, s48, 8192
    s_barrier
    s_add_u32 s43, s44, 57344
    s_add_u32 m0, s43, 0
    s_nop 0
    buffer_load_dwordx4 v11, s[16:19], s48 offen offset:0 sc1 lds
    buffer_load_dwordx4 v11, s[16:19], s48 offen offset:1024 sc1 lds
    s_add_u32 s48, s48, 8192
    s_add_u32 s43, s44, 65536
    s_add_u32 m0, s43, 0
    s_nop 0
    buffer_load_dwordx4 v11, s[16:19], s48 offen offset:0 sc1 lds
    buffer_load_dwordx4 v11, s[16:19], s48 offen offset:1024 sc1 lds
    s_add_u32 s48, s48, 8192
    s_add_u32 s43, s44, 73728
    s_add_u32 m0, s43, 0
    s_nop 0
    buffer_load_dwordx4 v11, s[16:19], s48 offen offset:0 sc1 lds
    buffer_load_dwordx4 v11, s[16:19], s48 offen offset:1024 sc1 lds
    s_add_u32 s48, s48, 8192
    s_add_u32 s43, s44, 0
    s_add_u32 m0, s43, 0
    s_nop 0
    buffer_load_dwordx4 v11, s[16:19], s48 offen offset:0 sc1 lds
    buffer_load_dwordx4 v11, s[16:19], s48 offen offset:1024 sc1 lds
    s_add_u32 s48, s48, 8192
    s_add_u32 s43, s44, 8192
    s_add_u32 m0, s43, 0
    s_nop 0
    buffer_load_dwordx4 v11, s[16:19], s48 offen offset:0 sc1 lds
    buffer_load_dwordx4 v11, s[16:19], s48 offen offset:1024 sc1 lds
    s_add_u32 s48, s48, 8192
    s_barrier
.Lk3_j3_34:
    v_and_b32 v3, 15, v2
    v_lshrrev_b32 v4, 4, v2
    v_lshlrev_b32 v5, 12, v3
    v_sub_u32 v5, 16384, v5
    v_lshl_add_u32 v5, v4, 4, v5
    v_mov_b32 v6, 0x7ff00000
    v_cmp_gt_u32 vcc, 2, v3
    s_nop 1
    v_cndmask_b32 v5, v6, v5, vcc
    s_lshr_b32 s58, s2, 4
    s_lshl_b32 s65, s58, 8
    v_mul_u32_u24 v13, 14336, v3
    v_lshl_add_u32 v13, v4, 4, v13
    v_cndmask_b32 v13, v6, v13, vcc
    v_mul_u32_u24 v14, 1792, v4
    v_lshl_add_u32 v14, v3, 4, v14
    v_lshrrev_b32 v7, 2, v2
    v_and_b32 v7, 3, v7
    v_and_b32 v8, 3, v2
    v_lshlrev_b32 v15, 8, v4
    v_lshl_add_u32 v15, v7, 6, v15
    v_lshl_add_u32 v15, v8, 3, v15
    v_and_b32 v7, 1, v4
    v_lshl_add_u32 v15, v7, 5, v15
    s_lshl_b32 s54, s42, 13
    s_add_u32 s54, s54, 32768
    s_and_b32 s3, s42, 0
    s_mul_i32 s3, s3, 24576
    s_add_u32 s54, s54, s3
    v_add_u32 v15, s54, v15
    v_xor_b32 v16, 32, v15
    s_and_b32 s57, s2, 15
    s_lshl_b32 s60, s57, 4
    s_add_u32 s60, s60, s58
    s_lshl_b32 s62, s60, 2
    s_mul_i32 s60, s60, 28672
    s_lshl_b32 s3, s42, 9
    s_add_u32 s60, s60, s3
    s_lshl_b32 s61, s57, 5
    s_add_u32 s61, s61, s58
    s_mul_i32 s61, s61, 896
    s_lshl_b32 s3, s42, 8
    s_add_u32 s61, s61, s3
    s_add_u32 s62, s62, s42
    s_lshl_b32 s62, s62, 4
    s_add_u32 s62, s62, 294912
    v_cmp_eq_u32 vcc, 0, v3
    s_nop 1
    v_cndmask_b32 v18, 0, 1.0, vcc
    s_add_u32 s28, s6, 0
    s_addc_u32 s29, s7, 0
    s_mov_b32 s30, 98304
    s_mov_b32 s31, 0x20000
    s_add_u32 s24, s6, 37748736
    s_addc_u32 s25, s7, 0
    s_mov_b32 s26, 7340032
    s_mov_b32 s27, 0x20000
    s_waitcnt vmcnt(0)
    s_barrier
    s_add_u32 s3, s65, 0
    buffer_load_dwordx4 v[48:51], v5, s[28:31], s3 offen sc1
    buffer_load_dwordx4 v[52:55], v5, s[28:31], s3 offen offset:64 sc1
    s_add_u32 s3, s65, 24576
    buffer_load_dwordx4 v[56:59], v5, s[28:31], s3 offen sc1
    buffer_load_dwordx4 v[60:63], v5, s[28:31], s3 offen offset:64 sc1
    s_add_u32 s3, s65, 49152
    buffer_load_dwordx4 v[64:67], v5, s[28:31], s3 offen sc1
    buffer_load_dwordx4 v[68:71], v5, s[28:31], s3 offen offset:64 sc1
    s_add_u32 s3, s65, 73728
    buffer_load_dwordx4 v[72:75], v5, s[28:31], s3 offen sc1
    buffer_load_dwordx4 v[76:79], v5, s[28:31], s3 offen offset:64 sc1
    s_add_u32 s3, s65, 128
    buffer_load_dwordx4 v[80:83], v5, s[28:31], s3 offen sc1
    buffer_load_dwordx4 v[84:87], v5, s[28:31], s3 offen offset:64 sc1
    s_add_u32 s3, s65, 24704
    buffer_load_dwordx4 v[88:91], v5, s[28:31], s3 offen sc1
    buffer_load_dwordx4 v[92:95], v5, s[28:31], s3 offen offset:64 sc1
    s_add_u32 s3, s65, 49280
    buffer_load_dwordx4 v[96:99], v5, s[28:31], s3 offen sc1
    buffer_load_dwordx4 v[100:103], v5, s[28:31], s3 offen offset:64 sc1
    s_add_u32 s3, s65, 73856
    buffer_load_dwordx4 v[104:107], v5, s[28:31], s3 offen sc1
    buffer_load_dwordx4 v[108:111], v5, s[28:31], s3 offen offset:64 sc1
    v_bfe_u32 v20, v2, 4, 1
    v_lshlrev_b32 v21, 13, v20
    v_lshl_add_u32 v21, v3, 4, v21
    v_lshlrev_b32 v22, 8, v20
    v_lshl_add_u32 v22, v3, 4, v22
    v_cvt_f32_u32 v20, v20
    s_add_u32 s3, s74, 8192
    buffer_load_dwordx4 v[168:171], v21, s[28:31], s3 offen sc1
    s_add_u32 s3, s74, 32768
    buffer_load_dwordx4 v[172:175], v21, s[28:31], s3 offen sc1
    s_add_u32 s3, s74, 57344
    buffer_load_dwordx4 v[176:179], v21, s[28:31], s3 offen sc1
    s_add_u32 s3, s74, 81920
    buffer_load_dwordx4 v[180:183], v21, s[28:31], s3 offen sc1
    s_barrier
    s_cmp_lg_u32 s42, 0
    s_cbranch_scc1 .Lk3_ps_39
    buffer_load_dword v9, v10, s[32:35], s63 offen sc1
.Lk3_ps_39:
    s_add_u32 s43, s44, 98304
    s_add_u32 m0, s43, 0
    s_nop 0
    buffer_load_dwordx4 v11, s[16:19], s48 offen offset:0 sc1 lds
    buffer_load_dwordx4 v11, s[16:19], s48 offen offset:1024 sc1 lds
    s_add_u32 s48, s48, 8192
    s_add_u32 s43, s44, 106496
    s_add_u32 m0, s43, 0
    s_nop 0
    buffer_load_dwordx4 v11, s[16:19], s48 offen offset:0 sc1 lds
    buffer_load_dwordx4 v11, s[16:19], s48 offen offset:1024 sc1 lds
    s_add_u32 s48, s48, 8192
    s_add_u32 s43, s44, 114688
    s_add_u32 m0, s43, 0
    s_nop 0
    buffer_load_dwordx4 v11, s[16:19], s48 offen offset:0 sc1 lds
    buffer_load_dwordx4 v11, s[16:19], s48 offen offset:1024 sc1 lds
    s_add_u32 s48, s48, 8192
    s_add_u32 s43, s44, 122880
    s_add_u32 m0, s43, 0
    s_nop 0
    buffer_load_dwordx4 v11, s[16:19], s48 offen offset:0 sc1 lds
    buffer_load_dwordx4 v11, s[16:19], s48 offen offset:1024 sc1 lds
    s_add_u32 s48, s48, 8192
    s_add_u32 s43, s44, 131072
    s_add_u32 m0, s43, 0
    s_nop 0
    buffer_load_dwordx4 v11, s[16:19], s48 offen offset:0 sc1 lds
    buffer_load_dwordx4 v11, s[16:19], s48 offen offset:1024 sc1 lds
    s_add_u32 s48, s48, 8192
    s_add_u32 s43, s44, 139264
    s_add_u32 m0, s43, 0
    s_nop 0
    buffer_load_dwordx4 v11, s[16:19], s48 offen offset:0 sc1 lds
    buffer_load_dwordx4 v11, s[16:19], s48 offen offset:1024 sc1 lds
    s_add_u32 s48, s48, 8192
    s_cmp_lg_u32 s42, 0
    s_cbranch_scc1 .Lk3_po_38
    s_waitcnt vmcnt(12)
    v_cmp_ne_u32 vcc, s100, v9
    s_cbranch_vccz .Lk3_po_38
    s_mov_b32 s59, 0x100000
.Lk3_pl_37:
    buffer_load_dword v9, v10, s[32:35], s63 offen sc1
    s_waitcnt vmcnt(0)
    v_cmp_ne_u32 vcc, s100, v9
    s_cbranch_vccz .Lk3_po_38
    s_sub_u32 s59, s59, 1
    s_cbranch_scc0 .Lk3_pl_37
.Lk3_po_38:
    s_barrier
    s_add_u32 s45, s45, 65536
    s_waitcnt vmcnt(0)
    v_add_f32 v168, v168, v172
    v_add_f32 v176, v176, v180
    v_add_f32 v169, v169, v173
    v_add_f32 v177, v177, v181
    v_add_f32 v170, v170, v174
    v_add_f32 v178, v178, v182
    v_add_f32 v171, v171, v175
    v_add_f32 v179, v179, v183
    v_add_f32 v168, v168, v176
    v_add_f32 v169, v169, v177
    v_add_f32 v170, v170, v178
    v_add_f32 v171, v171, v179
    v_cvt_pk_bf16_f32 v172, v168, v169
    v_lshlrev_b32 v168, 16, v172
    v_and_b32 v169, 0xffff0000, v172
    v_cvt_pk_bf16_f32 v172, v170, v171
    v_lshlrev_b32 v170, 16, v172
    v_and_b32 v171, 0xffff0000, v172
    v_add_f32 v168, v168, v20
    v_add_f32 v169, v169, v20
    v_add_f32 v170, v170, v20
    v_add_f32 v171, v171, v20
    v_cvt_pk_bf16_f32 v172, v168, v169
    v_lshlrev_b32 v168, 16, v172
    v_and_b32 v169, 0xffff0000, v172
    v_cvt_pk_bf16_f32 v172, v170, v171
    v_lshlrev_b32 v170, 16, v172
    v_and_b32 v171, 0xffff0000, v172
    v_add_u32 v22, 163328, v22
    ds_write_b128 v22, v[168:171]
    v_add_f32 v48, v48, v56
    v_add_f32 v64, v64, v72
    v_add_f32 v49, v49, v57
    v_add_f32 v65, v65, v73
    v_add_f32 v50, v50, v58
    v_add_f32 v66, v66, v74
    v_add_f32 v51, v51, v59
    v_add_f32 v67, v67, v75
    v_add_f32 v52, v52, v60
    v_add_f32 v68, v68, v76
    v_add_f32 v53, v53, v61
    v_add_f32 v69, v69, v77
    v_add_f32 v54, v54, v62
    v_add_f32 v70, v70, v78
    v_add_f32 v55, v55, v63
    v_add_f32 v71, v71, v79
    v_add_f32 v48, v48, v64
    v_add_f32 v49, v49, v65
    v_add_f32 v50, v50, v66
    v_add_f32 v51, v51, v67
    v_add_f32 v52, v52, v68
    v_add_f32 v53, v53, v69
    v_add_f32 v54, v54, v70
    v_add_f32 v55, v55, v71
    v_cvt_pk_bf16_f32 v56, v48, v49
    v_lshlrev_b32 v48, 16, v56
    v_and_b32 v49, 0xffff0000, v56
    v_cvt_pk_bf16_f32 v56, v50, v51
    v_lshlrev_b32 v50, 16, v56
    v_and_b32 v51, 0xffff0000, v56
    v_cvt_pk_bf16_f32 v56, v52, v53
    v_lshlrev_b32 v52, 16, v56
    v_and_b32 v53, 0xffff0000, v56
    v_cvt_pk_bf16_f32 v56, v54, v55
    v_lshlrev_b32 v54, 16, v56
    v_and_b32 v55, 0xffff0000, v56
    v_add_f32 v48, v48, v18
    v_add_f32 v49, v49, v18
    v_add_f32 v50, v50, v18
    v_add_f32 v51, v51, v18
    v_add_f32 v52, v52, v18
    v_add_f32 v53, v53, v18
    v_add_f32 v54, v54, v18
    v_add_f32 v55, v55, v18
    v_cvt_pk_bf16_f32 v112, v48, v49
    v_cvt_pk_bf16_f32 v113, v50, v51
    v_cvt_pk_bf16_f32 v114, v52, v53
    v_cvt_pk_bf16_f32 v115, v54, v55
    v_add_f32 v80, v80, v88
    v_add_f32 v96, v96, v104
    v_add_f32 v81, v81, v89
    v_add_f32 v97, v97, v105
    v_add_f32 v82, v82, v90
    v_add_f32 v98, v98, v106
    v_add_f32 v83, v83, v91
    v_add_f32 v99, v99, v107
    v_add_f32 v84, v84, v92
    v_add_f32 v100, v100, v108
    v_add_f32 v85, v85, v93
    v_add_f32 v101, v101, v109
    v_add_f32 v86, v86, v94
    v_add_f32 v102, v102, v110
    v_add_f32 v87, v87, v95
    v_add_f32 v103, v103, v111
    v_add_f32 v80, v80, v96
    v_add_f32 v81, v81, v97
    v_add_f32 v82, v82, v98
    v_add_f32 v83, v83, v99
    v_add_f32 v84, v84, v100
    v_add_f32 v85, v85, v101
    v_add_f32 v86, v86, v102
    v_add_f32 v87, v87, v103
    v_cvt_pk_bf16_f32 v88, v80, v81
    v_lshlrev_b32 v80, 16, v88
    v_and_b32 v81, 0xffff0000, v88
    v_cvt_pk_bf16_f32 v88, v82, v83
    v_lshlrev_b32 v82, 16, v88
    v_and_b32 v83, 0xffff0000, v88
    v_cvt_pk_bf16_f32 v88, v84, v85
    v_lshlrev_b32 v84, 16, v88
    v_and_b32 v85, 0xffff0000, v88
    v_cvt_pk_bf16_f32 v88, v86, v87
    v_lshlrev_b32 v86, 16, v88
    v_and_b32 v87, 0xffff0000, v88
    v_add_f32 v80, v80, v18
    v_add_f32 v81, v81, v18
    v_add_f32 v82, v82, v18
    v_add_f32 v83, v83, v18
    v_add_f32 v84, v84, v18
    v_add_f32 v85, v85, v18
    v_add_f32 v86, v86, v18
    v_add_f32 v87, v87, v18
    v_cvt_pk_bf16_f32 v116, v80, v81
    v_cvt_pk_bf16_f32 v117, v82, v83
    v_cvt_pk_bf16_f32 v118, v84, v85
    v_cvt_pk_bf16_f32 v119, v86, v87
    s_waitcnt lgkmcnt(0)
    s_barrier
    s_add_u32 m0, s54, 0
    s_add_u32 s3, s60, 0
    buffer_load_dwordx4 v14, s[24:27], s3 offen sc1 lds
    s_add_u32 m0, s54, 1024
    s_add_u32 s3, s60, 7168
    buffer_load_dwordx4 v14, s[24:27], s3 offen sc1 lds
    s_add_u32 m0, s54, 2048
    s_add_u32 s3, s60, 14336
    buffer_load_dwordx4 v14, s[24:27], s3 offen sc1 lds
    s_add_u32 m0, s54, 3072
    s_add_u32 s3, s60, 21504
    buffer_load_dwordx4 v14, s[24:27], s3 offen sc1 lds
    s_add_u32 m0, s54, 4096
    s_add_u32 s3, s60, 256
    buffer_load_dwordx4 v14, s[24:27], s3 offen sc1 lds
    s_add_u32 m0, s54, 5120
    s_add_u32 s3, s60, 7424
    buffer_load_dwordx4 v14, s[24:27], s3 offen sc1 lds
    s_add_u32 m0, s54, 6144
    s_add_u32 s3, s60, 14592
    buffer_load_dwordx4 v14, s[24:27], s3 offen sc1 lds
    s_add_u32 m0, s54, 7168
    s_add_u32 s3, s60, 21760
    buffer_load_dwordx4 v14, s[24:27], s3 offen sc1 lds
    s_and_b32 s14, s2, 7
    s_lshr_b32 s15, s2, 3
    s_and_b32 s12, s14, 1
    s_lshl_b32 s12, s12, 3
    s_and_b32 s3, s15, 7
    s_add_u32 s12, s12, s3
    s_lshr_b32 s13, s14, 1
    s_lshl_b32 s13, s13, 2
    s_lshr_b32 s3, s15, 3
    s_add_u32 s13, s13, s3
    s_lshl_b32 s37, s12, 18
    s_sub_u32 s42, s95, 4
    v_lshlrev_b32 v11, 4, v2
    s_mul_i32 s43, s42, 65536
    s_add_u32 s46, s37, s43
    s_add_u32 s47, s46, 32768
    s_lshl_b32 s45, s42, 12
    s_add_u32 s45, s45, 28672
    s_mul_i32 s44, s42, 7168
    s_mul_i32 s48, s13, 458752
    s_add_u32 s48, s48, s44
    s_lshl_b32 s63, s12, 10
    s_add_u32 s63, s63, 196608
    s_lshl_b32 s64, s13, 10
    s_add_u32 s64, s64, 294912
    s_add_u32 s20, s6, 13631488
    s_addc_u32 s21, s7, 0
    s_mov_b32 s22, 4194304
    s_mov_b32 s23, 0x20000
    s_add_u32 s28, s6, 52428800
    s_addc_u32 s29, s7, 0
    s_mov_b32 s30, 458752
    s_mov_b32 s31, 0x20000
    s_waitcnt vmcnt(0)
    ds_read_b64_tr_b16 v[120:121], v15 offset:0
    ds_read_b64_tr_b16 v[122:123], v15 offset:1024
    ds_read_b64_tr_b16 v[124:125], v15 offset:2048
    ds_read_b64_tr_b16 v[126:127], v15 offset:3072
    ds_read_b64_tr_b16 v[128:129], v16 offset:0
    ds_read_b64_tr_b16 v[130:131], v16 offset:1024
    ds_read_b64_tr_b16 v[132:133], v16 offset:2048
    ds_read_b64_tr_b16 v[134:135], v16 offset:3072
    ds_read_b64_tr_b16 v[136:137], v15 offset:4096
    ds_read_b64_tr_b16 v[138:139], v15 offset:5120
    ds_read_b64_tr_b16 v[140:141], v15 offset:6144
    ds_read_b64_tr_b16 v[142:143], v15 offset:7168
    ds_read_b64_tr_b16 v[144:145], v16 offset:4096
    ds_read_b64_tr_b16 v[146:147], v16 offset:5120
    ds_read_b64_tr_b16 v[148:149], v16 offset:6144
    ds_read_b64_tr_b16 v[150:151], v16 offset:7168
    s_waitcnt lgkmcnt(12)
    v_mfma_f32_16x16x32_bf16 v[152:155], v[120:123], v[112:115], 0
    v_mfma_f32_16x16x32_bf16 v[152:155], v[124:127], v[116:119], v[152:155]
    s_waitcnt lgkmcnt(8)
    v_mfma_f32_16x16x32_bf16 v[156:159], v[128:131], v[112:115], 0
    v_mfma_f32_16x16x32_bf16 v[156:159], v[132:135], v[116:119], v[156:159]
    s_waitcnt lgkmcnt(4)
    v_mfma_f32_16x16x32_bf16 v[160:163], v[136:139], v[112:115], 0
    v_mfma_f32_16x16x32_bf16 v[160:163], v[140:143], v[116:119], v[160:163]
    s_waitcnt lgkmcnt(0)
    v_mfma_f32_16x16x32_bf16 v[164:167], v[144:147], v[112:115], 0
    v_mfma_f32_16x16x32_bf16 v[164:167], v[148:151], v[116:119], v[164:167]
    s_cmp_eq_u32 s42, 3
    s_cselect_b32 s3, 0x7ff00000, s61
    buffer_store_dwordx4 v[152:155], v13, s[28:31], s61 offen offset:0 sc1
    buffer_store_dwordx4 v[156:159], v13, s[28:31], s61 offen offset:64 sc1
    s_nop 0
    buffer_store_dwordx4 v[160:163], v13, s[28:31], s3 offen offset:128 sc1
    s_nop 1
    buffer_store_dwordx4 v[164:167], v13, s[28:31], s3 offen offset:192 sc1
    s_barrier
    s_cmp_lg_u32 s42, 0
    s_cbranch_scc1 .Lk3_ps_42
    buffer_load_dword v9, v10, s[32:35], s63 offen sc1
.Lk3_ps_42:
    s_add_u32 s43, s44, 45056
    s_add_u32 m0, s43, 0
    s_nop 0
    buffer_load_dwordx4 v11, s[24:27], s48 offen offset:0 sc1 lds
    buffer_load_dwordx4 v11, s[24:27], s48 offen offset:1024 sc1 lds
    buffer_load_dwordx4 v11, s[24:27], s48 offen offset:2048 sc1 lds
    buffer_load_dwordx4 v11, s[24:27], s48 offen offset:3072 sc1 lds
    s_add_u32 m0, s43, 4096
    s_add_u32 s3, s48, 4096
    buffer_load_dwordx4 v11, s[24:27], s3 offen offset:0 sc1 lds
    buffer_load_dwordx4 v11, s[24:27], s3 offen offset:1024 sc1 lds
    buffer_load_dwordx4 v11, s[24:27], s3 offen offset:2048 sc1 lds
    s_add_u32 s48, s48, 28672
    s_add_u32 s43, s44, 90112
    s_add_u32 m0, s43, 0
    s_nop 0
    buffer_load_dwordx4 v11, s[24:27], s48 offen offset:0 sc1 lds
    buffer_load_dwordx4 v11, s[24:27], s48 offen offset:1024 sc1 lds
    buffer_load_dwordx4 v11, s[24:27], s48 offen offset:2048 sc1 lds
    buffer_load_dwordx4 v11, s[24:27], s48 offen offset:3072 sc1 lds
    s_add_u32 m0, s43, 4096
    s_add_u32 s3, s48, 4096
    buffer_load_dwordx4 v11, s[24:27], s3 offen offset:0 sc1 lds
    buffer_load_dwordx4 v11, s[24:27], s3 offen offset:1024 sc1 lds
    buffer_load_dwordx4 v11, s[24:27], s3 offen offset:2048 sc1 lds
    s_add_u32 s48, s48, 28672
    s_cmp_lg_u32 s42, 0
    s_cbranch_scc1 .Lk3_po_41
    s_waitcnt vmcnt(14)
    v_cmp_ne_u32 vcc, s100, v9
    s_cbranch_vccz .Lk3_po_41
    s_mov_b32 s59, 0x100000
.Lk3_pl_40:
    buffer_load_dword v9, v10, s[32:35], s63 offen sc1
    s_waitcnt vmcnt(0)
    v_cmp_ne_u32 vcc, s100, v9
    s_cbranch_vccz .Lk3_po_41
    s_sub_u32 s59, s59, 1
    s_cbranch_scc0 .Lk3_pl_40
.Lk3_po_41:
    s_barrier
    s_add_u32 s43, s45, 45056
    s_add_u32 m0, s43, 0
    s_nop 0
    buffer_load_dwordx4 v11, s[20:23], s46 offen sc1 lds
    buffer_load_dwordx4 v11, s[20:23], s46 offen offset:1024 sc1 lds
    s_add_u32 s46, s46, 2048
    s_add_u32 m0, s43, 2048
    s_nop 0
    buffer_load_dwordx4 v11, s[20:23], s47 offen sc1 lds
    buffer_load_dwordx4 v11, s[20:23], s47 offen offset:1024 sc1 lds
    s_add_u32 s47, s47, 2048
    s_add_u32 s43, s45, 90112
    s_add_u32 m0, s43, 0
    s_nop 0
    buffer_load_dwordx4 v11, s[20:23], s46 offen sc1 lds
    buffer_load_dwordx4 v11, s[20:23], s46 offen offset:1024 sc1 lds
    s_add_u32 s46, s46, 2048
    s_add_u32 m0, s43, 2048
    s_nop 0
    buffer_load_dwordx4 v11, s[20:23], s47 offen sc1 lds
    buffer_load_dwordx4 v11, s[20:23], s47 offen offset:1024 sc1 lds
    s_add_u32 s47, s47, 2048
    s_add_u32 s16, s6, 524288
    s_addc_u32 s17, s7, 0
    s_mov_b32 s18, 524288
    s_mov_b32 s19, 0x20000
    s_mov_b32 s40, 0
    s_waitcnt vmcnt(4)
    s_barrier
    s_add_u32 s43, s45, 0
    s_add_u32 m0, s43, 0
    s_nop 0
    buffer_load_dwordx4 v11, s[20:23], s46 offen sc1 lds
    buffer_load_dwordx4 v11, s[20:23], s46 offen offset:1024 sc1 lds
    s_add_u32 s46, s46, 2048
    s_add_u32 m0, s43, 2048
    s_nop 0
    buffer_load_dwordx4 v11, s[20:23], s47 offen sc1 lds
    buffer_load_dwordx4 v11, s[20:23], s47 offen offset:1024 sc1 lds
    s_add_u32 s47, s47, 2048
    s_add_u32 s43, s44, 0
    s_add_u32 m0, s43, 0
    s_nop 0
    buffer_load_dwordx4 v11, s[24:27], s48 offen offset:0 sc1 lds
    buffer_load_dwordx4 v11, s[24:27], s48 offen offset:1024 sc1 lds
    buffer_load_dwordx4 v11, s[24:27], s48 offen offset:2048 sc1 lds
    buffer_load_dwordx4 v11, s[24:27], s48 offen offset:3072 sc1 lds
    s_add_u32 m0, s43, 4096
    s_add_u32 s3, s48, 4096
    buffer_load_dwordx4 v11, s[24:27], s3 offen offset:0 sc1 lds
    buffer_load_dwordx4 v11, s[24:27], s3 offen offset:1024 sc1 lds
    buffer_load_dwordx4 v11, s[24:27], s3 offen offset:2048 sc1 lds
    s_add_u32 s48, s48, 28672
    v_mov_b32 v1, s100
    v_mov_b32 v3, 0
    s_mov_b64 exec, 1
    buffer_store_dword v1, v3, s[32:35], s62 offen sc1
    s_mov_b64 exec, -1
    s_mov_b32 s40, 45056
    s_mov_b32 s41, 2
.Lk3_ld_43:
    s_waitcnt vmcnt(12)
    s_barrier
    s_add_u32 s43, s40, s45
    s_add_u32 m0, s43, 0
    s_nop 0
    buffer_load_dwordx4 v11, s[20:23], s46 offen sc1 lds
    buffer_load_dwordx4 v11, s[20:23], s46 offen offset:1024 sc1 lds
    s_add_u32 s46, s46, 2048
    s_add_u32 m0, s43, 2048
    s_nop 0
    buffer_load_dwordx4 v11, s[20:23], s47 offen sc1 lds
    buffer_load_dwordx4 v11, s[20:23], s47 offen offset:1024 sc1 lds
    s_add_u32 s47, s47, 2048
    s_add_u32 s43, s40, s44
    s_add_u32 m0, s43, 0
    s_nop 0
    buffer_load_dwordx4 v11, s[24:27], s48 offen offset:0 sc1 lds
    buffer_load_dwordx4 v11, s[24:27], s48 offen offset:1024 sc1 lds
    buffer_load_dwordx4 v11, s[24:27], s48 offen offset:2048 sc1 lds
    buffer_load_dwordx4 v11, s[24:27], s48 offen offset:3072 sc1 lds
    s_add_u32 m0, s43, 4096
    s_add_u32 s3, s48, 4096
    buffer_load_dwordx4 v11, s[24:27], s3 offen offset:0 sc1 lds
    buffer_load_dwordx4 v11, s[24:27], s3 offen offset:1024 sc1 lds
    buffer_load_dwordx4 v11, s[24:27], s3 offen offset:2048 sc1 lds
    s_add_u32 s48, s48, 28672
    s_add_u32 s40, s40, 45056
    s_cmp_eq_u32 s40, 135168
    s_cselect_b32 s40, 0, s40
    s_sub_u32 s41, s41, 1
    s_cmp_lg_u32 s41, 0
    s_cbranch_scc1 .Lk3_ld_43
    s_mov_b32 s41, 3
.Lk3_ld_44:
    s_waitcnt vmcnt(11)
    s_barrier
    s_add_u32 s43, s40, s45
    s_add_u32 m0, s43, 0
    s_nop 0
    buffer_load_dwordx4 v11, s[20:23], s46 offen sc1 lds
    buffer_load_dwordx4 v11, s[20:23], s46 offen offset:1024 sc1 lds
    s_add_u32 s46, s46, 2048
    s_add_u32 m0, s43, 2048
    s_nop 0
    buffer_load_dwordx4 v11, s[20:23], s47 offen sc1 lds
    buffer_load_dwordx4 v11, s[20:23], s47 offen offset:1024 sc1 lds
    s_add_u32 s47, s47, 2048
    s_add_u32 s43, s40, s44
    s_add_u32 m0, s43, 0
    s_nop 0
    buffer_load_dwordx4 v11, s[24:27], s48 offen offset:0 sc1 lds
    buffer_load_dwordx4 v11, s[24:27], s48 offen offset:1024 sc1 lds
    buffer_load_dwordx4 v11, s[24:27], s48 offen offset:2048 sc1 lds
    buffer_load_dwordx4 v11, s[24:27], s48 offen offset:3072 sc1 lds
    s_add_u32 m0, s43, 4096
    s_add_u32 s3, s48, 4096
    buffer_load_dwordx4 v11, s[24:27], s3 offen offset:0 sc1 lds
    buffer_load_dwordx4 v11, s[24:27], s3 offen offset:1024 sc1 lds
    buffer_load_dwordx4 v11, s[24:27], s3 offen offset:2048 sc1 lds
    s_add_u32 s48, s48, 28672
    s_add_u32 s40, s40, 45056
    s_cmp_eq_u32 s40, 135168
    s_cselect_b32 s40, 0, s40
    s_sub_u32 s41, s41, 1
    s_cmp_lg_u32 s41, 0
    s_cbranch_scc1 .Lk3_ld_44
    s_waitcnt vmcnt(11)
    s_barrier
    s_add_u32 s43, s40, s45
    s_add_u32 m0, s43, 0
    s_nop 0
    buffer_load_dwordx4 v11, s[20:23], s46 offen sc1 lds
    buffer_load_dwordx4 v11, s[20:23], s46 offen offset:1024 sc1 lds
    s_add_u32 s46, s46, 2048
    s_add_u32 m0, s43, 2048
    s_nop 0
    buffer_load_dwordx4 v11, s[20:23], s47 offen sc1 lds
    buffer_load_dwordx4 v11, s[20:23], s47 offen offset:1024 sc1 lds
    s_add_u32 s47, s47, 2048
    s_add_u32 s43, s40, s44
    s_add_u32 m0, s43, 0
    s_nop 0
    buffer_load_dwordx4 v11, s[24:27], s48 offen offset:0 sc1 lds
    buffer_load_dwordx4 v11, s[24:27], s48 offen offset:1024 sc1 lds
    buffer_load_dwordx4 v11, s[24:27], s48 offen offset:2048 sc1 lds
    buffer_load_dwordx4 v11, s[24:27], s48 offen offset:3072 sc1 lds
    s_add_u32 m0, s43, 4096
    s_add_u32 s3, s48, 4096
    buffer_load_dwordx4 v11, s[24:27], s3 offen offset:0 sc1 lds
    buffer_load_dwordx4 v11, s[24:27], s3 offen offset:1024 sc1 lds
    buffer_load_dwordx4 v11, s[24:27], s3 offen offset:2048 sc1 lds
    s_add_u32 s48, s48, 28672
    s_add_u32 s40, s40, 45056
    s_cmp_eq_u32 s40, 135168
    s_cselect_b32 s40, 0, s40
    buffer_load_dword v9, v10, s[32:35], s64 offen sc1
    s_add_u32 s63, s63, 294912
    buffer_load_dword v8, v10, s[32:35], s63 offen sc1
    s_waitcnt vmcnt(13)
    s_barrier
    s_add_u32 s43, s40, s45
    s_add_u32 m0, s43, 0
    s_nop 0
    buffer_load_dwordx4 v11, s[20:23], s46 offen sc1 lds
    buffer_load_dwordx4 v11, s[20:23], s46 offen offset:1024 sc1 lds
    s_add_u32 s46, s46, 2048
    s_add_u32 m0, s43, 2048
    s_nop 0
    buffer_load_dwordx4 v11, s[20:23], s47 offen sc1 lds
    buffer_load_dwordx4 v11, s[20:23], s47 offen offset:1024 sc1 lds
    s_add_u32 s47, s47, 2048
    s_add_u32 s43, s40, s44
    s_add_u32 m0, s43, 0
    s_nop 0
    buffer_load_dwordx4 v11, s[24:27], s48 offen offset:0 sc1 lds
    buffer_load_dwordx4 v11, s[24:27], s48 offen offset:1024 sc1 lds
    buffer_load_dwordx4 v11, s[24:27], s48 offen offset:2048 sc1 lds
    buffer_load_dwordx4 v11, s[24:27], s48 offen offset:3072 sc1 lds
    s_add_u32 m0, s43, 4096
    s_add_u32 s3, s48, 4096
    buffer_load_dwordx4 v11, s[24:27], s3 offen offset:0 sc1 lds
    buffer_load_dwordx4 v11, s[24:27], s3 offen offset:1024 sc1 lds
    buffer_load_dwordx4 v11, s[24:27], s3 offen offset:2048 sc1 lds
    s_add_u32 s48, s48, 28672
    s_add_u32 s40, s40, 45056
    s_cmp_eq_u32 s40, 135168
    s_cselect_b32 s40, 0, s40
    s_waitcnt vmcnt(13)
    s_barrier
    s_add_u32 s43, s40, s45
    s_add_u32 m0, s43, 0
    s_nop 0
    buffer_load_dwordx4 v11, s[20:23], s46 offen sc1 lds
    buffer_load_dwordx4 v11, s[20:23], s46 offen offset:1024 sc1 lds
    s_add_u32 s46, s46, 2048
    s_add_u32 m0, s43, 2048
    s_nop 0
    buffer_load_dwordx4 v11, s[20:23], s47 offen sc1 lds
    buffer_load_dwordx4 v11, s[20:23], s47 offen offset:1024 sc1 lds
    s_add_u32 s47, s47, 2048
    s_add_u32 s43, s40, s44
    s_add_u32 m0, s43, 0
    s_nop 0
    buffer_load_dwordx4 v11, s[24:27], s48 offen offset:0 sc1 lds
    buffer_load_dwordx4 v11, s[24:27], s48 offen offset:1024 sc1 lds
    buffer_load_dwordx4 v11, s[24:27], s48 offen offset:2048 sc1 lds
    buffer_load_dwordx4 v11, s[24:27], s48 offen offset:3072 sc1 lds
    s_add_u32 m0, s43, 4096
    s_add_u32 s3, s48, 4096
    buffer_load_dwordx4 v11, s[24:27], s3 offen offset:0 sc1 lds
    buffer_load_dwordx4 v11, s[24:27], s3 offen offset:1024 sc1 lds
    buffer_load_dwordx4 v11, s[24:27], s3 offen offset:2048 sc1 lds
    s_add_u32 s48, s48, 28672
    s_add_u32 s40, s40, 45056
    s_cmp_eq_u32 s40, 135168
    s_cselect_b32 s40, 0, s40
    s_waitcnt vmcnt(22)
    v_cmp_ne_u32 vcc, s100, v9
    s_cbranch_vccz .Lk3_uo_45
    s_mov_b32 s59, 0x100000
.Lk3_pl_46:
    buffer_load_dword v9, v10, s[32:35], s64 offen sc1
    s_waitcnt vmcnt(0)
    v_cmp_ne_u32 vcc, s100, v9
    s_cbranch_vccz .Lk3_po_47
    s_sub_u32 s59, s59, 1
    s_cbranch_scc0 .Lk3_pl_46
.Lk3_po_47:
.Lk3_uo_45:
    v_cmp_ne_u32 vcc, s100, v8
    s_cbranch_vccz .Lk3_uo_48
    s_mov_b32 s59, 0x100000
.Lk3_pl_49:
    buffer_load_dword v8, v10, s[32:35], s63 offen sc1
    s_waitcnt vmcnt(0)
    v_cmp_ne_u32 vcc, s100, v8
    s_cbranch_vccz .Lk3_po_50
    s_sub_u32 s59, s59, 1
    s_cbranch_scc0 .Lk3_pl_49
.Lk3_po_50:
.Lk3_uo_48:
    s_lshl_b32 s50, s12, 3
    s_lshl_b32 s3, s42, 1
    s_add_u32 s50, s50, s3
    s_lshl_b32 s50, s50, 12
    buffer_load_dwordx4 v[32:35], v11, s[16:19], s50 offen offset:0 sc1
    buffer_load_dwordx4 v[36:39], v11, s[16:19], s50 offen offset:1024 sc1
    buffer_load_dwordx4 v[40:43], v11, s[16:19], s50 offen offset:2048 sc1
    buffer_load_dwordx4 v[44:47], v11, s[16:19], s50 offen offset:3072 sc1
    s_add_u32 s50, s50, 4096
    buffer_load_dwordx4 v[48:51], v11, s[16:19], s50 offen offset:0 sc1
    buffer_load_dwordx4 v[52:55], v11, s[16:19], s50 offen offset:1024 sc1
    buffer_load_dwordx4 v[56:59], v11, s[16:19], s50 offen offset:2048 sc1
    buffer_load_dwordx4 v[60:63], v11, s[16:19], s50 offen offset:3072 sc1
    s_lshl_b32 s50, s13, 1
    s_and_b32 s51, s42, 1
    s_add_u32 s50, s50, s51
    s_lshl_b32 s50, s50, 1
    s_lshr_b32 s3, s42, 1
    s_add_u32 s50, s50, s3
    s_mul_i32 s50, s50, 7168
    buffer_load_dwordx4 v[64:67], v11, s[28:31], s50 offen offset:0 sc1
    buffer_load_dwordx4 v[68:71], v11, s[28:31], s50 offen offset:896 sc1
    buffer_load_dwordx4 v[72:75], v11, s[28:31], s50 offen offset:1792 sc1
    buffer_load_dwordx4 v[76:79], v11, s[28:31], s50 offen offset:2688 sc1
    s_add_u32 s50, s50, 3584
    buffer_load_dwordx4 v[80:83], v11, s[28:31], s50 offen offset:0 sc1
    buffer_load_dwordx4 v[84:87], v11, s[28:31], s50 offen offset:896 sc1
    buffer_load_dwordx4 v[88:91], v11, s[28:31], s50 offen offset:1792 sc1
    buffer_load_dwordx4 v[92:95], v11, s[28:31], s50 offen offset:2688 sc1
    s_mov_b32 s41, 2
.Lk3_ld_51:
    s_waitcnt vmcnt(27)
    s_barrier
    s_add_u32 s43, s40, s45
    s_add_u32 m0, s43, 0
    s_nop 0
    buffer_load_dwordx4 v11, s[20:23], s46 offen sc1 lds
    buffer_load_dwordx4 v11, s[20:23], s46 offen offset:1024 sc1 lds
    s_add_u32 s46, s46, 2048
    s_add_u32 m0, s43, 2048
    s_nop 0
    buffer_load_dwordx4 v11, s[20:23], s47 offen sc1 lds
    buffer_load_dwordx4 v11, s[20:23], s47 offen offset:1024 sc1 lds
    s_add_u32 s47, s47, 2048
    s_add_u32 s43, s40, s44
    s_add_u32 m0, s43, 0
    s_nop 0
    buffer_load_dwordx4 v11, s[24:27], s48 offen offset:0 sc1 lds
    buffer_load_dwordx4 v11, s[24:27], s48 offen offset:1024 sc1 lds
    buffer_load_dwordx4 v11, s[24:27], s48 offen offset:2048 sc1 lds
    buffer_load_dwordx4 v11, s[24:27], s48 offen offset:3072 sc1 lds
    s_add_u32 m0, s43, 4096
    s_add_u32 s3, s48, 4096
    buffer_load_dwordx4 v11, s[24:27], s3 offen offset:0 sc1 lds
    buffer_load_dwordx4 v11, s[24:27], s3 offen offset:1024 sc1 lds
    buffer_load_dwordx4 v11, s[24:27], s3 offen offset:2048 sc1 lds
    s_add_u32 s48, s48, 28672
    s_add_u32 s40, s40, 45056
    s_cmp_eq_u32 s40, 135168
    s_cselect_b32 s40, 0, s40
    s_sub_u32 s41, s41, 1
    s_cmp_lg_u32 s41, 0
    s_cbranch_scc1 .Lk3_ld_51
    s_mov_b32 s41, 3
.Lk3_ld_52:
    s_waitcnt vmcnt(11)
    s_barrier
    s_add_u32 s43, s40, s45
    s_add_u32 m0, s43, 0
    s_nop 0
    buffer_load_dwordx4 v11, s[20:23], s46 offen sc1 lds
    buffer_load_dwordx4 v11, s[20:23], s46 offen offset:1024 sc1 lds
    s_add_u32 s46, s46, 2048
    s_add_u32 m0, s43, 2048
    s_nop 0
    buffer_load_dwordx4 v11, s[20:23], s47 offen sc1 lds
    buffer_load_dwordx4 v11, s[20:23], s47 offen offset:1024 sc1 lds
    s_add_u32 s47, s47, 2048
    s_add_u32 s43, s40, s44
    s_add_u32 m0, s43, 0
    s_nop 0
    buffer_load_dwordx4 v11, s[24:27], s48 offen offset:0 sc1 lds
    buffer_load_dwordx4 v11, s[24:27], s48 offen offset:1024 sc1 lds
    buffer_load_dwordx4 v11, s[24:27], s48 offen offset:2048 sc1 lds
    buffer_load_dwordx4 v11, s[24:27], s48 offen offset:3072 sc1 lds
    s_add_u32 m0, s43, 4096
    s_add_u32 s3, s48, 4096
    buffer_load_dwordx4 v11, s[24:27], s3 offen offset:0 sc1 lds
    buffer_load_dwordx4 v11, s[24:27], s3 offen offset:1024 sc1 lds
    buffer_load_dwordx4 v11, s[24:27], s3 offen offset:2048 sc1 lds
    s_add_u32 s48, s48, 28672
    s_add_u32 s40, s40, 45056
    s_cmp_eq_u32 s40, 135168
    s_cselect_b32 s40, 0, s40
    s_sub_u32 s41, s41, 1
    s_cmp_lg_u32 s41, 0
    s_cbranch_scc1 .Lk3_ld_52
    s_waitcnt vmcnt(22)
    v_pk_add_f32 v[32:33], v[32:33], v[36:37]
    v_pk_add_f32 v[40:41], v[40:41], v[44:45]
    v_pk_add_f32 v[34:35], v[34:35], v[38:39]
    v_pk_add_f32 v[42:43], v[42:43], v[46:47]
    v_pk_add_f32 v[32:33], v[32:33], v[40:41]
    v_pk_add_f32 v[34:35], v[34:35], v[42:43]
    v_pk_add_f32 v[48:49], v[48:49], v[52:53]
    v_pk_add_f32 v[56:57], v[56:57], v[60:61]
    v_pk_add_f32 v[50:51], v[50:51], v[54:55]
    v_pk_add_f32 v[58:59], v[58:59], v[62:63]
    v_pk_add_f32 v[48:49], v[48:49], v[56:57]
    v_pk_add_f32 v[50:51], v[50:51], v[58:59]
    v_add_f32_dpp v32, v32, v32 row_ror:8 row_mask:0xf bank_mask:0xf
    v_add_f32_dpp v33, v33, v33 row_ror:8 row_mask:0xf bank_mask:0xf
    v_add_f32_dpp v34, v34, v34 row_ror:8 row_mask:0xf bank_mask:0xf
    v_add_f32_dpp v35, v35, v35 row_ror:8 row_mask:0xf bank_mask:0xf
    v_add_f32_dpp v48, v48, v48 row_ror:8 row_mask:0xf bank_mask:0xf
    v_add_f32_dpp v49, v49, v49 row_ror:8 row_mask:0xf bank_mask:0xf
    v_add_f32_dpp v50, v50, v50 row_ror:8 row_mask:0xf bank_mask:0xf
    v_add_f32_dpp v51, v51, v51 row_ror:8 row_mask:0xf bank_mask:0xf
    v_mov_b32 v36, v32
    v_mov_b32 v37, v33
    v_mov_b32 v38, v34
    v_mov_b32 v39, v35
    v_mov_b32 v52, v48
    v_mov_b32 v53, v49
    v_mov_b32 v54, v50
    v_mov_b32 v55, v51
    v_permlane16_swap_b32 v36, v32
    v_permlane16_swap_b32 v37, v33
    v_permlane16_swap_b32 v38, v34
    v_permlane16_swap_b32 v39, v35
    v_permlane16_swap_b32 v52, v48
    v_permlane16_swap_b32 v53, v49
    v_permlane16_swap_b32 v54, v50
    v_permlane16_swap_b32 v55, v51
    v_add_f32 v32, v32, v36
    v_add_f32 v33, v33, v37
    v_add_f32 v34, v34, v38
    v_add_f32 v35, v35, v39
    v_add_f32 v48, v48, v52
    v_add_f32 v49, v49, v53
    v_add_f32 v50, v50, v54
    v_add_f32 v51, v51, v55
    v_mov_b32 v36, v32
    v_mov_b32 v37, v33
    v_mov_b32 v38, v34
    v_mov_b32 v39, v35
    v_mov_b32 v52, v48
    v_mov_b32 v53, v49
    v_mov_b32 v54, v50
    v_mov_b32 v55, v51
    v_permlane32_swap_b32 v36, v32
    v_permlane32_swap_b32 v37, v33
    v_permlane32_swap_b32 v38, v34
    v_permlane32_swap_b32 v39, v35
    v_permlane32_swap_b32 v52, v48
    v_permlane32_swap_b32 v53, v49
    v_permlane32_swap_b32 v54, v50
    v_permlane32_swap_b32 v55, v51
    v_add_f32 v32, v32, v36
    v_add_f32 v33, v33, v37
    v_add_f32 v34, v34, v38
    v_add_f32 v35, v35, v39
    v_add_f32 v48, v48, v52
    v_add_f32 v49, v49, v53
    v_add_f32 v50, v50, v54
    v_add_f32 v51, v51, v55
    v_pk_add_f32 v[64:65], v[64:65], v[80:81]
    v_pk_add_f32 v[66:67], v[66:67], v[82:83]
    v_pk_add_f32 v[68:69], v[68:69], v[84:85]
    v_pk_add_f32 v[70:71], v[70:71], v[86:87]
    v_pk_add_f32 v[72:73], v[72:73], v[88:89]
    v_pk_add_f32 v[74:75], v[74:75], v[90:91]
    v_pk_add_f32 v[76:77], v[76:77], v[92:93]
    v_pk_add_f32 v[78:79], v[78:79], v[94:95]
    v_pk_add_f32 v[64:65], v[64:65], v[72:73]
    v_pk_add_f32 v[66:67], v[66:67], v[74:75]
    v_pk_add_f32 v[68:69], v[68:69], v[76:77]
    v_pk_add_f32 v[70:71], v[70:71], v[78:79]
    v_pk_add_f32 v[64:65], v[64:65], v[68:69]
    v_pk_add_f32 v[66:67], v[66:67], v[70:71]
    v_mul_f32 v36, 0x3a800000, v32
    v_mov_b32 v37, 0x3727c5ac
    v_fmac_f32 v37, 0x3a800000, v33
    v_fma_f32 v37, -v36, v36, v37
    v_max_f32 v37, 0x3727c5ac, v37
    v_rsq_f32 v32, v37
    v_mul_f32 v38, 0x3a800000, v34
    v_mov_b32 v39, 0x3727c5ac
    v_fmac_f32 v39, 0x3a800000, v35
    v_fma_f32 v39, -v38, v38, v39
    v_max_f32 v39, 0x3727c5ac, v39
    v_rsq_f32 v34, v39
    v_mul_f32 v52, 0x3a800000, v48
    v_mov_b32 v53, 0x3727c5ac
    v_fmac_f32 v53, 0x3a800000, v49
    v_fma_f32 v53, -v52, v52, v53
    v_max_f32 v53, 0x3727c5ac, v53
    v_rsq_f32 v48, v53
    v_mul_f32 v54, 0x3a800000, v50
    v_mov_b32 v55, 0x3727c5ac
    v_fmac_f32 v55, 0x3a800000, v51
    v_fma_f32 v55, -v54, v54, v55
    v_max_f32 v55, 0x3727c5ac, v55
    v_rsq_f32 v50, v55
    v_mul_f32 v33, v36, v32
    v_mul_f32 v35, v38, v34
    v_mul_f32 v49, v52, v48
    v_mul_f32 v51, v54, v50
    v_and_b32 v30, 7, v2
    v_lshlrev_b32 v30, 4, v30
    s_lshl_b32 s3, s42, 8
    s_add_u32 s3, s3, 135168
    v_add_u32 v30, s3, v30
    ds_write_b128 v30, v[32:35]
    ds_write_b128 v30, v[48:51] offset:128
    s_lshl_b32 s3, s51, 10
    s_add_u32 s3, s3, 136192
    v_add_u32 v30, s3, v11
    s_cmp_lt_u32 s42, 2
    s_cbranch_scc1 .Lk3_uw_53
    ds_write_b128 v30, v[64:67]
.Lk3_uw_53:
    s_waitcnt vmcnt(11) lgkmcnt(0)
    s_barrier
    s_cmp_ge_u32 s42, 2
    s_cbranch_scc1 .Lk3_uw_54
    ds_read_b128 v[68:71], v30
    s_waitcnt lgkmcnt(0)
    v_pk_add_f32 v[64:65], v[64:65], v[68:69]
    v_pk_add_f32 v[66:67], v[66:67], v[70:71]
    ds_write_b128 v30, v[64:67]
.Lk3_uw_54:
    s_waitcnt vmcnt(0) lgkmcnt(0)
    s_barrier
    s_and_b32 s14, s2, 7
    s_lshr_b32 s15, s2, 3
    s_and_b32 s12, s14, 1
    s_lshl_b32 s12, s12, 3
    s_and_b32 s3, s15, 7
    s_add_u32 s12, s12, s3
    s_and_b32 s11, s14, 2
    s_lshl_b32 s11, s11, 1
    s_lshr_b32 s3, s15, 3
    s_add_u32 s11, s11, s3
    s_lshr_b32 s10, s14, 2
    s_lshl_b32 s13, s11, 1
    s_add_u32 s13, s13, s10
    s_lshl_b32 s3, s12, 3
    s_lshl_b32 s43, s42, 1
    s_add_u32 s3, s3, s43
    s_mul_i32 s46, s3, 114688
    s_add_u32 s47, s46, 114688
    s_mul_i32 s52, s10, 28672
    s_xor_b32 s3, s10, 2
    s_mul_i32 s53, s3, 28672
    s_lshl_b32 s44, s42, 12
    s_add_u32 s45, s44, 16384
    s_lshl_b32 s56, s11, 2
    s_add_u32 s57, s56, s3
    s_add_u32 s56, s56, s10
    s_mul_i32 s56, s56, 196608
    s_add_u32 s56, s56, s44
    s_mul_i32 s57, s57, 196608
    s_add_u32 s57, s57, s44
    v_add_u32 v12, 3072, v11
    v_add_u32 v13, 6144, v11
    v_and_b32 v14, 15, v2
    v_lshlrev_b32 v14, 4, v14
    s_lshl_b32 s65, s12, 2
    s_add_u32 s63, s65, s10
    s_xor_b32 s64, s63, 2
    s_lshl_b32 s63, s63, 8
    s_add_u32 s63, s63, 589824
    s_lshl_b32 s64, s64, 8
    s_add_u32 s64, s64, 589824
    s_lshl_b32 s65, s12, 10
    s_add_u32 s65, s65, 393216
    s_add_u32 s16, s6, 45088768
    s_addc_u32 s17, s7, 0
    s_mov_b32 s18, 7340032
    s_mov_b32 s19, 0x20000
    s_add_u32 s20, s6, 17825792
    s_addc_u32 s21, s7, 0
    s_mov_b32 s22, 14680064
    s_mov_b32 s23, 0x20000
    v_add_u32 v16, s44, v11
    s_lshl_b32 s49, s42, 11
    s_lshl_b32 s48, s13, 16
    s_add_u32 s48, s48, s49
    s_add_u32 s48, s48, 6291456
    s_barrier
    s_cmp_lg_u32 s42, 0
    s_cbranch_scc1 .Lk3_ps_57
    buffer_load_dword v9, v14, s[32:35], s63 offen sc1
.Lk3_ps_57:
    s_add_u32 s43, s44, 0
    s_add_u32 m0, s43, 0
    s_nop 0
    buffer_load_dwordx4 v11, s[16:19], s56 offen offset:0 sc1 lds
    buffer_load_dwordx4 v11, s[16:19], s56 offen offset:1024 sc1 lds
    buffer_load_dwordx4 v11, s[16:19], s56 offen offset:2048 sc1 lds
    buffer_load_dwordx4 v11, s[16:19], s56 offen offset:3072 sc1 lds
    s_add_u32 s56, s56, 16384
    s_add_u32 s43, s44, 32768
    s_add_u32 m0, s43, 0
    s_nop 0
    buffer_load_dwordx4 v11, s[16:19], s56 offen offset:0 sc1 lds
    buffer_load_dwordx4 v11, s[16:19], s56 offen offset:1024 sc1 lds
    buffer_load_dwordx4 v11, s[16:19], s56 offen offset:2048 sc1 lds
    buffer_load_dwordx4 v11, s[16:19], s56 offen offset:3072 sc1 lds
    s_add_u32 s56, s56, 16384
    s_add_u32 s43, s44, 65536
    s_add_u32 m0, s43, 0
    s_nop 0
    buffer_load_dwordx4 v11, s[16:19], s56 offen offset:0 sc1 lds
    buffer_load_dwordx4 v11, s[16:19], s56 offen offset:1024 sc1 lds
    buffer_load_dwordx4 v11, s[16:19], s56 offen offset:2048 sc1 lds
    buffer_load_dwordx4 v11, s[16:19], s56 offen offset:3072 sc1 lds
    s_add_u32 s56, s56, 16384
    s_cmp_lg_u32 s42, 0
    s_cbranch_scc1 .Lk3_po_56
    s_waitcnt vmcnt(12)
    v_cmp_ne_u32 vcc, s100, v9
    s_cbranch_vccz .Lk3_po_56
    s_mov_b32 s59, 0x100000
.Lk3_pl_55:
    buffer_load_dword v9, v14, s[32:35], s63 offen sc1
    s_waitcnt vmcnt(0)
    v_cmp_ne_u32 vcc, s100, v9
    s_cbranch_vccz .Lk3_po_56
    s_sub_u32 s59, s59, 1
    s_cbranch_scc0 .Lk3_pl_55
.Lk3_po_56:
    s_barrier
    s_add_u32 s43, s45, 0
    s_add_u32 m0, s43, 0
    s_add_u32 s3, s46, s52
    buffer_load_dwordx4 v11, s[20:23], s3 offen sc1 lds
    buffer_load_dwordx4 v11, s[20:23], s3 offen offset:1024 sc1 lds
    s_add_u32 m0, s43, 2048
    s_add_u32 s3, s47, s52
    buffer_load_dwordx4 v11, s[20:23], s3 offen sc1 lds
    buffer_load_dwordx4 v11, s[20:23], s3 offen offset:1024 sc1 lds
    s_add_u32 s52, s52, 0x1c00
    s_add_u32 s43, s45, 32768
    s_add_u32 m0, s43, 0
    s_add_u32 s3, s46, s52
    buffer_load_dwordx4 v11, s[20:23], s3 offen sc1 lds
    buffer_load_dwordx4 v11, s[20:23], s3 offen offset:1024 sc1 lds
    s_add_u32 m0, s43, 2048
    s_add_u32 s3, s47, s52
    buffer_load_dwordx4 v11, s[20:23], s3 offen sc1 lds
    buffer_load_dwordx4 v11, s[20:23], s3 offen offset:1024 sc1 lds
    s_add_u32 s52, s52, 0x1c00
    s_add_u32 s43, s45, 65536
    s_add_u32 m0, s43, 0
    s_add_u32 s3, s46, s52
    buffer_load_dwordx4 v11, s[20:23], s3 offen sc1 lds
    buffer_load_dwordx4 v11, s[20:23], s3 offen offset:1024 sc1 lds
    s_add_u32 m0, s43, 2048
    s_add_u32 s3, s47, s52
    buffer_load_dwordx4 v11, s[20:23], s3 offen sc1 lds
    buffer_load_dwordx4 v11, s[20:23], s3 offen offset:1024 sc1 lds
    s_add_u32 s52, s52, 0x1c00
    buffer_load_dword v9, v14, s[32:35], s64 offen sc1
    s_mov_b32 s40, 0
    s_waitcnt lgkmcnt(0)
    s_waitcnt vmcnt(9)
    s_barrier
    s_add_u32 s43, s45, 98304
    s_add_u32 m0, s43, 0
    s_add_u32 s3, s46, s52
    buffer_load_dwordx4 v11, s[20:23], s3 offen sc1 lds
    buffer_load_dwordx4 v11, s[20:23], s3 offen offset:1024 sc1 lds
    s_add_u32 m0, s43, 2048
    s_add_u32 s3, s47, s52
    buffer_load_dwordx4 v11, s[20:23], s3 offen sc1 lds
    buffer_load_dwordx4 v11, s[20:23], s3 offen offset:1024 sc1 lds
    s_add_u32 s52, s52, 0xffffb400
    s_add_u32 s43, s44, 98304
    s_add_u32 m0, s43, 0
    s_nop 0
    buffer_load_dwordx4 v11, s[16:19], s56 offen offset:0 sc1 lds
    buffer_load_dwordx4 v11, s[16:19], s56 offen offset:1024 sc1 lds
    buffer_load_dwordx4 v11, s[16:19], s56 offen offset:2048 sc1 lds
    buffer_load_dwordx4 v11, s[16:19], s56 offen offset:3072 sc1 lds
    s_add_u32 s56, s56, 16384
    s_waitcnt vmcnt(8)
    v_cmp_ne_u32 vcc, s100, v9
    s_cbranch_vccz .Lk3_uo_58
    s_mov_b32 s59, 0x100000
.Lk3_pl_59:
    buffer_load_dword v9, v14, s[32:35], s64 offen sc1
    s_waitcnt vmcnt(0)
    v_cmp_ne_u32 vcc, s100, v9
    s_cbranch_vccz .Lk3_po_60
    s_sub_u32 s59, s59, 1
    s_cbranch_scc0 .Lk3_pl_59
.Lk3_po_60:
.Lk3_uo_58:
    s_add_u32 s43, s45, 131072
    s_add_u32 m0, s43, 0
    s_add_u32 s3, s46, s53
    buffer_load_dwordx4 v11, s[20:23], s3 offen sc1 lds
    buffer_load_dwordx4 v11, s[20:23], s3 offen offset:1024 sc1 lds
    s_add_u32 m0, s43, 2048
    s_add_u32 s3, s47, s53
    buffer_load_dwordx4 v11, s[20:23], s3 offen sc1 lds
    buffer_load_dwordx4 v11, s[20:23], s3 offen offset:1024 sc1 lds
    s_add_u32 s53, s53, 0x1c00
    s_add_u32 s43, s44, 131072
    s_add_u32 m0, s43, 0
    s_nop 0
    buffer_load_dwordx4 v11, s[16:19], s57 offen offset:0 sc1 lds
    buffer_load_dwordx4 v11, s[16:19], s57 offen offset:1024 sc1 lds
    buffer_load_dwordx4 v11, s[16:19], s57 offen offset:2048 sc1 lds
    buffer_load_dwordx4 v11, s[16:19], s57 offen offset:3072 sc1 lds
    s_add_u32 s57, s57, 16384
    s_waitcnt vmcnt(21)
    s_barrier
    s_add_u32 s43, s40, s45
    s_add_u32 m0, s43, 0
    s_add_u32 s3, s46, s53
    buffer_load_dwordx4 v11, s[20:23], s3 offen sc1 lds
    buffer_load_dwordx4 v11, s[20:23], s3 offen offset:1024 sc1 lds
    s_add_u32 m0, s43, 2048
    s_add_u32 s3, s47, s53
    buffer_load_dwordx4 v11, s[20:23], s3 offen sc1 lds
    buffer_load_dwordx4 v11, s[20:23], s3 offen offset:1024 sc1 lds
    s_add_u32 s53, s53, 0x1c00
    s_add_u32 s43, s40, s44
    s_add_u32 m0, s43, 0
    s_nop 0
    buffer_load_dwordx4 v11, s[16:19], s57 offen offset:0 sc1 lds
    buffer_load_dwordx4 v11, s[16:19], s57 offen offset:1024 sc1 lds
    buffer_load_dwordx4 v11, s[16:19], s57 offen offset:2048 sc1 lds
    buffer_load_dwordx4 v11, s[16:19], s57 offen offset:3072 sc1 lds
    s_add_u32 s57, s57, 16384
    s_add_u32 s40, s40, 32768
    s_cmp_eq_u32 s40, 163840
    s_cselect_b32 s40, 0, s40
    s_waitcnt vmcnt(25)
    s_barrier
    s_add_u32 s43, s40, s45
    s_add_u32 m0, s43, 0
    s_add_u32 s3, s46, s53
    buffer_load_dwordx4 v11, s[20:23], s3 offen sc1 lds
    buffer_load_dwordx4 v11, s[20:23], s3 offen offset:1024 sc1 lds
    s_add_u32 m0, s43, 2048
    s_add_u32 s3, s47, s53
    buffer_load_dwordx4 v11, s[20:23], s3 offen sc1 lds
    buffer_load_dwordx4 v11, s[20:23], s3 offen offset:1024 sc1 lds
    s_add_u32 s53, s53, 0x1c00
    s_add_u32 s43, s40, s44
    s_add_u32 m0, s43, 0
    s_nop 0
    buffer_load_dwordx4 v11, s[16:19], s57 offen offset:0 sc1 lds
    buffer_load_dwordx4 v11, s[16:19], s57 offen offset:1024 sc1 lds
    buffer_load_dwordx4 v11, s[16:19], s57 offen offset:2048 sc1 lds
    buffer_load_dwordx4 v11, s[16:19], s57 offen offset:3072 sc1 lds
    s_add_u32 s57, s57, 16384
    s_add_u32 s40, s40, 32768
    s_cmp_eq_u32 s40, 163840
    s_cselect_b32 s40, 0, s40
    buffer_load_dword v9, v10, s[32:35], s65 offen sc1
    s_waitcnt vmcnt(25)
    s_barrier
    s_add_u32 s43, s40, s45
    s_add_u32 m0, s43, 0
    s_add_u32 s3, s46, s53
    buffer_load_dwordx4 v11, s[20:23], s3 offen sc1 lds
    buffer_load_dwordx4 v11, s[20:23], s3 offen offset:1024 sc1 lds
    s_add_u32 m0, s43, 2048
    s_add_u32 s3, s47, s53
    buffer_load_dwordx4 v11, s[20:23], s3 offen sc1 lds
    buffer_load_dwordx4 v11, s[20:23], s3 offen offset:1024 sc1 lds
    s_add_u32 s53, s53, 0xffffb400
    s_add_u32 s43, s40, s44
    s_add_u32 m0, s43, 0
    s_nop 0
    buffer_load_dwordx4 v11, s[16:19], s57 offen offset:0 sc1 lds
    buffer_load_dwordx4 v11, s[16:19], s57 offen offset:1024 sc1 lds
    buffer_load_dwordx4 v11, s[16:19], s57 offen offset:2048 sc1 lds
    buffer_load_dwordx4 v11, s[16:19], s57 offen offset:3072 sc1 lds
    s_add_u32 s57, s57, 16384
    s_add_u32 s40, s40, 32768
    s_cmp_eq_u32 s40, 163840
    s_cselect_b32 s40, 0, s40
    s_waitcnt vmcnt(8)
    v_cmp_ne_u32 vcc, s100, v9
    s_cbranch_vccz .Lk3_uo_61
    s_mov_b32 s59, 0x100000
.Lk3_pl_62:
    buffer_load_dword v9, v10, s[32:35], s65 offen sc1
    s_waitcnt vmcnt(0)
    v_cmp_ne_u32 vcc, s100, v9
    s_cbranch_vccz .Lk3_po_63
    s_sub_u32 s59, s59, 1
    s_cbranch_scc0 .Lk3_pl_62
.Lk3_po_63:
.Lk3_uo_61:
    s_mov_b32 s41, 3
.Lk3_ld_64:
    s_waitcnt vmcnt(25)
    s_barrier
    s_add_u32 s43, s40, s45
    s_add_u32 m0, s43, 0
    s_add_u32 s3, s46, s52
    buffer_load_dwordx4 v11, s[20:23], s3 offen sc1 lds
    buffer_load_dwordx4 v11, s[20:23], s3 offen offset:1024 sc1 lds
    s_add_u32 m0, s43, 2048
    s_add_u32 s3, s47, s52
    buffer_load_dwordx4 v11, s[20:23], s3 offen sc1 lds
    buffer_load_dwordx4 v11, s[20:23], s3 offen offset:1024 sc1 lds
    s_add_u32 s52, s52, 0x1c00
    s_add_u32 s43, s40, s44
    s_add_u32 m0, s43, 0
    s_nop 0
    buffer_load_dwordx4 v11, s[16:19], s56 offen offset:0 sc1 lds
    buffer_load_dwordx4 v11, s[16:19], s56 offen offset:1024 sc1 lds
    buffer_load_dwordx4 v11, s[16:19], s56 offen offset:2048 sc1 lds
    buffer_load_dwordx4 v11, s[16:19], s56 offen offset:3072 sc1 lds
    s_add_u32 s56, s56, 16384
    s_add_u32 s40, s40, 32768
    s_cmp_eq_u32 s40, 163840
    s_cselect_b32 s40, 0, s40
    s_sub_u32 s41, s41, 1
    s_cmp_lg_u32 s41, 0
    s_cbranch_scc1 .Lk3_ld_64
    s_waitcnt vmcnt(24)
    s_barrier
    s_add_u32 s43, s40, s45
    s_add_u32 m0, s43, 0
    s_add_u32 s3, s46, s52
    buffer_load_dwordx4 v11, s[20:23], s3 offen sc1 lds
    buffer_load_dwordx4 v11, s[20:23], s3 offen offset:1024 sc1 lds
    s_add_u32 m0, s43, 2048
    s_add_u32 s3, s47, s52
    buffer_load_dwordx4 v11, s[20:23], s3 offen sc1 lds
    buffer_load_dwordx4 v11, s[20:23], s3 offen offset:1024 sc1 lds
    s_add_u32 s52, s52, 0xffffb400
    s_add_u32 s43, s40, s44
    s_add_u32 m0, s43, 0
    s_nop 0
    buffer_load_dwordx4 v11, s[16:19], s56 offen offset:0 sc1 lds
    buffer_load_dwordx4 v11, s[16:19], s56 offen offset:1024 sc1 lds
    buffer_load_dwordx4 v11, s[16:19], s56 offen offset:2048 sc1 lds
    buffer_load_dwordx4 v11, s[16:19], s56 offen offset:3072 sc1 lds
    s_add_u32 s56, s56, 16384
    s_add_u32 s40, s40, 32768
    s_cmp_eq_u32 s40, 163840
    s_cselect_b32 s40, 0, s40
    s_mov_b32 s41, 3
.Lk3_ld_65:
    s_waitcnt vmcnt(24)
    s_barrier
    s_add_u32 s43, s40, s45
    s_add_u32 m0, s43, 0
    s_add_u32 s3, s46, s53
    buffer_load_dwordx4 v11, s[20:23], s3 offen sc1 lds
    buffer_load_dwordx4 v11, s[20:23], s3 offen offset:1024 sc1 lds
    s_add_u32 m0, s43, 2048
    s_add_u32 s3, s47, s53
    buffer_load_dwordx4 v11, s[20:23], s3 offen sc1 lds
    buffer_load_dwordx4 v11, s[20:23], s3 offen offset:1024 sc1 lds
    s_add_u32 s53, s53, 0x1c00
    s_add_u32 s43, s40, s44
    s_add_u32 m0, s43, 0
    s_nop 0
    buffer_load_dwordx4 v11, s[16:19], s57 offen offset:0 sc1 lds
    buffer_load_dwordx4 v11, s[16:19], s57 offen offset:1024 sc1 lds
    buffer_load_dwordx4 v11, s[16:19], s57 offen offset:2048 sc1 lds
    buffer_load_dwordx4 v11, s[16:19], s57 offen offset:3072 sc1 lds
    s_add_u32 s57, s57, 16384
    s_add_u32 s40, s40, 32768
    s_cmp_eq_u32 s40, 163840
    s_cselect_b32 s40, 0, s40
    s_sub_u32 s41, s41, 1
    s_cmp_lg_u32 s41, 0
    s_cbranch_scc1 .Lk3_ld_65
    s_waitcnt vmcnt(24)
    s_barrier
    s_add_u32 s43, s40, s45
    s_add_u32 m0, s43, 0
    s_add_u32 s3, s46, s53
    buffer_load_dwordx4 v11, s[20:23], s3 offen sc1 lds
    buffer_load_dwordx4 v11, s[20:23], s3 offen offset:1024 sc1 lds
    s_add_u32 m0, s43, 2048
    s_add_u32 s3, s47, s53
    buffer_load_dwordx4 v11, s[20:23], s3 offen sc1 lds
    buffer_load_dwordx4 v11, s[20:23], s3 offen offset:1024 sc1 lds
    s_add_u32 s53, s53, 0xffffb400
    s_add_u32 s43, s40, s44
    s_add_u32 m0, s43, 0
    s_nop 0
    buffer_load_dwordx4 v11, s[16:19], s57 offen offset:0 sc1 lds
    buffer_load_dwordx4 v11, s[16:19], s57 offen offset:1024 sc1 lds
    buffer_load_dwordx4 v11, s[16:19], s57 offen offset:2048 sc1 lds
    buffer_load_dwordx4 v11, s[16:19], s57 offen offset:3072 sc1 lds
    s_add_u32 s57, s57, 16384
    s_add_u32 s40, s40, 32768
    s_cmp_eq_u32 s40, 163840
    s_cselect_b32 s40, 0, s40
    s_mov_b32 s41, 3
.Lk3_ld_66:
    s_waitcnt vmcnt(24)
    s_barrier
    s_add_u32 s43, s40, s45
    s_add_u32 m0, s43, 0
    s_add_u32 s3, s46, s52
    buffer_load_dwordx4 v11, s[20:23], s3 offen sc1 lds
    buffer_load_dwordx4 v11, s[20:23], s3 offen offset:1024 sc1 lds
    s_add_u32 m0, s43, 2048
    s_add_u32 s3, s47, s52
    buffer_load_dwordx4 v11, s[20:23], s3 offen sc1 lds
    buffer_load_dwordx4 v11, s[20:23], s3 offen offset:1024 sc1 lds
    s_add_u32 s52, s52, 0x1c00
    s_add_u32 s43, s40, s44
    s_add_u32 m0, s43, 0
    s_nop 0
    buffer_load_dwordx4 v11, s[16:19], s56 offen offset:0 sc1 lds
    buffer_load_dwordx4 v11, s[16:19], s56 offen offset:1024 sc1 lds
    buffer_load_dwordx4 v11, s[16:19], s56 offen offset:2048 sc1 lds
    buffer_load_dwordx4 v11, s[16:19], s56 offen offset:3072 sc1 lds
    s_add_u32 s56, s56, 16384
    s_add_u32 s40, s40, 32768
    s_cmp_eq_u32 s40, 163840
    s_cselect_b32 s40, 0, s40
    s_sub_u32 s41, s41, 1
    s_cmp_lg_u32 s41, 0
    s_cbranch_scc1 .Lk3_ld_66
    s_waitcnt vmcnt(24)
    s_barrier
    s_add_u32 s43, s40, s45
    s_add_u32 m0, s43, 0
    s_add_u32 s3, s46, s52
    buffer_load_dwordx4 v11, s[20:23], s3 offen sc1 lds
    buffer_load_dwordx4 v11, s[20:23], s3 offen offset:1024 sc1 lds
    s_add_u32 m0, s43, 2048
    s_add_u32 s3, s47, s52
    buffer_load_dwordx4 v11, s[20:23], s3 offen sc1 lds
    buffer_load_dwordx4 v11, s[20:23], s3 offen offset:1024 sc1 lds
    s_add_u32 s52, s52, 0xffffb400
    s_add_u32 s43, s40, s44
    s_add_u32 m0, s43, 0
    s_nop 0
    buffer_load_dwordx4 v11, s[16:19], s56 offen offset:0 sc1 lds
    buffer_load_dwordx4 v11, s[16:19], s56 offen offset:1024 sc1 lds
    buffer_load_dwordx4 v11, s[16:19], s56 offen offset:2048 sc1 lds
    buffer_load_dwordx4 v11, s[16:19], s56 offen offset:3072 sc1 lds
    s_add_u32 s56, s56, 16384
    s_add_u32 s40, s40, 32768
    s_cmp_eq_u32 s40, 163840
    s_cselect_b32 s40, 0, s40
    s_mov_b32 s41, 3
.Lk3_ld_67:
    s_waitcnt vmcnt(24)
    s_barrier
    s_add_u32 s43, s40, s45
    s_add_u32 m0, s43, 0
    s_add_u32 s3, s46, s53
    buffer_load_dwordx4 v11, s[20:23], s3 offen sc1 lds
    buffer_load_dwordx4 v11, s[20:23], s3 offen offset:1024 sc1 lds
    s_add_u32 m0, s43, 2048
    s_add_u32 s3, s47, s53
    buffer_load_dwordx4 v11, s[20:23], s3 offen sc1 lds
    buffer_load_dwordx4 v11, s[20:23], s3 offen offset:1024 sc1 lds
    s_add_u32 s53, s53, 0x1c00
    s_add_u32 s43, s40, s44
    s_add_u32 m0, s43, 0
    s_nop 0
    buffer_load_dwordx4 v11, s[16:19], s57 offen offset:0 sc1 lds
    buffer_load_dwordx4 v11, s[16:19], s57 offen offset:1024 sc1 lds
    buffer_load_dwordx4 v11, s[16:19], s57 offen offset:2048 sc1 lds
    buffer_load_dwordx4 v11, s[16:19], s57 offen offset:3072 sc1 lds
    s_add_u32 s57, s57, 16384
    s_add_u32 s40, s40, 32768
    s_cmp_eq_u32 s40, 163840
    s_cselect_b32 s40, 0, s40
    s_sub_u32 s41, s41, 1
    s_cmp_lg_u32 s41, 0
    s_cbranch_scc1 .Lk3_ld_67
    s_waitcnt vmcnt(24)
    s_barrier
    s_add_u32 s43, s40, s45
    s_add_u32 m0, s43, 0
    s_add_u32 s3, s46, s53
    buffer_load_dwordx4 v11, s[20:23], s3 offen sc1 lds
    buffer_load_dwordx4 v11, s[20:23], s3 offen offset:1024 sc1 lds
    s_add_u32 m0, s43, 2048
    s_add_u32 s3, s47, s53
    buffer_load_dwordx4 v11, s[20:23], s3 offen sc1 lds
    buffer_load_dwordx4 v11, s[20:23], s3 offen offset:1024 sc1 lds
    s_add_u32 s53, s53, 0xffffb400
    s_add_u32 s43, s40, s44
    s_add_u32 m0, s43, 0
    s_nop 0
    buffer_load_dwordx4 v11, s[16:19], s57 offen offset:0 sc1 lds
    buffer_load_dwordx4 v11, s[16:19], s57 offen offset:1024 sc1 lds
    buffer_load_dwordx4 v11, s[16:19], s57 offen offset:2048 sc1 lds
    buffer_load_dwordx4 v11, s[16:19], s57 offen offset:3072 sc1 lds
    s_add_u32 s57, s57, 16384
    s_add_u32 s40, s40, 32768
    s_cmp_eq_u32 s40, 163840
    s_cselect_b32 s40, 0, s40
    s_waitcnt vmcnt(24)
    s_barrier
    s_mov_b32 s52, 6144
    s_add_u32 s43, s40, s45
    s_add_u32 m0, s43, 0
    s_add_u32 s3, s46, s52
    buffer_load_dwordx4 v11, s[20:23], s3 offen sc1 lds
    buffer_load_dwordx4 v13, s[20:23], s3 offen offset:1024 sc1 lds
    s_add_u32 m0, s43, 2048
    s_add_u32 s3, s47, s52
    buffer_load_dwordx4 v11, s[20:23], s3 offen sc1 lds
    buffer_load_dwordx4 v13, s[20:23], s3 offen offset:1024 sc1 lds
    s_add_u32 s52, s52, 0x3800
    s_add_u32 s43, s40, s49
    s_add_u32 m0, s43, 0
    s_nop 0
    buffer_load_dwordx4 v11, s[16:19], s48 offen offset:0 sc1 lds
    buffer_load_dwordx4 v11, s[16:19], s48 offen offset:1024 sc1 lds
    s_add_u32 s48, s48, 8192
    s_add_u32 s40, s40, 32768
    s_cmp_eq_u32 s40, 163840
    s_cselect_b32 s40, 0, s40
    s_waitcnt vmcnt(22)
    s_barrier
    s_add_u32 s43, s40, s45
    s_add_u32 m0, s43, 0
    s_add_u32 s3, s46, s52
    buffer_load_dwordx4 v11, s[20:23], s3 offen sc1 lds
    buffer_load_dwordx4 v13, s[20:23], s3 offen offset:1024 sc1 lds
    s_add_u32 m0, s43, 2048
    s_add_u32 s3, s47, s52
    buffer_load_dwordx4 v11, s[20:23], s3 offen sc1 lds
    buffer_load_dwordx4 v13, s[20:23], s3 offen offset:1024 sc1 lds
    s_add_u32 s52, s52, 0x3800
    s_add_u32 s43, s40, s49
    s_add_u32 m0, s43, 0
    s_nop 0
    buffer_load_dwordx4 v11, s[16:19], s48 offen offset:0 sc1 lds
    buffer_load_dwordx4 v11, s[16:19], s48 offen offset:1024 sc1 lds
    s_add_u32 s48, s48, 8192
    s_add_u32 s40, s40, 32768
    s_cmp_eq_u32 s40, 163840
    s_cselect_b32 s40, 0, s40
    s_waitcnt vmcnt(20)
    s_barrier
    s_add_u32 s43, s40, s45
    s_add_u32 m0, s43, 0
    s_add_u32 s3, s46, s52
    buffer_load_dwordx4 v11, s[20:23], s3 offen sc1 lds
    buffer_load_dwordx4 v13, s[20:23], s3 offen offset:1024 sc1 lds
    s_add_u32 m0, s43, 2048
    s_add_u32 s3, s47, s52
    buffer_load_dwordx4 v11, s[20:23], s3 offen sc1 lds
    buffer_load_dwordx4 v13, s[20:23], s3 offen offset:1024 sc1 lds
    s_add_u32 s52, s52, 0x3800
    s_add_u32 s43, s40, s49
    s_add_u32 m0, s43, 0
    s_nop 0
    buffer_load_dwordx4 v11, s[16:19], s48 offen offset:0 sc1 lds
    buffer_load_dwordx4 v11, s[16:19], s48 offen offset:1024 sc1 lds
    s_add_u32 s48, s48, 8192
    s_add_u32 s40, s40, 32768
    s_cmp_eq_u32 s40, 163840
    s_cselect_b32 s40, 0, s40
    s_mov_b32 s41, 5
.Lk3_ld_68:
    s_waitcnt vmcnt(18)
    s_barrier
    s_add_u32 s43, s40, s45
    s_add_u32 m0, s43, 0
    s_add_u32 s3, s46, s52
    buffer_load_dwordx4 v11, s[20:23], s3 offen sc1 lds
    buffer_load_dwordx4 v13, s[20:23], s3 offen offset:1024 sc1 lds
    s_add_u32 m0, s43, 2048
    s_add_u32 s3, s47, s52
    buffer_load_dwordx4 v11, s[20:23], s3 offen sc1 lds
    buffer_load_dwordx4 v13, s[20:23], s3 offen offset:1024 sc1 lds
    s_add_u32 s52, s52, 0x3800
    s_add_u32 s43, s40, s49
    s_add_u32 m0, s43, 0
    s_nop 0
    buffer_load_dwordx4 v11, s[16:19], s48 offen offset:0 sc1 lds
    buffer_load_dwordx4 v11, s[16:19], s48 offen offset:1024 sc1 lds
    s_add_u32 s48, s48, 8192
    s_add_u32 s40, s40, 32768
    s_cmp_eq_u32 s40, 163840
    s_cselect_b32 s40, 0, s40
    s_sub_u32 s41, s41, 1
    s_cmp_lg_u32 s41, 0
    s_cbranch_scc1 .Lk3_ld_68
    s_waitcnt vmcnt(18)
    s_barrier
    s_waitcnt vmcnt(12)
    s_barrier
    s_waitcnt vmcnt(6)
    s_barrier
    s_waitcnt vmcnt(0)
    s_barrier
    s_endpgm
.Lk3_late_32:
    buffer_load_dwordx4 v[32:35], v11, s[32:35], 0 offen sc1
    buffer_load_dwordx4 v[36:39], v11, s[32:35], 0 offen offset:1024 sc1
    s_barrier
    s_waitcnt vmcnt(0)
    v_xor_b32 v32, s100, v32
    v_bitop3_b32 v32, v32, v33, s100 bitop3:0xf6
    v_bitop3_b32 v32, v32, v34, s100 bitop3:0xf6
    v_bitop3_b32 v32, v32, v35, s100 bitop3:0xf6
    v_bitop3_b32 v32, v32, v36, s100 bitop3:0xf6
    v_bitop3_b32 v32, v32, v37, s100 bitop3:0xf6
    v_bitop3_b32 v32, v32, v38, s100 bitop3:0xf6
    v_bitop3_b32 v32, v32, v39, s100 bitop3:0xf6
    v_cmp_ne_u32 vcc, 0, v32
    s_cbranch_vccnz .Lk3_late_33
    s_add_u32 s43, s44, 16384
    s_add_u32 m0, s43, 0
    s_nop 0
    buffer_load_dwordx4 v11, s[16:19], s48 offen offset:0 sc1 lds
    buffer_load_dwordx4 v11, s[16:19], s48 offen offset:1024 sc1 lds
    s_add_u32 s48, s48, 8192
    s_add_u32 s43, s44, 24576
    s_add_u32 m0, s43, 0
    s_nop 0
    buffer_load_dwordx4 v11, s[16:19], s48 offen offset:0 sc1 lds
    buffer_load_dwordx4 v11, s[16:19], s48 offen offset:1024 sc1 lds
    s_add_u32 s48, s48, 8192
    s_add_u32 s43, s44, 32768
    s_add_u32 m0, s43, 0
    s_nop 0
    buffer_load_dwordx4 v11, s[16:19], s48 offen offset:0 sc1 lds
    buffer_load_dwordx4 v11, s[16:19], s48 offen offset:1024 sc1 lds
    s_add_u32 s48, s48, 8192
    s_add_u32 s43, s44, 40960
    s_add_u32 m0, s43, 0
    s_nop 0
    buffer_load_dwordx4 v11, s[16:19], s48 offen offset:0 sc1 lds
    buffer_load_dwordx4 v11, s[16:19], s48 offen offset:1024 sc1 lds
    s_add_u32 s48, s48, 8192
    s_add_u32 s43, s44, 49152
    s_add_u32 m0, s43, 0
    s_nop 0
    buffer_load_dwordx4 v11, s[16:19], s48 offen offset:0 sc1 lds
    buffer_load_dwordx4 v11, s[16:19], s48 offen offset:1024 sc1 lds
    s_add_u32 s48, s48, 8192
    s_barrier
    s_add_u32 s43, s44, 57344
    s_add_u32 m0, s43, 0
    s_nop 0
    buffer_load_dwordx4 v11, s[16:19], s48 offen offset:0 sc1 lds
    buffer_load_dwordx4 v11, s[16:19], s48 offen offset:1024 sc1 lds
    s_add_u32 s48, s48, 8192
    s_add_u32 s43, s44, 65536
    s_add_u32 m0, s43, 0
    s_nop 0
    buffer_load_dwordx4 v11, s[16:19], s48 offen offset:0 sc1 lds
    buffer_load_dwordx4 v11, s[16:19], s48 offen offset:1024 sc1 lds
    s_add_u32 s48, s48, 8192
    s_add_u32 s43, s44, 73728
    s_add_u32 m0, s43, 0
    s_nop 0
    buffer_load_dwordx4 v11, s[16:19], s48 offen offset:0 sc1 lds
    buffer_load_dwordx4 v11, s[16:19], s48 offen offset:1024 sc1 lds
    s_add_u32 s48, s48, 8192
    s_add_u32 s43, s44, 0
    s_add_u32 m0, s43, 0
    s_nop 0
    buffer_load_dwordx4 v11, s[16:19], s48 offen offset:0 sc1 lds
    buffer_load_dwordx4 v11, s[16:19], s48 offen offset:1024 sc1 lds
    s_add_u32 s48, s48, 8192
    s_add_u32 s43, s44, 8192
    s_add_u32 m0, s43, 0
    s_nop 0
    buffer_load_dwordx4 v11, s[16:19], s48 offen offset:0 sc1 lds
    buffer_load_dwordx4 v11, s[16:19], s48 offen offset:1024 sc1 lds
    s_add_u32 s48, s48, 8192
    s_branch .Lk3_j3_34
.Lk3_late_33:
    s_barrier
    s_mov_b32 s59, 0x100000
.Lk3_sp_35:
    buffer_load_dwordx4 v[32:35], v11, s[32:35], 0 offen sc1
    buffer_load_dwordx4 v[36:39], v11, s[32:35], 0 offen offset:1024 sc1
    s_waitcnt vmcnt(0)
    v_xor_b32 v32, s100, v32
    v_bitop3_b32 v32, v32, v33, s100 bitop3:0xf6
    v_bitop3_b32 v32, v32, v34, s100 bitop3:0xf6
    v_bitop3_b32 v32, v32, v35, s100 bitop3:0xf6
    v_bitop3_b32 v32, v32, v36, s100 bitop3:0xf6
    v_bitop3_b32 v32, v32, v37, s100 bitop3:0xf6
    v_bitop3_b32 v32, v32, v38, s100 bitop3:0xf6
    v_bitop3_b32 v32, v32, v39, s100 bitop3:0xf6
    v_cmp_ne_u32 vcc, 0, v32
    s_cbranch_vccz .Lk3_so_36
    s_sub_u32 s59, s59, 1
    s_cbranch_scc0 .Lk3_sp_35
.Lk3_so_36:
    s_add_u32 s43, s44, 16384
    s_add_u32 m0, s43, 0
    s_nop 0
    buffer_load_dwordx4 v11, s[16:19], s48 offen offset:0 sc1 lds
    buffer_load_dwordx4 v11, s[16:19], s48 offen offset:1024 sc1 lds
    s_add_u32 s48, s48, 8192
    s_add_u32 s43, s44, 24576
    s_add_u32 m0, s43, 0
    s_nop 0
    buffer_load_dwordx4 v11, s[16:19], s48 offen offset:0 sc1 lds
    buffer_load_dwordx4 v11, s[16:19], s48 offen offset:1024 sc1 lds
    s_add_u32 s48, s48, 8192
    s_add_u32 s43, s44, 32768
    s_add_u32 m0, s43, 0
    s_nop 0
    buffer_load_dwordx4 v11, s[16:19], s48 offen offset:0 sc1 lds
    buffer_load_dwordx4 v11, s[16:19], s48 offen offset:1024 sc1 lds
    s_add_u32 s48, s48, 8192
    s_add_u32 s43, s44, 40960
    s_add_u32 m0, s43, 0
    s_nop 0
    buffer_load_dwordx4 v11, s[16:19], s48 offen offset:0 sc1 lds
    buffer_load_dwordx4 v11, s[16:19], s48 offen offset:1024 sc1 lds
    s_add_u32 s48, s48, 8192
    s_add_u32 s43, s44, 49152
    s_add_u32 m0, s43, 0
    s_nop 0
    buffer_load_dwordx4 v11, s[16:19], s48 offen offset:0 sc1 lds
    buffer_load_dwordx4 v11, s[16:19], s48 offen offset:1024 sc1 lds
    s_add_u32 s48, s48, 8192
    s_add_u32 s43, s44, 57344
    s_add_u32 m0, s43, 0
    s_nop 0
    buffer_load_dwordx4 v11, s[16:19], s48 offen offset:0 sc1 lds
    buffer_load_dwordx4 v11, s[16:19], s48 offen offset:1024 sc1 lds
    s_add_u32 s48, s48, 8192
    s_add_u32 s43, s44, 65536
    s_add_u32 m0, s43, 0
    s_nop 0
    buffer_load_dwordx4 v11, s[16:19], s48 offen offset:0 sc1 lds
    buffer_load_dwordx4 v11, s[16:19], s48 offen offset:1024 sc1 lds
    s_add_u32 s48, s48, 8192
    s_add_u32 s43, s44, 73728
    s_add_u32 m0, s43, 0
    s_nop 0
    buffer_load_dwordx4 v11, s[16:19], s48 offen offset:0 sc1 lds
    buffer_load_dwordx4 v11, s[16:19], s48 offen offset:1024 sc1 lds
    s_add_u32 s48, s48, 8192
    s_add_u32 s43, s44, 0
    s_add_u32 m0, s43, 0
    s_nop 0
    buffer_load_dwordx4 v11, s[16:19], s48 offen offset:0 sc1 lds
    buffer_load_dwordx4 v11, s[16:19], s48 offen offset:1024 sc1 lds
    s_add_u32 s48, s48, 8192
    s_add_u32 s43, s44, 8192
    s_add_u32 m0, s43, 0
    s_nop 0
    buffer_load_dwordx4 v11, s[16:19], s48 offen offset:0 sc1 lds
    buffer_load_dwordx4 v11, s[16:19], s48 offen offset:1024 sc1 lds
    s_add_u32 s48, s48, 8192
    s_branch .Lk3_j3_34
    .p2align 6
.Lk3_c4_15:
    s_lshl_b32 s56, s12, 3
    s_add_u32 s56, s56, s13
    s_lshl_b32 s56, s56, 2
    s_add_u32 s56, s56, s95
    s_lshl_b32 s56, s56, 4
    s_add_u32 s56, s56, 98304
    s_and_b32 s14, s2, 7
    s_lshr_b32 s15, s2, 3
    s_lshr_b32 s12, s14, 1
    s_lshl_b32 s12, s12, 2
    s_and_b32 s3, s15, 3
    s_add_u32 s12, s12, s3
    s_and_b32 s13, s14, 1
    s_lshl_b32 s13, s13, 3
    s_lshr_b32 s3, s15, 2
    s_add_u32 s13, s13, s3
    s_lshr_b32 s38, s95, 1
    s_and_b32 s39, s95, 1
    v_and_b32 v3, 15, v2
    v_lshrrev_b32 v4, 4, v2
    v_lshrrev_b32 v5, 2, v2
    v_and_b32 v5, 3, v5
    v_and_b32 v6, 3, v2
    v_and_b32 v7, 1, v4
    v_lshrrev_b32 v8, 1, v4
    v_lshl_add_u32 v8, v8, 2, v7
    v_mul_u32_u24 v8, 512, v8
    v_lshl_add_u32 v8, v5, 6, v8
    v_lshl_add_u32 v8, v6, 3, v8
    s_mul_i32 s40, s39, 0
    s_and_b32 s41, s40, 1
    v_xor_b32 v7, s41, v7
    v_lshl_add_u32 v8, v7, 5, v8
    s_lshr_b32 s41, s40, 1
    s_lshl_b32 s41, s41, 8
    v_add_u32 v10, s41, v8
    v_xor_b32 v8, 32, v8
    s_add_u32 s41, s40, 1
    s_lshr_b32 s41, s41, 1
    s_lshl_b32 s41, s41, 8
    v_add_u32 v11, s41, v8
    s_mul_i32 s41, s38, 8192
    s_add_u32 s41, s41, 0
    v_lshlrev_b32 v8, 4, v2
    v_add_u32 v12, s41, v8
    s_mov_b32 s43, 24576
    s_mov_b32 s40, 0
    v_add_u32 v12, 65536, v10
    v_add_u32 v14, 65536, v11
    s_lshl_b32 s46, s13, 1
    s_lshl_b32 s47, s12, 3
    s_lshl_b32 s3, s95, 1
    s_add_u32 s47, s47, s3
    v_lshlrev_b32 v5, 7, v3
    v_lshl_add_u32 v5, v4, 3, v5
    s_lshl_b32 s3, s95, 12
    s_add_u32 s3, s3, 81920
    v_add_u32 v13, s3, v5
    v_lshlrev_b32 v6, 4, v4
    v_lshlrev_b32 v15, 4, v2
    s_add_u32 s20, s6, 0
    s_addc_u32 s21, s7, 0
    s_mov_b32 s22, 98304
    s_mov_b32 s23, 0x20000
    s_add_u32 s32, s6, 62914560
    s_addc_u32 s33, s7, 0
    s_mov_b32 s34, 786432
    s_mov_b32 s35, 0x20000
    s_add_u32 s16, s6, 5242880
    s_addc_u32 s17, s7, 0
    s_mov_b32 s18, 4194304
    s_mov_b32 s19, 0x20000
    s_lshl_b32 s49, s46, 7
    s_add_u32 s50, s49, 128
    s_lshl_b32 s54, s47, 15
    s_add_u32 s55, s54, 32768
    s_barrier
    s_waitcnt vmcnt(0)
    v_mov_b32 v1, s100
    v_mov_b32 v5, 0
    s_mov_b64 exec, 1
    buffer_store_dword v1, v5, s[32:35], s56 offen sc1
    s_mov_b64 exec, -1
    s_waitcnt lgkmcnt(0)
    s_barrier
    v_add_u32 v6, 163328, v6
    s_add_u32 s24, s6, 9437184
    s_addc_u32 s25, s7, 0
    s_mov_b32 s26, 4194304
    s_mov_b32 s27, 0x20000
    s_add_u32 s28, s6, 13631488
    s_addc_u32 s29, s7, 0
    s_mov_b32 s30, 4194304
    s_mov_b32 s31, 0x20000
    v_lshlrev_b32 v5, 4, v2
    s_lshl_b32 s48, s47, 5
    s_add_u32 s48, s48, s46
    s_lshl_b32 s48, s48, 10
    s_add_u32 s51, s48, 1024
    s_add_u32 s52, s48, 32768
    s_add_u32 s53, s48, 33792
    v_lshrrev_b32 v7, 1, v4
    v_lshlrev_b32 v7, 12, v7
    v_and_b32 v8, 1, v4
    v_lshl_add_u32 v7, v8, 7, v7
    v_lshl_add_u32 v7, v3, 3, v7
    s_lshl_b32 s50, s47, 12
    s_add_u32 s50, s50, s49
    s_lshl_b32 s56, s12, 4
    s_add_u32 s56, s56, s13
    s_lshl_b32 s56, s56, 2
    s_add_u32 s56, s56, s95
    s_lshl_b32 s56, s56, 4
    s_add_u32 s56, s56, 196608
    ds_read_b64_tr_b16 v[80:81], v10 offset:16384
    ds_read_b64_tr_b16 v[82:83], v10 offset:17408
    ds_read_b64_tr_b16 v[84:85], v11 offset:16384
    ds_read_b64_tr_b16 v[86:87], v11 offset:17408
    ds_read_b64_tr_b16 v[88:89], v10 offset:16640
    ds_read_b64_tr_b16 v[90:91], v10 offset:17664
    ds_read_b64_tr_b16 v[92:93], v11 offset:16640
    ds_read_b64_tr_b16 v[94:95], v11 offset:17664
    s_barrier
    buffer_load_dwordx4 v[112:115], v15, s[16:19], s54 offen offset:0 sc1
    buffer_load_dwordx4 v[116:119], v15, s[16:19], s55 offen offset:0 sc1
    buffer_load_dwordx4 v[120:123], v15, s[16:19], s54 offen offset:1024 sc1
    buffer_load_dwordx4 v[124:127], v15, s[16:19], s55 offen offset:1024 sc1
    buffer_load_dwordx4 v[128:131], v15, s[16:19], s54 offen offset:2048 sc1
    buffer_load_dwordx4 v[132:135], v15, s[16:19], s55 offen offset:2048 sc1
    buffer_load_dwordx4 v[136:139], v15, s[16:19], s54 offen offset:3072 sc1
    buffer_load_dwordx4 v[140:143], v15, s[16:19], s55 offen offset:3072 sc1
    s_add_u32 s54, s54, 4096
    s_add_u32 s55, s55, 4096
    s_waitcnt vmcnt(6) lgkmcnt(0)
    v_mfma_f32_16x16x32_bf16 v[48:51], v[80:83], v[112:115], 0
    ds_read_b64_tr_b16 v[96:97], v10 offset:20480
    ds_read_b64_tr_b16 v[98:99], v10 offset:21504
    v_mfma_f32_16x16x32_bf16 v[64:67], v[80:83], v[116:119], 0
    ds_read_b64_tr_b16 v[100:101], v11 offset:20480
    ds_read_b64_tr_b16 v[102:103], v11 offset:21504
    buffer_load_dwordx4 v[144:147], v15, s[16:19], s54 offen offset:0 sc1
    v_mfma_f32_16x16x32_bf16 v[52:55], v[84:87], v[112:115], 0
    ds_read_b64_tr_b16 v[104:105], v10 offset:20736
    ds_read_b64_tr_b16 v[106:107], v10 offset:21760
    buffer_load_dwordx4 v[148:151], v15, s[16:19], s55 offen offset:0 sc1
    v_mfma_f32_16x16x32_bf16 v[68:71], v[84:87], v[116:119], 0
    ds_read_b64_tr_b16 v[108:109], v11 offset:20736
    ds_read_b64_tr_b16 v[110:111], v11 offset:21760
    buffer_load_dwordx4 v[152:155], v15, s[16:19], s54 offen offset:1024 sc1
    v_mfma_f32_16x16x32_bf16 v[56:59], v[88:91], v[112:115], 0
    v_mfma_f32_16x16x32_bf16 v[72:75], v[88:91], v[116:119], 0
    buffer_load_dwordx4 v[156:159], v15, s[16:19], s55 offen offset:1024 sc1
    v_mfma_f32_16x16x32_bf16 v[60:63], v[92:95], v[112:115], 0
    buffer_load_dwordx4 v[160:163], v15, s[16:19], s54 offen offset:2048 sc1
    v_mfma_f32_16x16x32_bf16 v[76:79], v[92:95], v[116:119], 0
    buffer_load_dwordx4 v[164:167], v15, s[16:19], s55 offen offset:2048 sc1
    s_waitcnt vmcnt(10) lgkmcnt(0)
    v_mfma_f32_16x16x32_bf16 v[48:51], v[96:99], v[120:123], v[48:51]
    ds_read_b64_tr_b16 v[80:81], v10 offset:24576
    ds_read_b64_tr_b16 v[82:83], v10 offset:25600
    v_mfma_f32_16x16x32_bf16 v[64:67], v[96:99], v[124:127], v[64:67]
    ds_read_b64_tr_b16 v[84:85], v11 offset:24576
    ds_read_b64_tr_b16 v[86:87], v11 offset:25600
    buffer_load_dwordx4 v[168:171], v15, s[16:19], s54 offen offset:3072 sc1
    v_mfma_f32_16x16x32_bf16 v[52:55], v[100:103], v[120:123], v[52:55]
    ds_read_b64_tr_b16 v[88:89], v10 offset:24832
    ds_read_b64_tr_b16 v[90:91], v10 offset:25856
    buffer_load_dwordx4 v[172:175], v15, s[16:19], s55 offen offset:3072 sc1
    v_mfma_f32_16x16x32_bf16 v[68:71], v[100:103], v[124:127], v[68:71]
    ds_read_b64_tr_b16 v[92:93], v11 offset:24832
    ds_read_b64_tr_b16 v[94:95], v11 offset:25856
    s_add_u32 s54, s54, 4096
    s_add_u32 s55, s55, 4096
    v_mfma_f32_16x16x32_bf16 v[56:59], v[104:107], v[120:123], v[56:59]
    buffer_load_dwordx4 v[176:179], v15, s[16:19], s54 offen offset:0 sc1
    v_mfma_f32_16x16x32_bf16 v[72:75], v[104:107], v[124:127], v[72:75]
    buffer_load_dwordx4 v[180:183], v15, s[16:19], s55 offen offset:0 sc1
    v_mfma_f32_16x16x32_bf16 v[60:63], v[108:111], v[120:123], v[60:63]
    buffer_load_dwordx4 v[184:187], v15, s[16:19], s54 offen offset:1024 sc1
    v_mfma_f32_16x16x32_bf16 v[76:79], v[108:111], v[124:127], v[76:79]
    buffer_load_dwordx4 v[188:191], v15, s[16:19], s55 offen offset:1024 sc1
    s_waitcnt vmcnt(14) lgkmcnt(0)
    v_mfma_f32_16x16x32_bf16 v[48:51], v[80:83], v[128:131], v[48:51]
    ds_read_b64_tr_b16 v[96:97], v10 offset:28672
    ds_read_b64_tr_b16 v[98:99], v10 offset:29696
    v_mfma_f32_16x16x32_bf16 v[64:67], v[80:83], v[132:135], v[64:67]
    ds_read_b64_tr_b16 v[100:101], v11 offset:28672
    ds_read_b64_tr_b16 v[102:103], v11 offset:29696
    buffer_load_dwordx4 v[192:195], v15, s[16:19], s54 offen offset:2048 sc1
    v_mfma_f32_16x16x32_bf16 v[52:55], v[84:87], v[128:131], v[52:55]
    ds_read_b64_tr_b16 v[104:105], v10 offset:28928
    ds_read_b64_tr_b16 v[106:107], v10 offset:29952
    buffer_load_dwordx4 v[196:199], v15, s[16:19], s55 offen offset:2048 sc1
    v_mfma_f32_16x16x32_bf16 v[68:71], v[84:87], v[132:135], v[68:71]
    ds_read_b64_tr_b16 v[108:109], v11 offset:28928
    ds_read_b64_tr_b16 v[110:111], v11 offset:29952
    buffer_load_dwordx4 v[200:203], v15, s[16:19], s54 offen offset:3072 sc1
    v_mfma_f32_16x16x32_bf16 v[56:59], v[88:91], v[128:131], v[56:59]
    buffer_load_dwordx4 v[204:207], v15, s[16:19], s55 offen offset:3072 sc1
    v_mfma_f32_16x16x32_bf16 v[72:75], v[88:91], v[132:135], v[72:75]
    s_add_u32 s54, s54, 4096
    s_add_u32 s55, s55, 4096
    v_mfma_f32_16x16x32_bf16 v[60:63], v[92:95], v[128:131], v[60:63]
    buffer_load_dwordx4 v[208:211], v15, s[16:19], s54 offen offset:0 sc1
    v_mfma_f32_16x16x32_bf16 v[76:79], v[92:95], v[132:135], v[76:79]
    buffer_load_dwordx4 v[212:215], v15, s[16:19], s55 offen offset:0 sc1
    s_waitcnt vmcnt(18) lgkmcnt(0)
    v_mfma_f32_16x16x32_bf16 v[48:51], v[96:99], v[136:139], v[48:51]
    ds_read_b64_tr_b16 v[80:81], v10 offset:32768
    ds_read_b64_tr_b16 v[82:83], v10 offset:33792
    v_mfma_f32_16x16x32_bf16 v[64:67], v[96:99], v[140:143], v[64:67]
    ds_read_b64_tr_b16 v[84:85], v11 offset:32768
    ds_read_b64_tr_b16 v[86:87], v11 offset:33792
    buffer_load_dwordx4 v[216:219], v15, s[16:19], s54 offen offset:1024 sc1
    v_mfma_f32_16x16x32_bf16 v[52:55], v[100:103], v[136:139], v[52:55]
    ds_read_b64_tr_b16 v[88:89], v10 offset:33024
    ds_read_b64_tr_b16 v[90:91], v10 offset:34048
    buffer_load_dwordx4 v[220:223], v15, s[16:19], s55 offen offset:1024 sc1
    v_mfma_f32_16x16x32_bf16 v[68:71], v[100:103], v[140:143], v[68:71]
    ds_read_b64_tr_b16 v[92:93], v11 offset:33024
    ds_read_b64_tr_b16 v[94:95], v11 offset:34048
    buffer_load_dwordx4 v[224:227], v15, s[16:19], s54 offen offset:2048 sc1
    v_mfma_f32_16x16x32_bf16 v[56:59], v[104:107], v[136:139], v[56:59]
    buffer_load_dwordx4 v[228:231], v15, s[16:19], s55 offen offset:2048 sc1
    v_mfma_f32_16x16x32_bf16 v[72:75], v[104:107], v[140:143], v[72:75]
    buffer_load_dwordx4 v[232:235], v15, s[16:19], s54 offen offset:3072 sc1
    v_mfma_f32_16x16x32_bf16 v[60:63], v[108:111], v[136:139], v[60:63]
    buffer_load_dwordx4 v[236:239], v15, s[16:19], s55 offen offset:3072 sc1
    v_mfma_f32_16x16x32_bf16 v[76:79], v[108:111], v[140:143], v[76:79]
    s_add_u32 s54, s54, 4096
    s_add_u32 s55, s55, 4096
    s_waitcnt vmcnt(22) lgkmcnt(0)
    v_mfma_f32_16x16x32_bf16 v[48:51], v[80:83], v[144:147], v[48:51]
    ds_read_b64_tr_b16 v[96:97], v10 offset:36864
    ds_read_b64_tr_b16 v[98:99], v10 offset:37888
    v_mfma_f32_16x16x32_bf16 v[64:67], v[80:83], v[148:151], v[64:67]
    ds_read_b64_tr_b16 v[100:101], v11 offset:36864
    ds_read_b64_tr_b16 v[102:103], v11 offset:37888
    buffer_load_dwordx4 v[112:115], v15, s[16:19], s54 offen offset:0 sc1
    v_mfma_f32_16x16x32_bf16 v[52:55], v[84:87], v[144:147], v[52:55]
    ds_read_b64_tr_b16 v[104:105], v10 offset:37120
    ds_read_b64_tr_b16 v[106:107], v10 offset:38144
    buffer_load_dwordx4 v[116:119], v15, s[16:19], s55 offen offset:0 sc1
    v_mfma_f32_16x16x32_bf16 v[68:71], v[84:87], v[148:151], v[68:71]
    ds_read_b64_tr_b16 v[108:109], v11 offset:37120
    ds_read_b64_tr_b16 v[110:111], v11 offset:38144
    buffer_load_dwordx4 v[120:123], v15, s[16:19], s54 offen offset:1024 sc1
    v_mfma_f32_16x16x32_bf16 v[56:59], v[88:91], v[144:147], v[56:59]
    v_mfma_f32_16x16x32_bf16 v[72:75], v[88:91], v[148:151], v[72:75]
    buffer_load_dwordx4 v[124:127], v15, s[16:19], s55 offen offset:1024 sc1
    v_mfma_f32_16x16x32_bf16 v[60:63], v[92:95], v[144:147], v[60:63]
    buffer_load_dwordx4 v[128:131], v15, s[16:19], s54 offen offset:2048 sc1
    v_mfma_f32_16x16x32_bf16 v[76:79], v[92:95], v[148:151], v[76:79]
    buffer_load_dwordx4 v[132:135], v15, s[16:19], s55 offen offset:2048 sc1
    s_waitcnt vmcnt(26) lgkmcnt(0)
    v_mfma_f32_16x16x32_bf16 v[48:51], v[96:99], v[152:155], v[48:51]
    ds_read_b64_tr_b16 v[80:81], v10 offset:40960
    ds_read_b64_tr_b16 v[82:83], v10 offset:41984
    v_mfma_f32_16x16x32_bf16 v[64:67], v[96:99], v[156:159], v[64:67]
    ds_read_b64_tr_b16 v[84:85], v11 offset:40960
    ds_read_b64_tr_b16 v[86:87], v11 offset:41984
    buffer_load_dwordx4 v[136:139], v15, s[16:19], s54 offen offset:3072 sc1
    v_mfma_f32_16x16x32_bf16 v[52:55], v[100:103], v[152:155], v[52:55]
    ds_read_b64_tr_b16 v[88:89], v10 offset:41216
    ds_read_b64_tr_b16 v[90:91], v10 offset:42240
    v_mfma_f32_16x16x32_bf16 v[68:71], v[100:103], v[156:159], v[68:71]
    ds_read_b64_tr_b16 v[92:93], v11 offset:41216
    ds_read_b64_tr_b16 v[94:95], v11 offset:42240
    buffer_load_dwordx4 v[140:143], v15, s[16:19], s55 offen offset:3072 sc1
    v_mfma_f32_16x16x32_bf16 v[56:59], v[104:107], v[152:155], v[56:59]
    s_add_u32 s54, s54, 4096
    s_add_u32 s55, s55, 4096
    v_mfma_f32_16x16x32_bf16 v[72:75], v[104:107], v[156:159], v[72:75]
    v_mfma_f32_16x16x32_bf16 v[60:63], v[108:111], v[152:155], v[60:63]
    buffer_load_dwordx4 v[144:147], v15, s[16:19], s54 offen offset:0 sc1
    v_mfma_f32_16x16x32_bf16 v[76:79], v[108:111], v[156:159], v[76:79]
    buffer_load_dwordx4 v[148:151], v15, s[16:19], s55 offen offset:0 sc1
    s_waitcnt vmcnt(28) lgkmcnt(0)
    v_mfma_f32_16x16x32_bf16 v[48:51], v[80:83], v[160:163], v[48:51]
    ds_read_b64_tr_b16 v[96:97], v10 offset:45056
    ds_read_b64_tr_b16 v[98:99], v10 offset:46080
    v_mfma_f32_16x16x32_bf16 v[64:67], v[80:83], v[164:167], v[64:67]
    ds_read_b64_tr_b16 v[100:101], v11 offset:45056
    ds_read_b64_tr_b16 v[102:103], v11 offset:46080
    v_mfma_f32_16x16x32_bf16 v[52:55], v[84:87], v[160:163], v[52:55]
    ds_read_b64_tr_b16 v[104:105], v10 offset:45312
    ds_read_b64_tr_b16 v[106:107], v10 offset:46336
    v_mfma_f32_16x16x32_bf16 v[68:71], v[84:87], v[164:167], v[68:71]
    ds_read_b64_tr_b16 v[108:109], v11 offset:45312
    ds_read_b64_tr_b16 v[110:111], v11 offset:46336
    buffer_load_dwordx4 v[152:155], v15, s[16:19], s54 offen offset:1024 sc1
    v_mfma_f32_16x16x32_bf16 v[56:59], v[88:91], v[160:163], v[56:59]
    v_mfma_f32_16x16x32_bf16 v[72:75], v[88:91], v[164:167], v[72:75]
    v_mfma_f32_16x16x32_bf16 v[60:63], v[92:95], v[160:163], v[60:63]
    v_mfma_f32_16x16x32_bf16 v[76:79], v[92:95], v[164:167], v[76:79]
    buffer_load_dwordx4 v[156:159], v15, s[16:19], s55 offen offset:1024 sc1
    s_waitcnt vmcnt(28) lgkmcnt(0)
    v_mfma_f32_16x16x32_bf16 v[48:51], v[96:99], v[168:171], v[48:51]
    ds_read_b64_tr_b16 v[80:81], v10 offset:49152
    ds_read_b64_tr_b16 v[82:83], v10 offset:50176
    v_mfma_f32_16x16x32_bf16 v[64:67], v[96:99], v[172:175], v[64:67]
    ds_read_b64_tr_b16 v[84:85], v11 offset:49152
    ds_read_b64_tr_b16 v[86:87], v11 offset:50176
    v_mfma_f32_16x16x32_bf16 v[52:55], v[100:103], v[168:171], v[52:55]
    ds_read_b64_tr_b16 v[88:89], v10 offset:49408
    ds_read_b64_tr_b16 v[90:91], v10 offset:50432
    v_mfma_f32_16x16x32_bf16 v[68:71], v[100:103], v[172:175], v[68:71]
    ds_read_b64_tr_b16 v[92:93], v11 offset:49408
    ds_read_b64_tr_b16 v[94:95], v11 offset:50432
    buffer_load_dwordx4 v[160:163], v15, s[16:19], s54 offen offset:2048 sc1
    v_mfma_f32_16x16x32_bf16 v[56:59], v[104:107], v[168:171], v[56:59]
    v_mfma_f32_16x16x32_bf16 v[72:75], v[104:107], v[172:175], v[72:75]
    v_mfma_f32_16x16x32_bf16 v[60:63], v[108:111], v[168:171], v[60:63]
    v_mfma_f32_16x16x32_bf16 v[76:79], v[108:111], v[172:175], v[76:79]
    buffer_load_dwordx4 v[164:167], v15, s[16:19], s55 offen offset:2048 sc1
    s_waitcnt vmcnt(28) lgkmcnt(0)
    v_mfma_f32_16x16x32_bf16 v[48:51], v[80:83], v[176:179], v[48:51]
    ds_read_b64_tr_b16 v[96:97], v10 offset:53248
    ds_read_b64_tr_b16 v[98:99], v10 offset:54272
    v_mfma_f32_16x16x32_bf16 v[64:67], v[80:83], v[180:183], v[64:67]
    ds_read_b64_tr_b16 v[100:101], v11 offset:53248
    ds_read_b64_tr_b16 v[102:103], v11 offset:54272
    v_mfma_f32_16x16x32_bf16 v[52:55], v[84:87], v[176:179], v[52:55]
    ds_read_b64_tr_b16 v[104:105], v10 offset:53504
    ds_read_b64_tr_b16 v[106:107], v10 offset:54528
    buffer_load_dwordx4 v[168:171], v15, s[16:19], s54 offen offset:3072 sc1
    v_mfma_f32_16x16x32_bf16 v[68:71], v[84:87], v[180:183], v[68:71]
    ds_read_b64_tr_b16 v[108:109], v11 offset:53504
    ds_read_b64_tr_b16 v[110:111], v11 offset:54528
    v_mfma_f32_16x16x32_bf16 v[56:59], v[88:91], v[176:179], v[56:59]
    v_mfma_f32_16x16x32_bf16 v[72:75], v[88:91], v[180:183], v[72:75]
    buffer_load_dwordx4 v[172:175], v15, s[16:19], s55 offen offset:3072 sc1
    v_mfma_f32_16x16x32_bf16 v[60:63], v[92:95], v[176:179], v[60:63]
    v_mfma_f32_16x16x32_bf16 v[76:79], v[92:95], v[180:183], v[76:79]
    s_add_u32 s54, s54, 4096
    s_add_u32 s55, s55, 4096
    s_waitcnt vmcnt(28) lgkmcnt(0)
    v_mfma_f32_16x16x32_bf16 v[48:51], v[96:99], v[184:187], v[48:51]
    ds_read_b64_tr_b16 v[80:81], v10 offset:57344
    ds_read_b64_tr_b16 v[82:83], v10 offset:58368
    v_mfma_f32_16x16x32_bf16 v[64:67], v[96:99], v[188:191], v[64:67]
    ds_read_b64_tr_b16 v[84:85], v11 offset:57344
    ds_read_b64_tr_b16 v[86:87], v11 offset:58368
    v_mfma_f32_16x16x32_bf16 v[52:55], v[100:103], v[184:187], v[52:55]
    ds_read_b64_tr_b16 v[88:89], v10 offset:57600
    ds_read_b64_tr_b16 v[90:91], v10 offset:58624
    v_mfma_f32_16x16x32_bf16 v[68:71], v[100:103], v[188:191], v[68:71]
    ds_read_b64_tr_b16 v[92:93], v11 offset:57600
    ds_read_b64_tr_b16 v[94:95], v11 offset:58624
    buffer_load_dwordx4 v[176:179], v15, s[16:19], s54 offen offset:0 sc1
    v_mfma_f32_16x16x32_bf16 v[56:59], v[104:107], v[184:187], v[56:59]
    v_mfma_f32_16x16x32_bf16 v[72:75], v[104:107], v[188:191], v[72:75]
    v_mfma_f32_16x16x32_bf16 v[60:63], v[108:111], v[184:187], v[60:63]
    v_mfma_f32_16x16x32_bf16 v[76:79], v[108:111], v[188:191], v[76:79]
    buffer_load_dwordx4 v[180:183], v15, s[16:19], s55 offen offset:0 sc1
    s_waitcnt vmcnt(28) lgkmcnt(0)
    v_mfma_f32_16x16x32_bf16 v[48:51], v[80:83], v[192:195], v[48:51]
    ds_read_b64_tr_b16 v[96:97], v10 offset:61440
    ds_read_b64_tr_b16 v[98:99], v10 offset:62464
    v_mfma_f32_16x16x32_bf16 v[64:67], v[80:83], v[196:199], v[64:67]
    ds_read_b64_tr_b16 v[100:101], v11 offset:61440
    ds_read_b64_tr_b16 v[102:103], v11 offset:62464
    v_mfma_f32_16x16x32_bf16 v[52:55], v[84:87], v[192:195], v[52:55]
    ds_read_b64_tr_b16 v[104:105], v10 offset:61696
    ds_read_b64_tr_b16 v[106:107], v10 offset:62720
    v_mfma_f32_16x16x32_bf16 v[68:71], v[84:87], v[196:199], v[68:71]
    ds_read_b64_tr_b16 v[108:109], v11 offset:61696
    ds_read_b64_tr_b16 v[110:111], v11 offset:62720
    buffer_load_dwordx4 v[184:187], v15, s[16:19], s54 offen offset:1024 sc1
    v_mfma_f32_16x16x32_bf16 v[56:59], v[88:91], v[192:195], v[56:59]
    v_mfma_f32_16x16x32_bf16 v[72:75], v[88:91], v[196:199], v[72:75]
    v_mfma_f32_16x16x32_bf16 v[60:63], v[92:95], v[192:195], v[60:63]
    v_mfma_f32_16x16x32_bf16 v[76:79], v[92:95], v[196:199], v[76:79]
    buffer_load_dwordx4 v[188:191], v15, s[16:19], s55 offen offset:1024 sc1
    s_waitcnt vmcnt(28) lgkmcnt(0)
    v_mfma_f32_16x16x32_bf16 v[48:51], v[96:99], v[200:203], v[48:51]
    ds_read_b64_tr_b16 v[80:81], v12 offset:0
    ds_read_b64_tr_b16 v[82:83], v12 offset:1024
    v_mfma_f32_16x16x32_bf16 v[64:67], v[96:99], v[204:207], v[64:67]
    ds_read_b64_tr_b16 v[84:85], v14 offset:0
    ds_read_b64_tr_b16 v[86:87], v14 offset:1024
    v_mfma_f32_16x16x32_bf16 v[52:55], v[100:103], v[200:203], v[52:55]
    ds_read_b64_tr_b16 v[88:89], v12 offset:256
    ds_read_b64_tr_b16 v[90:91], v12 offset:1280
    v_mfma_f32_16x16x32_bf16 v[68:71], v[100:103], v[204:207], v[68:71]
    ds_read_b64_tr_b16 v[92:93], v14 offset:256
    ds_read_b64_tr_b16 v[94:95], v14 offset:1280
    buffer_load_dwordx4 v[192:195], v15, s[16:19], s54 offen offset:2048 sc1
    v_mfma_f32_16x16x32_bf16 v[56:59], v[104:107], v[200:203], v[56:59]
    v_mfma_f32_16x16x32_bf16 v[72:75], v[104:107], v[204:207], v[72:75]
    v_mfma_f32_16x16x32_bf16 v[60:63], v[108:111], v[200:203], v[60:63]
    v_mfma_f32_16x16x32_bf16 v[76:79], v[108:111], v[204:207], v[76:79]
    buffer_load_dwordx4 v[196:199], v15, s[16:19], s55 offen offset:2048 sc1
    s_waitcnt vmcnt(28) lgkmcnt(0)
    v_mfma_f32_16x16x32_bf16 v[48:51], v[80:83], v[208:211], v[48:51]
    ds_read_b64_tr_b16 v[96:97], v12 offset:4096
    ds_read_b64_tr_b16 v[98:99], v12 offset:5120
    v_mfma_f32_16x16x32_bf16 v[64:67], v[80:83], v[212:215], v[64:67]
    ds_read_b64_tr_b16 v[100:101], v14 offset:4096
    ds_read_b64_tr_b16 v[102:103], v14 offset:5120
    v_mfma_f32_16x16x32_bf16 v[52:55], v[84:87], v[208:211], v[52:55]
    ds_read_b64_tr_b16 v[104:105], v12 offset:4352
    ds_read_b64_tr_b16 v[106:107], v12 offset:5376
    buffer_load_dwordx4 v[200:203], v15, s[16:19], s54 offen offset:3072 sc1
    v_mfma_f32_16x16x32_bf16 v[68:71], v[84:87], v[212:215], v[68:71]
    ds_read_b64_tr_b16 v[108:109], v14 offset:4352
    ds_read_b64_tr_b16 v[110:111], v14 offset:5376
    v_mfma_f32_16x16x32_bf16 v[56:59], v[88:91], v[208:211], v[56:59]
    v_mfma_f32_16x16x32_bf16 v[72:75], v[88:91], v[212:215], v[72:75]
    buffer_load_dwordx4 v[204:207], v15, s[16:19], s55 offen offset:3072 sc1
    v_mfma_f32_16x16x32_bf16 v[60:63], v[92:95], v[208:211], v[60:63]
    v_mfma_f32_16x16x32_bf16 v[76:79], v[92:95], v[212:215], v[76:79]
    s_add_u32 s54, s54, 4096
    s_add_u32 s55, s55, 4096
    s_waitcnt vmcnt(28) lgkmcnt(0)
    v_mfma_f32_16x16x32_bf16 v[48:51], v[96:99], v[216:219], v[48:51]
    ds_read_b64_tr_b16 v[80:81], v12 offset:8192
    ds_read_b64_tr_b16 v[82:83], v12 offset:9216
    v_mfma_f32_16x16x32_bf16 v[64:67], v[96:99], v[220:223], v[64:67]
    ds_read_b64_tr_b16 v[84:85], v14 offset:8192
    ds_read_b64_tr_b16 v[86:87], v14 offset:9216
    v_mfma_f32_16x16x32_bf16 v[52:55], v[100:103], v[216:219], v[52:55]
    ds_read_b64_tr_b16 v[88:89], v12 offset:8448
    ds_read_b64_tr_b16 v[90:91], v12 offset:9472
    v_mfma_f32_16x16x32_bf16 v[68:71], v[100:103], v[220:223], v[68:71]
    ds_read_b64_tr_b16 v[92:93], v14 offset:8448
    ds_read_b64_tr_b16 v[94:95], v14 offset:9472
    buffer_load_dwordx4 v[208:211], v15, s[16:19], s54 offen offset:0 sc1
    v_mfma_f32_16x16x32_bf16 v[56:59], v[104:107], v[216:219], v[56:59]
    v_mfma_f32_16x16x32_bf16 v[72:75], v[104:107], v[220:223], v[72:75]
    v_mfma_f32_16x16x32_bf16 v[60:63], v[108:111], v[216:219], v[60:63]
    v_mfma_f32_16x16x32_bf16 v[76:79], v[108:111], v[220:223], v[76:79]
    buffer_load_dwordx4 v[212:215], v15, s[16:19], s55 offen offset:0 sc1
    s_waitcnt vmcnt(28) lgkmcnt(0)
    v_mfma_f32_16x16x32_bf16 v[48:51], v[80:83], v[224:227], v[48:51]
    ds_read_b64_tr_b16 v[96:97], v12 offset:12288
    ds_read_b64_tr_b16 v[98:99], v12 offset:13312
    v_mfma_f32_16x16x32_bf16 v[64:67], v[80:83], v[228:231], v[64:67]
    ds_read_b64_tr_b16 v[100:101], v14 offset:12288
    ds_read_b64_tr_b16 v[102:103], v14 offset:13312
    v_mfma_f32_16x16x32_bf16 v[52:55], v[84:87], v[224:227], v[52:55]
    ds_read_b64_tr_b16 v[104:105], v12 offset:12544
    ds_read_b64_tr_b16 v[106:107], v12 offset:13568
    v_mfma_f32_16x16x32_bf16 v[68:71], v[84:87], v[228:231], v[68:71]
    ds_read_b64_tr_b16 v[108:109], v14 offset:12544
    ds_read_b64_tr_b16 v[110:111], v14 offset:13568
    buffer_load_dwordx4 v[216:219], v15, s[16:19], s54 offen offset:1024 sc1
    v_mfma_f32_16x16x32_bf16 v[56:59], v[88:91], v[224:227], v[56:59]
    v_mfma_f32_16x16x32_bf16 v[72:75], v[88:91], v[228:231], v[72:75]
    v_mfma_f32_16x16x32_bf16 v[60:63], v[92:95], v[224:227], v[60:63]
    v_mfma_f32_16x16x32_bf16 v[76:79], v[92:95], v[228:231], v[76:79]
    buffer_load_dwordx4 v[220:223], v15, s[16:19], s55 offen offset:1024 sc1
    s_waitcnt vmcnt(28) lgkmcnt(0)
    v_mfma_f32_16x16x32_bf16 v[48:51], v[96:99], v[232:235], v[48:51]
    ds_read_b64_tr_b16 v[80:81], v10 offset:0
    ds_read_b64_tr_b16 v[82:83], v10 offset:1024
    v_mfma_f32_16x16x32_bf16 v[64:67], v[96:99], v[236:239], v[64:67]
    ds_read_b64_tr_b16 v[84:85], v11 offset:0
    ds_read_b64_tr_b16 v[86:87], v11 offset:1024
    v_mfma_f32_16x16x32_bf16 v[52:55], v[100:103], v[232:235], v[52:55]
    ds_read_b64_tr_b16 v[88:89], v10 offset:256
    ds_read_b64_tr_b16 v[90:91], v10 offset:1280
    v_mfma_f32_16x16x32_bf16 v[68:71], v[100:103], v[236:239], v[68:71]
    ds_read_b64_tr_b16 v[92:93], v11 offset:256
    ds_read_b64_tr_b16 v[94:95], v11 offset:1280
    buffer_load_dwordx4 v[224:227], v15, s[16:19], s54 offen offset:2048 sc1
    v_mfma_f32_16x16x32_bf16 v[56:59], v[104:107], v[232:235], v[56:59]
    v_mfma_f32_16x16x32_bf16 v[72:75], v[104:107], v[236:239], v[72:75]
    v_mfma_f32_16x16x32_bf16 v[60:63], v[108:111], v[232:235], v[60:63]
    v_mfma_f32_16x16x32_bf16 v[76:79], v[108:111], v[236:239], v[76:79]
    buffer_load_dwordx4 v[228:231], v15, s[16:19], s55 offen offset:2048 sc1
    s_waitcnt vmcnt(28) lgkmcnt(0)
    v_mfma_f32_16x16x32_bf16 v[48:51], v[80:83], v[112:115], v[48:51]
    ds_read_b64_tr_b16 v[96:97], v10 offset:4096
    ds_read_b64_tr_b16 v[98:99], v10 offset:5120
    v_mfma_f32_16x16x32_bf16 v[64:67], v[80:83], v[116:119], v[64:67]
    ds_read_b64_tr_b16 v[100:101], v11 offset:4096
    ds_read_b64_tr_b16 v[102:103], v11 offset:5120
    v_mfma_f32_16x16x32_bf16 v[52:55], v[84:87], v[112:115], v[52:55]
    ds_read_b64_tr_b16 v[104:105], v10 offset:4352
    ds_read_b64_tr_b16 v[106:107], v10 offset:5376
    buffer_load_dwordx4 v[232:235], v15, s[16:19], s54 offen offset:3072 sc1
    v_mfma_f32_16x16x32_bf16 v[68:71], v[84:87], v[116:119], v[68:71]
    ds_read_b64_tr_b16 v[108:109], v11 offset:4352
    ds_read_b64_tr_b16 v[110:111], v11 offset:5376
    v_mfma_f32_16x16x32_bf16 v[56:59], v[88:91], v[112:115], v[56:59]
    v_mfma_f32_16x16x32_bf16 v[72:75], v[88:91], v[116:119], v[72:75]
    buffer_load_dwordx4 v[236:239], v15, s[16:19], s55 offen offset:3072 sc1
    v_mfma_f32_16x16x32_bf16 v[60:63], v[92:95], v[112:115], v[60:63]
    v_mfma_f32_16x16x32_bf16 v[76:79], v[92:95], v[116:119], v[76:79]
    s_add_u32 s54, s54, 4096
    s_add_u32 s55, s55, 4096
    s_waitcnt vmcnt(28) lgkmcnt(0)
    v_mfma_f32_16x16x32_bf16 v[48:51], v[96:99], v[120:123], v[48:51]
    ds_read_b64_tr_b16 v[80:81], v10 offset:8192
    ds_read_b64_tr_b16 v[82:83], v10 offset:9216
    v_mfma_f32_16x16x32_bf16 v[64:67], v[96:99], v[124:127], v[64:67]
    ds_read_b64_tr_b16 v[84:85], v11 offset:8192
    ds_read_b64_tr_b16 v[86:87], v11 offset:9216
    v_mfma_f32_16x16x32_bf16 v[52:55], v[100:103], v[120:123], v[52:55]
    ds_read_b64_tr_b16 v[88:89], v10 offset:8448
    ds_read_b64_tr_b16 v[90:91], v10 offset:9472
    v_mfma_f32_16x16x32_bf16 v[68:71], v[100:103], v[124:127], v[68:71]
    ds_read_b64_tr_b16 v[92:93], v11 offset:8448
    ds_read_b64_tr_b16 v[94:95], v11 offset:9472
    v_mfma_f32_16x16x32_bf16 v[56:59], v[104:107], v[120:123], v[56:59]
    v_mfma_f32_16x16x32_bf16 v[72:75], v[104:107], v[124:127], v[72:75]
    v_mfma_f32_16x16x32_bf16 v[60:63], v[108:111], v[120:123], v[60:63]
    v_mfma_f32_16x16x32_bf16 v[76:79], v[108:111], v[124:127], v[76:79]
    s_waitcnt vmcnt(26) lgkmcnt(0)
    v_mfma_f32_16x16x32_bf16 v[48:51], v[80:83], v[128:131], v[48:51]
    ds_read_b64_tr_b16 v[96:97], v10 offset:12288
    ds_read_b64_tr_b16 v[98:99], v10 offset:13312
    ds_read_b64 v[112:113], v13 offset:0
    v_mfma_f32_16x16x32_bf16 v[64:67], v[80:83], v[132:135], v[64:67]
    ds_read_b64_tr_b16 v[100:101], v11 offset:12288
    ds_read_b64_tr_b16 v[102:103], v11 offset:13312
    ds_read_b64 v[114:115], v13 offset:32
    v_mfma_f32_16x16x32_bf16 v[52:55], v[84:87], v[128:131], v[52:55]
    ds_read_b64_tr_b16 v[104:105], v10 offset:12544
    ds_read_b64_tr_b16 v[106:107], v10 offset:13568
    ds_read_b64 v[116:117], v13 offset:64
    v_mfma_f32_16x16x32_bf16 v[68:71], v[84:87], v[132:135], v[68:71]
    ds_read_b64_tr_b16 v[108:109], v11 offset:12544
    ds_read_b64_tr_b16 v[110:111], v11 offset:13568
    ds_read_b64 v[118:119], v13 offset:96
    v_mfma_f32_16x16x32_bf16 v[56:59], v[88:91], v[128:131], v[56:59]
    ds_read_b64 v[120:121], v13 offset:2048
    v_mfma_f32_16x16x32_bf16 v[72:75], v[88:91], v[132:135], v[72:75]
    ds_read_b64 v[122:123], v13 offset:2080
    v_mfma_f32_16x16x32_bf16 v[60:63], v[92:95], v[128:131], v[60:63]
    ds_read_b64 v[124:125], v13 offset:2112
    v_mfma_f32_16x16x32_bf16 v[76:79], v[92:95], v[132:135], v[76:79]
    ds_read_b64 v[126:127], v13 offset:2144
    s_waitcnt vmcnt(24) lgkmcnt(0)
    s_barrier
    v_add_u32 v10, 0x20000, v10
    v_add_u32 v11, 0x20000, v11
    v_mfma_f32_16x16x32_bf16 v[48:51], v[96:99], v[136:139], v[48:51]
    ds_read_b64_tr_b16 v[80:81], v12 offset:32768
    ds_read_b64_tr_b16 v[82:83], v12 offset:33792
    v_mfma_f32_16x16x32_bf16 v[64:67], v[96:99], v[140:143], v[64:67]
    ds_read_b64_tr_b16 v[84:85], v14 offset:32768
    ds_read_b64_tr_b16 v[86:87], v14 offset:33792
    v_mfma_f32_16x16x32_bf16 v[52:55], v[100:103], v[136:139], v[52:55]
    ds_read_b64_tr_b16 v[88:89], v12 offset:33024
    ds_read_b64_tr_b16 v[90:91], v12 offset:34048
    v_mfma_f32_16x16x32_bf16 v[68:71], v[100:103], v[140:143], v[68:71]
    ds_read_b64_tr_b16 v[92:93], v14 offset:33024
    ds_read_b64_tr_b16 v[94:95], v14 offset:34048
    v_mfma_f32_16x16x32_bf16 v[56:59], v[104:107], v[136:139], v[56:59]
    v_mfma_f32_16x16x32_bf16 v[72:75], v[104:107], v[140:143], v[72:75]
    v_mfma_f32_16x16x32_bf16 v[60:63], v[108:111], v[136:139], v[60:63]
    v_mfma_f32_16x16x32_bf16 v[76:79], v[108:111], v[140:143], v[76:79]
    s_waitcnt vmcnt(22) lgkmcnt(0)
    v_mfma_f32_16x16x32_bf16 v[48:51], v[80:83], v[144:147], v[48:51]
    ds_read_b64_tr_b16 v[96:97], v12 offset:36864
    ds_read_b64_tr_b16 v[98:99], v12 offset:37888
    ds_read_b128 v[16:19], v6 offset:0
    v_mfma_f32_16x16x32_bf16 v[64:67], v[80:83], v[148:151], v[64:67]
    ds_read_b64_tr_b16 v[100:101], v14 offset:36864
    ds_read_b64_tr_b16 v[102:103], v14 offset:37888
    ds_read_b128 v[20:23], v6 offset:64
    v_mfma_f32_16x16x32_bf16 v[52:55], v[84:87], v[144:147], v[52:55]
    ds_read_b64_tr_b16 v[104:105], v12 offset:37120
    ds_read_b64_tr_b16 v[106:107], v12 offset:38144
    ds_read_b128 v[24:27], v6 offset:128
    v_mfma_f32_16x16x32_bf16 v[68:71], v[84:87], v[148:151], v[68:71]
    ds_read_b64_tr_b16 v[108:109], v14 offset:37120
    ds_read_b64_tr_b16 v[110:111], v14 offset:38144
    ds_read_b128 v[28:31], v6 offset:192
    v_mfma_f32_16x16x32_bf16 v[56:59], v[88:91], v[144:147], v[56:59]
    ds_read_b128 v[32:35], v6 offset:256
    v_mfma_f32_16x16x32_bf16 v[72:75], v[88:91], v[148:151], v[72:75]
    ds_read_b128 v[36:39], v6 offset:320
    v_mfma_f32_16x16x32_bf16 v[60:63], v[92:95], v[144:147], v[60:63]
    ds_read_b128 v[40:43], v6 offset:384
    v_mfma_f32_16x16x32_bf16 v[76:79], v[92:95], v[148:151], v[76:79]
    ds_read_b128 v[44:47], v6 offset:448
    s_waitcnt vmcnt(20) lgkmcnt(0)
    v_mfma_f32_16x16x32_bf16 v[48:51], v[96:99], v[152:155], v[48:51]
    ds_read_b64_tr_b16 v[80:81], v12 offset:40960
    ds_read_b64_tr_b16 v[82:83], v12 offset:41984
    v_mfma_f32_16x16x32_bf16 v[64:67], v[96:99], v[156:159], v[64:67]
    ds_read_b64_tr_b16 v[84:85], v14 offset:40960
    ds_read_b64_tr_b16 v[86:87], v14 offset:41984
    v_mfma_f32_16x16x32_bf16 v[52:55], v[100:103], v[152:155], v[52:55]
    ds_read_b64_tr_b16 v[88:89], v12 offset:41216
    ds_read_b64_tr_b16 v[90:91], v12 offset:42240
    v_mfma_f32_16x16x32_bf16 v[68:71], v[100:103], v[156:159], v[68:71]
    ds_read_b64_tr_b16 v[92:93], v14 offset:41216
    ds_read_b64_tr_b16 v[94:95], v14 offset:42240
    v_mfma_f32_16x16x32_bf16 v[56:59], v[104:107], v[152:155], v[56:59]
    v_mfma_f32_16x16x32_bf16 v[72:75], v[104:107], v[156:159], v[72:75]
    v_mfma_f32_16x16x32_bf16 v[60:63], v[108:111], v[152:155], v[60:63]
    v_mfma_f32_16x16x32_bf16 v[76:79], v[108:111], v[156:159], v[76:79]
    s_waitcnt vmcnt(18) lgkmcnt(0)
    v_mfma_f32_16x16x32_bf16 v[48:51], v[80:83], v[160:163], v[48:51]
    ds_read_b64_tr_b16 v[96:97], v12 offset:45056
    ds_read_b64_tr_b16 v[98:99], v12 offset:46080
    v_mfma_f32_16x16x32_bf16 v[64:67], v[80:83], v[164:167], v[64:67]
    ds_read_b64_tr_b16 v[100:101], v14 offset:45056
    ds_read_b64_tr_b16 v[102:103], v14 offset:46080
    v_lshlrev_b32 v128, 16, v112
    v_mfma_f32_16x16x32_bf16 v[52:55], v[84:87], v[160:163], v[52:55]
    ds_read_b64_tr_b16 v[104:105], v12 offset:45312
    ds_read_b64_tr_b16 v[106:107], v12 offset:46336
    v_mfma_f32_16x16x32_bf16 v[68:71], v[84:87], v[164:167], v[68:71]
    ds_read_b64_tr_b16 v[108:109], v14 offset:45312
    ds_read_b64_tr_b16 v[110:111], v14 offset:46336
    v_and_b32 v129, 0xffff0000, v112
    v_mfma_f32_16x16x32_bf16 v[56:59], v[88:91], v[160:163], v[56:59]
    v_mfma_f32_16x16x32_bf16 v[72:75], v[88:91], v[164:167], v[72:75]
    v_lshlrev_b32 v130, 16, v113
    v_mfma_f32_16x16x32_bf16 v[60:63], v[92:95], v[160:163], v[60:63]
    v_mfma_f32_16x16x32_bf16 v[76:79], v[92:95], v[164:167], v[76:79]
    v_and_b32 v131, 0xffff0000, v113
    s_waitcnt vmcnt(16) lgkmcnt(0)
    v_mfma_f32_16x16x32_bf16 v[48:51], v[96:99], v[168:171], v[48:51]
    ds_read_b64_tr_b16 v[80:81], v12 offset:49152
    ds_read_b64_tr_b16 v[82:83], v12 offset:50176
    v_mfma_f32_16x16x32_bf16 v[64:67], v[96:99], v[172:175], v[64:67]
    ds_read_b64_tr_b16 v[84:85], v14 offset:49152
    ds_read_b64_tr_b16 v[86:87], v14 offset:50176
    v_lshlrev_b32 v132, 16, v114
    v_mfma_f32_16x16x32_bf16 v[52:55], v[100:103], v[168:171], v[52:55]
    ds_read_b64_tr_b16 v[88:89], v12 offset:49408
    ds_read_b64_tr_b16 v[90:91], v12 offset:50432
    v_mfma_f32_16x16x32_bf16 v[68:71], v[100:103], v[172:175], v[68:71]
    ds_read_b64_tr_b16 v[92:93], v14 offset:49408
    ds_read_b64_tr_b16 v[94:95], v14 offset:50432
    v_and_b32 v133, 0xffff0000, v114
    v_mfma_f32_16x16x32_bf16 v[56:59], v[104:107], v[168:171], v[56:59]
    v_mfma_f32_16x16x32_bf16 v[72:75], v[104:107], v[172:175], v[72:75]
    v_lshlrev_b32 v134, 16, v115
    v_mfma_f32_16x16x32_bf16 v[60:63], v[108:111], v[168:171], v[60:63]
    v_mfma_f32_16x16x32_bf16 v[76:79], v[108:111], v[172:175], v[76:79]
    v_and_b32 v135, 0xffff0000, v115
    s_waitcnt vmcnt(14) lgkmcnt(0)
    v_mfma_f32_16x16x32_bf16 v[48:51], v[80:83], v[176:179], v[48:51]
    ds_read_b64_tr_b16 v[96:97], v12 offset:53248
    ds_read_b64_tr_b16 v[98:99], v12 offset:54272
    v_mfma_f32_16x16x32_bf16 v[64:67], v[80:83], v[180:183], v[64:67]
    ds_read_b64_tr_b16 v[100:101], v14 offset:53248
    ds_read_b64_tr_b16 v[102:103], v14 offset:54272
    v_lshlrev_b32 v136, 16, v116
    v_mfma_f32_16x16x32_bf16 v[52:55], v[84:87], v[176:179], v[52:55]
    ds_read_b64_tr_b16 v[104:105], v12 offset:53504
    ds_read_b64_tr_b16 v[106:107], v12 offset:54528
    v_mfma_f32_16x16x32_bf16 v[68:71], v[84:87], v[180:183], v[68:71]
    ds_read_b64_tr_b16 v[108:109], v14 offset:53504
    ds_read_b64_tr_b16 v[110:111], v14 offset:54528
    v_and_b32 v137, 0xffff0000, v116
    v_mfma_f32_16x16x32_bf16 v[56:59], v[88:91], v[176:179], v[56:59]
    v_mfma_f32_16x16x32_bf16 v[72:75], v[88:91], v[180:183], v[72:75]
    v_lshlrev_b32 v138, 16, v117
    v_mfma_f32_16x16x32_bf16 v[60:63], v[92:95], v[176:179], v[60:63]
    v_mfma_f32_16x16x32_bf16 v[76:79], v[92:95], v[180:183], v[76:79]
    v_and_b32 v139, 0xffff0000, v117
    s_waitcnt vmcnt(12) lgkmcnt(0)
    v_mfma_f32_16x16x32_bf16 v[48:51], v[96:99], v[184:187], v[48:51]
    ds_read_b64_tr_b16 v[80:81], v12 offset:57344
    ds_read_b64_tr_b16 v[82:83], v12 offset:58368
    v_mfma_f32_16x16x32_bf16 v[64:67], v[96:99], v[188:191], v[64:67]
    ds_read_b64_tr_b16 v[84:85], v14 offset:57344
    ds_read_b64_tr_b16 v[86:87], v14 offset:58368
    v_lshlrev_b32 v140, 16, v118
    v_mfma_f32_16x16x32_bf16 v[52:55], v[100:103], v[184:187], v[52:55]
    ds_read_b64_tr_b16 v[88:89], v12 offset:57600
    ds_read_b64_tr_b16 v[90:91], v12 offset:58624
    v_mfma_f32_16x16x32_bf16 v[68:71], v[100:103], v[188:191], v[68:71]
    ds_read_b64_tr_b16 v[92:93], v14 offset:57600
    ds_read_b64_tr_b16 v[94:95], v14 offset:58624
    v_and_b32 v141, 0xffff0000, v118
    v_mfma_f32_16x16x32_bf16 v[56:59], v[104:107], v[184:187], v[56:59]
    v_mfma_f32_16x16x32_bf16 v[72:75], v[104:107], v[188:191], v[72:75]
    v_lshlrev_b32 v142, 16, v119
    v_mfma_f32_16x16x32_bf16 v[60:63], v[108:111], v[184:187], v[60:63]
    v_mfma_f32_16x16x32_bf16 v[76:79], v[108:111], v[188:191], v[76:79]
    v_and_b32 v143, 0xffff0000, v119
    s_waitcnt vmcnt(10) lgkmcnt(0)
    v_mfma_f32_16x16x32_bf16 v[48:51], v[80:83], v[192:195], v[48:51]
    ds_read_b64_tr_b16 v[96:97], v12 offset:61440
    ds_read_b64_tr_b16 v[98:99], v12 offset:62464
    v_mfma_f32_16x16x32_bf16 v[64:67], v[80:83], v[196:199], v[64:67]
    ds_read_b64_tr_b16 v[100:101], v14 offset:61440
    ds_read_b64_tr_b16 v[102:103], v14 offset:62464
    v_lshlrev_b32 v144, 16, v120
    v_mfma_f32_16x16x32_bf16 v[52:55], v[84:87], v[192:195], v[52:55]
    ds_read_b64_tr_b16 v[104:105], v12 offset:61696
    ds_read_b64_tr_b16 v[106:107], v12 offset:62720
    v_mfma_f32_16x16x32_bf16 v[68:71], v[84:87], v[196:199], v[68:71]
    ds_read_b64_tr_b16 v[108:109], v14 offset:61696
    ds_read_b64_tr_b16 v[110:111], v14 offset:62720
    v_and_b32 v145, 0xffff0000, v120
    v_mfma_f32_16x16x32_bf16 v[56:59], v[88:91], v[192:195], v[56:59]
    v_mfma_f32_16x16x32_bf16 v[72:75], v[88:91], v[196:199], v[72:75]
    v_lshlrev_b32 v146, 16, v121
    v_mfma_f32_16x16x32_bf16 v[60:63], v[92:95], v[192:195], v[60:63]
    v_mfma_f32_16x16x32_bf16 v[76:79], v[92:95], v[196:199], v[76:79]
    v_and_b32 v147, 0xffff0000, v121
    s_waitcnt vmcnt(8) lgkmcnt(0)
    v_mfma_f32_16x16x32_bf16 v[48:51], v[96:99], v[200:203], v[48:51]
    ds_read_b64_tr_b16 v[80:81], v10 offset:0
    ds_read_b64_tr_b16 v[82:83], v10 offset:1024
    v_mfma_f32_16x16x32_bf16 v[64:67], v[96:99], v[204:207], v[64:67]
    ds_read_b64_tr_b16 v[84:85], v11 offset:0
    ds_read_b64_tr_b16 v[86:87], v11 offset:1024
    v_lshlrev_b32 v148, 16, v122
    v_mfma_f32_16x16x32_bf16 v[52:55], v[100:103], v[200:203], v[52:55]
    ds_read_b64_tr_b16 v[88:89], v10 offset:256
    ds_read_b64_tr_b16 v[90:91], v10 offset:1280
    v_mfma_f32_16x16x32_bf16 v[68:71], v[100:103], v[204:207], v[68:71]
    ds_read_b64_tr_b16 v[92:93], v11 offset:256
    ds_read_b64_tr_b16 v[94:95], v11 offset:1280
    v_and_b32 v149, 0xffff0000, v122
    v_mfma_f32_16x16x32_bf16 v[56:59], v[104:107], v[200:203], v[56:59]
    v_mfma_f32_16x16x32_bf16 v[72:75], v[104:107], v[204:207], v[72:75]
    v_lshlrev_b32 v150, 16, v123
    v_mfma_f32_16x16x32_bf16 v[60:63], v[108:111], v[200:203], v[60:63]
    v_mfma_f32_16x16x32_bf16 v[76:79], v[108:111], v[204:207], v[76:79]
    v_and_b32 v151, 0xffff0000, v123
    s_waitcnt vmcnt(6) lgkmcnt(0)
    v_mfma_f32_16x16x32_bf16 v[48:51], v[80:83], v[208:211], v[48:51]
    ds_read_b64_tr_b16 v[96:97], v10 offset:4096
    ds_read_b64_tr_b16 v[98:99], v10 offset:5120
    v_mfma_f32_16x16x32_bf16 v[64:67], v[80:83], v[212:215], v[64:67]
    ds_read_b64_tr_b16 v[100:101], v11 offset:4096
    ds_read_b64_tr_b16 v[102:103], v11 offset:5120
    v_lshlrev_b32 v152, 16, v124
    v_mfma_f32_16x16x32_bf16 v[52:55], v[84:87], v[208:211], v[52:55]
    ds_read_b64_tr_b16 v[104:105], v10 offset:4352
    ds_read_b64_tr_b16 v[106:107], v10 offset:5376
    v_mfma_f32_16x16x32_bf16 v[68:71], v[84:87], v[212:215], v[68:71]
    ds_read_b64_tr_b16 v[108:109], v11 offset:4352
    ds_read_b64_tr_b16 v[110:111], v11 offset:5376
    v_and_b32 v153, 0xffff0000, v124
    v_mfma_f32_16x16x32_bf16 v[56:59], v[88:91], v[208:211], v[56:59]
    v_mfma_f32_16x16x32_bf16 v[72:75], v[88:91], v[212:215], v[72:75]
    v_lshlrev_b32 v154, 16, v125
    v_mfma_f32_16x16x32_bf16 v[60:63], v[92:95], v[208:211], v[60:63]
    v_mfma_f32_16x16x32_bf16 v[76:79], v[92:95], v[212:215], v[76:79]
    v_and_b32 v155, 0xffff0000, v125
    s_waitcnt vmcnt(4) lgkmcnt(0)
    v_mfma_f32_16x16x32_bf16 v[48:51], v[96:99], v[216:219], v[48:51]
    ds_read_b64_tr_b16 v[80:81], v10 offset:8192
    ds_read_b64_tr_b16 v[82:83], v10 offset:9216
    v_mfma_f32_16x16x32_bf16 v[64:67], v[96:99], v[220:223], v[64:67]
    ds_read_b64_tr_b16 v[84:85], v11 offset:8192
    ds_read_b64_tr_b16 v[86:87], v11 offset:9216
    v_lshlrev_b32 v156, 16, v126
    v_mfma_f32_16x16x32_bf16 v[52:55], v[100:103], v[216:219], v[52:55]
    ds_read_b64_tr_b16 v[88:89], v10 offset:8448
    ds_read_b64_tr_b16 v[90:91], v10 offset:9472
    v_mfma_f32_16x16x32_bf16 v[68:71], v[100:103], v[220:223], v[68:71]
    ds_read_b64_tr_b16 v[92:93], v11 offset:8448
    ds_read_b64_tr_b16 v[94:95], v11 offset:9472
    v_and_b32 v157, 0xffff0000, v126
    v_mfma_f32_16x16x32_bf16 v[56:59], v[104:107], v[216:219], v[56:59]
    v_mfma_f32_16x16x32_bf16 v[72:75], v[104:107], v[220:223], v[72:75]
    v_lshlrev_b32 v158, 16, v127
    v_mfma_f32_16x16x32_bf16 v[60:63], v[108:111], v[216:219], v[60:63]
    v_mfma_f32_16x16x32_bf16 v[76:79], v[108:111], v[220:223], v[76:79]
    v_and_b32 v159, 0xffff0000, v127
    s_waitcnt vmcnt(2) lgkmcnt(0)
    v_mfma_f32_16x16x32_bf16 v[48:51], v[80:83], v[224:227], v[48:51]
    ds_read_b64_tr_b16 v[96:97], v10 offset:12288
    ds_read_b64_tr_b16 v[98:99], v10 offset:13312
    v_mfma_f32_16x16x32_bf16 v[64:67], v[80:83], v[228:231], v[64:67]
    ds_read_b64_tr_b16 v[100:101], v11 offset:12288
    ds_read_b64_tr_b16 v[102:103], v11 offset:13312
    v_mfma_f32_16x16x32_bf16 v[52:55], v[84:87], v[224:227], v[52:55]
    ds_read_b64_tr_b16 v[104:105], v10 offset:12544
    ds_read_b64_tr_b16 v[106:107], v10 offset:13568
    v_mfma_f32_16x16x32_bf16 v[68:71], v[84:87], v[228:231], v[68:71]
    ds_read_b64_tr_b16 v[108:109], v11 offset:12544
    ds_read_b64_tr_b16 v[110:111], v11 offset:13568
    v_mfma_f32_16x16x32_bf16 v[56:59], v[88:91], v[224:227], v[56:59]
    v_mfma_f32_16x16x32_bf16 v[72:75], v[88:91], v[228:231], v[72:75]
    v_mfma_f32_16x16x32_bf16 v[60:63], v[92:95], v[224:227], v[60:63]
    v_mfma_f32_16x16x32_bf16 v[76:79], v[92:95], v[228:231], v[76:79]
    s_waitcnt vmcnt(0) lgkmcnt(0)
    s_add_u32 s16, s6, 524288
    s_addc_u32 s17, s7, 0
    s_mov_b32 s18, 524288
    s_mov_b32 s19, 0x20000
    v_mfma_f32_16x16x32_bf16 v[48:51], v[96:99], v[232:235], v[48:51]
    v_mfma_f32_16x16x32_bf16 v[64:67], v[96:99], v[236:239], v[64:67]
    v_mfma_f32_16x16x32_bf16 v[52:55], v[100:103], v[232:235], v[52:55]
    v_mfma_f32_16x16x32_bf16 v[68:71], v[100:103], v[236:239], v[68:71]
    v_mfma_f32_16x16x32_bf16 v[56:59], v[104:107], v[232:235], v[56:59]
    v_mfma_f32_16x16x32_bf16 v[72:75], v[104:107], v[236:239], v[72:75]
    v_mfma_f32_16x16x32_bf16 v[60:63], v[108:111], v[232:235], v[60:63]
    v_mfma_f32_16x16x32_bf16 v[76:79], v[108:111], v[236:239], v[76:79]
    s_nop 0
    v_pk_fma_f32 v[128:129], v[16:17], v[48:49], v[128:129]
    v_pk_fma_f32 v[130:131], v[18:19], v[50:51], v[130:131]
    v_pk_fma_f32 v[132:133], v[20:21], v[52:53], v[132:133]
    v_pk_fma_f32 v[134:135], v[22:23], v[54:55], v[134:135]
    v_cvt_pk_bf16_f32 v176, v128, v129
    v_cvt_pk_bf16_f32 v177, v130, v131
    v_cvt_pk_bf16_f32 v178, v132, v133
    v_cvt_pk_bf16_f32 v179, v134, v135
    v_lshlrev_b32 v128, 16, v176
    v_and_b32 v129, 0xffff0000, v176
    v_lshlrev_b32 v130, 16, v177
    v_and_b32 v131, 0xffff0000, v177
    v_lshlrev_b32 v132, 16, v178
    v_and_b32 v133, 0xffff0000, v178
    v_lshlrev_b32 v134, 16, v179
    v_and_b32 v135, 0xffff0000, v179
    v_pk_mul_f32 v[168:169], v[128:129], v[32:33]
    v_pk_mul_f32 v[170:171], v[130:131], v[34:35]
    v_pk_mul_f32 v[172:173], v[132:133], v[36:37]
    v_pk_mul_f32 v[174:175], v[134:135], v[38:39]
    v_cvt_pk_bf16_f32 v192, v168, v169
    v_cvt_pk_bf16_f32 v193, v170, v171
    v_cvt_pk_bf16_f32 v194, v172, v173
    v_cvt_pk_bf16_f32 v195, v174, v175
    buffer_store_dwordx4 v[192:195], v5, s[28:31], s48 offen sc1
    v_pk_fma_f32 v[136:137], v[24:25], v[56:57], v[136:137]
    v_pk_fma_f32 v[138:139], v[26:27], v[58:59], v[138:139]
    v_pk_fma_f32 v[140:141], v[28:29], v[60:61], v[140:141]
    v_pk_fma_f32 v[142:143], v[30:31], v[62:63], v[142:143]
    v_cvt_pk_bf16_f32 v180, v136, v137
    v_cvt_pk_bf16_f32 v181, v138, v139
    v_cvt_pk_bf16_f32 v182, v140, v141
    v_cvt_pk_bf16_f32 v183, v142, v143
    v_lshlrev_b32 v136, 16, v180
    v_and_b32 v137, 0xffff0000, v180
    v_lshlrev_b32 v138, 16, v181
    v_and_b32 v139, 0xffff0000, v181
    v_lshlrev_b32 v140, 16, v182
    v_and_b32 v141, 0xffff0000, v182
    v_lshlrev_b32 v142, 16, v183
    v_and_b32 v143, 0xffff0000, v183
    v_pk_mul_f32 v[168:169], v[136:137], v[40:41]
    v_pk_mul_f32 v[170:171], v[138:139], v[42:43]
    v_pk_mul_f32 v[172:173], v[140:141], v[44:45]
    v_pk_mul_f32 v[174:175], v[142:143], v[46:47]
    v_cvt_pk_bf16_f32 v196, v168, v169
    v_cvt_pk_bf16_f32 v197, v170, v171
    v_cvt_pk_bf16_f32 v198, v172, v173
    v_cvt_pk_bf16_f32 v199, v174, v175
    buffer_store_dwordx4 v[196:199], v5, s[28:31], s51 offen sc1
    v_pk_fma_f32 v[144:145], v[16:17], v[64:65], v[144:145]
    v_pk_fma_f32 v[146:147], v[18:19], v[66:67], v[146:147]
    v_pk_fma_f32 v[148:149], v[20:21], v[68:69], v[148:149]
    v_pk_fma_f32 v[150:151], v[22:23], v[70:71], v[150:151]
    v_cvt_pk_bf16_f32 v184, v144, v145
    v_cvt_pk_bf16_f32 v185, v146, v147
    v_cvt_pk_bf16_f32 v186, v148, v149
    v_cvt_pk_bf16_f32 v187, v150, v151
    v_lshlrev_b32 v144, 16, v184
    v_and_b32 v145, 0xffff0000, v184
    v_lshlrev_b32 v146, 16, v185
    v_and_b32 v147, 0xffff0000, v185
    v_lshlrev_b32 v148, 16, v186
    v_and_b32 v149, 0xffff0000, v186
    v_lshlrev_b32 v150, 16, v187
    v_and_b32 v151, 0xffff0000, v187
    v_pk_mul_f32 v[168:169], v[144:145], v[32:33]
    v_pk_mul_f32 v[170:171], v[146:147], v[34:35]
    v_pk_mul_f32 v[172:173], v[148:149], v[36:37]
    v_pk_mul_f32 v[174:175], v[150:151], v[38:39]
    v_cvt_pk_bf16_f32 v192, v168, v169
    v_cvt_pk_bf16_f32 v193, v170, v171
    v_cvt_pk_bf16_f32 v194, v172, v173
    v_cvt_pk_bf16_f32 v195, v174, v175
    buffer_store_dwordx4 v[192:195], v5, s[28:31], s52 offen sc1
    v_pk_fma_f32 v[152:153], v[24:25], v[72:73], v[152:153]
    v_pk_fma_f32 v[154:155], v[26:27], v[74:75], v[154:155]
    v_pk_fma_f32 v[156:157], v[28:29], v[76:77], v[156:157]
    v_pk_fma_f32 v[158:159], v[30:31], v[78:79], v[158:159]
    v_cvt_pk_bf16_f32 v188, v152, v153
    v_cvt_pk_bf16_f32 v189, v154, v155
    v_cvt_pk_bf16_f32 v190, v156, v157
    v_cvt_pk_bf16_f32 v191, v158, v159
    v_lshlrev_b32 v152, 16, v188
    v_and_b32 v153, 0xffff0000, v188
    v_lshlrev_b32 v154, 16, v189
    v_and_b32 v155, 0xffff0000, v189
    v_lshlrev_b32 v156, 16, v190
    v_and_b32 v157, 0xffff0000, v190
    v_lshlrev_b32 v158, 16, v191
    v_and_b32 v159, 0xffff0000, v191
    v_pk_mul_f32 v[168:169], v[152:153], v[40:41]
    v_pk_mul_f32 v[170:171], v[154:155], v[42:43]
    v_pk_mul_f32 v[172:173], v[156:157], v[44:45]
    v_pk_mul_f32 v[174:175], v[158:159], v[46:47]
    v_cvt_pk_bf16_f32 v196, v168, v169
    v_cvt_pk_bf16_f32 v197, v170, v171
    v_cvt_pk_bf16_f32 v198, v172, v173
    v_cvt_pk_bf16_f32 v199, v174, v175
    buffer_store_dwordx4 v[196:199], v5, s[28:31], s53 offen sc1
    v_pk_add_f32 v[168:169], v[128:129], v[130:131]
    v_pk_add_f32 v[170:171], v[132:133], v[134:135]
    v_pk_mul_f32 v[172:173], v[128:129], v[128:129]
    v_pk_mul_f32 v[174:175], v[130:131], v[130:131]
    v_pk_fma_f32 v[172:173], v[132:133], v[132:133], v[172:173]
    v_pk_fma_f32 v[174:175], v[134:135], v[134:135], v[174:175]
    v_pk_add_f32 v[168:169], v[168:169], v[170:171]
    v_pk_add_f32 v[172:173], v[172:173], v[174:175]
    v_add_f32 v160, v168, v169
    v_add_f32 v164, v172, v173
    v_pk_add_f32 v[168:169], v[136:137], v[138:139]
    v_pk_add_f32 v[170:171], v[140:141], v[142:143]
    v_pk_mul_f32 v[172:173], v[136:137], v[136:137]
    v_pk_mul_f32 v[174:175], v[138:139], v[138:139]
    v_pk_fma_f32 v[172:173], v[140:141], v[140:141], v[172:173]
    v_pk_fma_f32 v[174:175], v[142:143], v[142:143], v[174:175]
    v_pk_add_f32 v[168:169], v[168:169], v[170:171]
    v_pk_add_f32 v[172:173], v[172:173], v[174:175]
    v_add_f32 v161, v168, v169
    v_add_f32 v165, v172, v173
    v_pk_add_f32 v[168:169], v[144:145], v[146:147]
    v_pk_add_f32 v[170:171], v[148:149], v[150:151]
    v_pk_mul_f32 v[172:173], v[144:145], v[144:145]
    v_pk_mul_f32 v[174:175], v[146:147], v[146:147]
    v_pk_fma_f32 v[172:173], v[148:149], v[148:149], v[172:173]
    v_pk_fma_f32 v[174:175], v[150:151], v[150:151], v[174:175]
    v_pk_add_f32 v[168:169], v[168:169], v[170:171]
    v_pk_add_f32 v[172:173], v[172:173], v[174:175]
    v_add_f32 v162, v168, v169
    v_add_f32 v166, v172, v173
    v_pk_add_f32 v[168:169], v[152:153], v[154:155]
    v_pk_add_f32 v[170:171], v[156:157], v[158:159]
    v_pk_mul_f32 v[172:173], v[152:153], v[152:153]
    v_pk_mul_f32 v[174:175], v[154:155], v[154:155]
    v_pk_fma_f32 v[172:173], v[156:157], v[156:157], v[172:173]
    v_pk_fma_f32 v[174:175], v[158:159], v[158:159], v[174:175]
    v_pk_add_f32 v[168:169], v[168:169], v[170:171]
    v_pk_add_f32 v[172:173], v[172:173], v[174:175]
    v_add_f32 v163, v168, v169
    v_add_f32 v167, v172, v173
    v_permlane32_swap_b32 v160, v162
    v_permlane32_swap_b32 v161, v163
    v_add_f32 v160, v160, v162
    v_add_f32 v161, v161, v163
    s_nop 1
    v_permlane16_swap_b32 v160, v161
    v_add_f32 v160, v160, v161
    v_permlane32_swap_b32 v164, v166
    v_permlane32_swap_b32 v165, v167
    v_add_f32 v164, v164, v166
    v_add_f32 v165, v165, v167
    s_nop 1
    v_permlane16_swap_b32 v164, v165
    v_add_f32 v164, v164, v165
    v_mov_b32 v161, v164
    s_waitcnt vmcnt(0)
    v_mov_b32 v1, s100
    v_mov_b32 v9, 0
    s_mov_b64 exec, 1
    buffer_store_dword v1, v9, s[32:35], s56 offen sc1
    s_mov_b64 exec, -1
    s_barrier
    buffer_store_dwordx2 v[160:161], v7, s[16:19], s50 offen sc1
    buffer_store_dwordx4 v[176:179], v5, s[24:27], s48 offen sc1
    buffer_store_dwordx4 v[180:183], v5, s[24:27], s51 offen sc1
    buffer_store_dwordx4 v[184:187], v5, s[24:27], s52 offen sc1
    buffer_store_dwordx4 v[188:191], v5, s[24:27], s53 offen sc1
    s_add_u32 s56, s56, 294912
    s_and_b32 s14, s2, 7
    s_lshr_b32 s15, s2, 3
    s_and_b32 s12, s14, 1
    s_lshl_b32 s12, s12, 3
    s_and_b32 s3, s15, 7
    s_add_u32 s12, s12, s3
    s_and_b32 s11, s14, 2
    s_lshl_b32 s11, s11, 1
    s_lshr_b32 s3, s15, 3
    s_add_u32 s11, s11, s3
    s_lshr_b32 s10, s14, 2
    s_lshl_b32 s13, s11, 1
    s_add_u32 s13, s13, s10
    s_lshl_b32 s49, s13, 1
    s_and_b32 s3, s95, 1
    s_add_u32 s49, s49, s3
    s_lshl_b32 s49, s49, 7
    s_and_b32 s14, s2, 7
    s_lshr_b32 s15, s2, 3
    s_and_b32 s12, s14, 1
    s_lshl_b32 s12, s12, 3
    s_and_b32 s3, s15, 7
    s_add_u32 s12, s12, s3
    s_lshr_b32 s13, s14, 1
    s_lshl_b32 s13, s13, 2
    s_lshr_b32 s3, s15, 3
    s_add_u32 s13, s13, s3
    s_lshr_b32 s38, s95, 1
    s_and_b32 s39, s95, 1
    v_and_b32 v3, 15, v2
    v_lshrrev_b32 v4, 4, v2
    v_lshrrev_b32 v5, 2, v2
    v_and_b32 v5, 3, v5
    v_and_b32 v6, 3, v2
    v_and_b32 v7, 1, v4
    v_mov_b32 v8, v4
    v_mul_u32_u24 v8, 1792, v8
    v_lshl_add_u32 v8, v5, 6, v8
    v_lshl_add_u32 v8, v6, 3, v8
    s_mul_i32 s40, s39, 8
    s_and_b32 s41, s40, 1
    v_xor_b32 v7, s41, v7
    v_lshl_add_u32 v8, v7, 5, v8
    s_lshr_b32 s41, s40, 1
    s_lshl_b32 s41, s41, 8
    v_add_u32 v10, s41, v8
    v_xor_b32 v8, 32, v8
    s_add_u32 s41, s40, 1
    s_lshr_b32 s41, s41, 1
    s_lshl_b32 s41, s41, 8
    v_add_u32 v11, s41, v8
    s_mul_i32 s41, s38, 8192
    s_add_u32 s41, s41, 28672
    v_lshlrev_b32 v8, 4, v2
    v_add_u32 v12, s41, v8
    s_mov_b32 s43, 45056
    s_mov_b32 s40, 0
    s_lshl_b32 s3, s39, 10
    v_subrev_u32 v8, s3, v10
    s_lshl_b32 s3, s39, 5
    v_xor_b32 v8, s3, v8
    v_add_u32 v8, 45056, v8
    s_mov_b32 s40, 45056
    v_add_u32 v10, s40, v10
    v_add_u32 v11, s40, v11
    v_add_u32 v12, s40, v12
    s_add_u32 s24, s6, 17825792
    s_addc_u32 s25, s7, 0
    s_mov_b32 s26, 14680064
    s_mov_b32 s27, 0x20000
    s_add_u32 s20, s6, 0
    s_addc_u32 s21, s7, 0
    s_mov_b32 s22, 98304
    s_mov_b32 s23, 0x20000
    v_lshlrev_b32 v6, 4, v4
    s_add_u32 s44, s49, 20480
    buffer_load_dwordx4 v[128:131], v6, s[20:23], s44 offen sc1
    buffer_load_dwordx4 v[132:135], v6, s[20:23], s44 offen offset:64 sc1
    s_add_u32 s44, s49, 45056
    buffer_load_dwordx4 v[136:139], v6, s[20:23], s44 offen sc1
    buffer_load_dwordx4 v[140:143], v6, s[20:23], s44 offen offset:64 sc1
    s_add_u32 s44, s49, 69632
    buffer_load_dwordx4 v[144:147], v6, s[20:23], s44 offen sc1
    buffer_load_dwordx4 v[148:151], v6, s[20:23], s44 offen offset:64 sc1
    s_add_u32 s44, s49, 94208
    buffer_load_dwordx4 v[152:155], v6, s[20:23], s44 offen sc1
    buffer_load_dwordx4 v[156:159], v6, s[20:23], s44 offen offset:64 sc1
    s_barrier
    s_waitcnt vmcnt(0)
    v_mov_b32 v1, s100
    v_mov_b32 v5, 0
    s_mov_b64 exec, 1
    buffer_store_dword v1, v5, s[32:35], s56 offen sc1
    s_mov_b64 exec, -1
    v_mov_b32 v16, 0
    v_mov_b32 v17, 0
    v_mov_b32 v18, 0
    v_mov_b32 v19, 0
    v_mov_b32 v20, 0
    v_mov_b32 v21, 0
    v_mov_b32 v22, 0
    v_mov_b32 v23, 0
    v_mov_b32 v24, 0
    v_mov_b32 v25, 0
    v_mov_b32 v26, 0
    v_mov_b32 v27, 0
    v_mov_b32 v28, 0
    v_mov_b32 v29, 0
    v_mov_b32 v30, 0
    v_mov_b32 v31, 0
    v_mov_b32 v32, 0
    v_mov_b32 v33, 0
    v_mov_b32 v34, 0
    v_mov_b32 v35, 0
    v_mov_b32 v36, 0
    v_mov_b32 v37, 0
    v_mov_b32 v38, 0
    v_mov_b32 v39, 0
    v_mov_b32 v40, 0
    v_mov_b32 v41, 0
    v_mov_b32 v42, 0
    v_mov_b32 v43, 0
    v_mov_b32 v44, 0
    v_mov_b32 v45, 0
    v_mov_b32 v46, 0
    v_mov_b32 v47, 0
    v_mov_b32 v48, 0
    v_mov_b32 v49, 0
    v_mov_b32 v50, 0
    v_mov_b32 v51, 0
    v_mov_b32 v52, 0
    v_mov_b32 v53, 0
    v_mov_b32 v54, 0
    v_mov_b32 v55, 0
    v_mov_b32 v56, 0
    v_mov_b32 v57, 0
    v_mov_b32 v58, 0
    v_mov_b32 v59, 0
    v_mov_b32 v60, 0
    v_mov_b32 v61, 0
    v_mov_b32 v62, 0
    v_mov_b32 v63, 0
    v_mov_b32 v64, 0
    v_mov_b32 v65, 0
    v_mov_b32 v66, 0
    v_mov_b32 v67, 0
    v_mov_b32 v68, 0
    v_mov_b32 v69, 0
    v_mov_b32 v70, 0
    v_mov_b32 v71, 0
    v_mov_b32 v72, 0
    v_mov_b32 v73, 0
    v_mov_b32 v74, 0
    v_mov_b32 v75, 0
    v_mov_b32 v76, 0
    v_mov_b32 v77, 0
    v_mov_b32 v78, 0
    v_mov_b32 v79, 0
    v_mov_b32 v80, 0
    v_mov_b32 v81, 0
    v_mov_b32 v82, 0
    v_mov_b32 v83, 0
    v_mov_b32 v84, 0
    v_mov_b32 v85, 0
    v_mov_b32 v86, 0
    v_mov_b32 v87, 0
    v_mov_b32 v88, 0
    v_mov_b32 v89, 0
    v_mov_b32 v90, 0
    v_mov_b32 v91, 0
    v_mov_b32 v92, 0
    v_mov_b32 v93, 0
    v_mov_b32 v94, 0
    v_mov_b32 v95, 0
    v_mov_b32 v96, 0
    v_mov_b32 v97, 0
    v_mov_b32 v98, 0
    v_mov_b32 v99, 0
    v_mov_b32 v100, 0
    v_mov_b32 v101, 0
    v_mov_b32 v102, 0
    v_mov_b32 v103, 0
    v_mov_b32 v104, 0
    v_mov_b32 v105, 0
    v_mov_b32 v106, 0
    v_mov_b32 v107, 0
    v_mov_b32 v108, 0
    v_mov_b32 v109, 0
    v_mov_b32 v110, 0
    v_mov_b32 v111, 0
    v_mov_b32 v112, 0
    v_mov_b32 v113, 0
    v_mov_b32 v114, 0
    v_mov_b32 v115, 0
    v_mov_b32 v116, 0
    v_mov_b32 v117, 0
    v_mov_b32 v118, 0
    v_mov_b32 v119, 0
    v_mov_b32 v120, 0
    v_mov_b32 v121, 0
    v_mov_b32 v122, 0
    v_mov_b32 v123, 0
    v_mov_b32 v124, 0
    v_mov_b32 v125, 0
    v_mov_b32 v126, 0
    v_mov_b32 v127, 0
    s_lshl_b32 s3, s38, 9
    s_add_u32 s3, s3, 135168
    v_lshlrev_b32 v13, 3, v3
    v_add_u32 v13, s3, v13
    s_lshl_b32 s3, s39, 9
    s_add_u32 s3, s3, 136192
    v_lshlrev_b32 v14, 4, v4
    v_add_u32 v7, 136576, v14
    v_add_u32 v14, s3, v14
    s_lshl_b32 s3, s39, 6
    v_add_u32 v7, s3, v7
    v_lshlrev_b32 v15, 4, v2
    s_lshl_b32 s3, s39, 9
    v_and_b32 v9, 0x1ff, v15
    v_add_u32 v9, s3, v9
    v_lshrrev_b32 v6, 5, v2
    v_mul_u32_u24 v6, 114688, v6
    v_add_u32 v9, v9, v6
    s_lshl_b32 s46, s12, 3
    s_lshl_b32 s3, s38, 2
    s_add_u32 s46, s46, s3
    s_mul_i32 s46, s46, 112
    s_mul_i32 s3, s13, 7
    s_add_u32 s46, s46, s3
    s_lshl_b32 s46, s46, 10
    s_add_u32 s50, s46, 6144
    s_add_u32 s51, s50, 229376
    s_lshl_b32 s3, s39, 10
    s_add_u32 s46, s46, s3
    s_add_u32 s47, s46, 114688
    s_add_u32 s48, s47, 114688
    s_add_u32 s49, s48, 114688
    s_lshl_b32 s56, s12, 4
    s_add_u32 s56, s56, s13
    s_lshl_b32 s56, s56, 2
    s_add_u32 s56, s56, s95
    s_lshl_b32 s56, s56, 4
    s_add_u32 s56, s56, 393216
    v_pk_add_f32 v[128:129], v[128:129], v[136:137]
    v_pk_add_f32 v[144:145], v[144:145], v[152:153]
    v_pk_add_f32 v[130:131], v[130:131], v[138:139]
    v_pk_add_f32 v[146:147], v[146:147], v[154:155]
    v_pk_add_f32 v[132:133], v[132:133], v[140:141]
    v_pk_add_f32 v[148:149], v[148:149], v[156:157]
    v_pk_add_f32 v[134:135], v[134:135], v[142:143]
    v_pk_add_f32 v[150:151], v[150:151], v[158:159]
    v_pk_add_f32 v[128:129], v[128:129], v[144:145]
    v_pk_add_f32 v[130:131], v[130:131], v[146:147]
    v_pk_add_f32 v[132:133], v[132:133], v[148:149]
    v_pk_add_f32 v[134:135], v[134:135], v[150:151]
    v_cvt_pk_bf16_f32 v136, v128, v129
    v_lshlrev_b32 v128, 16, v136
    v_and_b32 v129, 0xffff0000, v136
    v_cvt_pk_bf16_f32 v136, v130, v131
    v_lshlrev_b32 v130, 16, v136
    v_and_b32 v131, 0xffff0000, v136
    v_cvt_pk_bf16_f32 v136, v132, v133
    v_lshlrev_b32 v132, 16, v136
    v_and_b32 v133, 0xffff0000, v136
    v_cvt_pk_bf16_f32 v136, v134, v135
    v_lshlrev_b32 v134, 16, v136
    v_and_b32 v135, 0xffff0000, v136
    v_mov_b32 v246, v128
    v_mov_b32 v247, v129
    v_mov_b32 v248, v130
    v_mov_b32 v249, v131
    v_mov_b32 v250, v132
    v_mov_b32 v251, v133
    v_mov_b32 v252, v134
    v_mov_b32 v253, v135
    s_barrier
    ds_read_b64_tr_b16 v[144:145], v10 offset:0
    ds_read_b64_tr_b16 v[146:147], v10 offset:7168
    ds_read_b128 v[128:131], v12 offset:0
    ds_read_b128 v[132:135], v12 offset:2048
    ds_read_b128 v[136:139], v12 offset:4096
    ds_read_b128 v[140:143], v12 offset:6144
    ds_read_b64_tr_b16 v[148:149], v11 offset:0
    ds_read_b64_tr_b16 v[150:151], v11 offset:7168
    ds_read_b64_tr_b16 v[152:153], v10 offset:256
    ds_read_b64_tr_b16 v[154:155], v10 offset:7424
    ds_read_b64_tr_b16 v[156:157], v11 offset:256
    ds_read_b64_tr_b16 v[158:159], v11 offset:7424
    ds_read_b64_tr_b16 v[160:161], v10 offset:512
    ds_read_b64_tr_b16 v[162:163], v10 offset:7680
    ds_read_b64_tr_b16 v[164:165], v11 offset:512
    ds_read_b64_tr_b16 v[166:167], v11 offset:7680
    ds_read_b64_tr_b16 v[168:169], v8 offset:768
    ds_read_b64_tr_b16 v[170:171], v8 offset:7936
    s_mov_b32 s41, 16
.Lk3_gl_69:
    s_waitcnt lgkmcnt(0)
    v_mfma_f32_16x16x32_bf16 v[16:19], v[144:147], v[128:131], v[16:19]
    ds_read_b64_tr_b16 v[188:189], v10 offset:14336
    v_mfma_f32_16x16x32_bf16 v[44:47], v[144:147], v[132:135], v[44:47]
    ds_read_b64_tr_b16 v[190:191], v10 offset:21504
    v_mfma_f32_16x16x32_bf16 v[72:75], v[144:147], v[136:139], v[72:75]
    ds_read_b128 v[172:175], v12 offset:1024
    v_mfma_f32_16x16x32_bf16 v[100:103], v[144:147], v[140:143], v[100:103]
    ds_read_b128 v[176:179], v12 offset:3072
    v_mfma_f32_16x16x32_bf16 v[20:23], v[148:151], v[128:131], v[20:23]
    ds_read_b128 v[180:183], v12 offset:5120
    v_mfma_f32_16x16x32_bf16 v[48:51], v[148:151], v[132:135], v[48:51]
    ds_read_b128 v[184:187], v12 offset:7168
    v_mfma_f32_16x16x32_bf16 v[76:79], v[148:151], v[136:139], v[76:79]
    ds_read_b64_tr_b16 v[192:193], v11 offset:14336
    v_mfma_f32_16x16x32_bf16 v[104:107], v[148:151], v[140:143], v[104:107]
    ds_read_b64_tr_b16 v[194:195], v11 offset:21504
    v_mfma_f32_16x16x32_bf16 v[24:27], v[152:155], v[128:131], v[24:27]
    ds_read_b64_tr_b16 v[196:197], v10 offset:14592
    v_mfma_f32_16x16x32_bf16 v[52:55], v[152:155], v[132:135], v[52:55]
    ds_read_b64_tr_b16 v[198:199], v10 offset:21760
    v_mfma_f32_16x16x32_bf16 v[80:83], v[152:155], v[136:139], v[80:83]
    ds_read_b64_tr_b16 v[200:201], v11 offset:14592
    v_mfma_f32_16x16x32_bf16 v[108:111], v[152:155], v[140:143], v[108:111]
    ds_read_b64_tr_b16 v[202:203], v11 offset:21760
    v_mfma_f32_16x16x32_bf16 v[28:31], v[156:159], v[128:131], v[28:31]
    ds_read_b64_tr_b16 v[204:205], v10 offset:14848
    v_mfma_f32_16x16x32_bf16 v[56:59], v[156:159], v[132:135], v[56:59]
    ds_read_b64_tr_b16 v[206:207], v10 offset:22016
    v_mfma_f32_16x16x32_bf16 v[84:87], v[156:159], v[136:139], v[84:87]
    ds_read_b64_tr_b16 v[208:209], v11 offset:14848
    v_mfma_f32_16x16x32_bf16 v[112:115], v[156:159], v[140:143], v[112:115]
    ds_read_b64_tr_b16 v[210:211], v11 offset:22016
    v_mfma_f32_16x16x32_bf16 v[32:35], v[160:163], v[128:131], v[32:35]
    ds_read_b64_tr_b16 v[212:213], v8 offset:15104
    v_mfma_f32_16x16x32_bf16 v[60:63], v[160:163], v[132:135], v[60:63]
    ds_read_b64_tr_b16 v[214:215], v8 offset:22272
    v_mfma_f32_16x16x32_bf16 v[88:91], v[160:163], v[136:139], v[88:91]
    s_add_u32 s40, s40, 45056
    v_mfma_f32_16x16x32_bf16 v[116:119], v[160:163], v[140:143], v[116:119]
    s_cmp_eq_u32 s40, 135168
    v_mfma_f32_16x16x32_bf16 v[36:39], v[164:167], v[128:131], v[36:39]
    s_cselect_b32 s42, 0xfffea000, s43
    v_mfma_f32_16x16x32_bf16 v[64:67], v[164:167], v[132:135], v[64:67]
    s_cselect_b32 s40, 0, s40
    v_mfma_f32_16x16x32_bf16 v[92:95], v[164:167], v[136:139], v[92:95]
    v_add_u32 v10, s42, v10
    v_mfma_f32_16x16x32_bf16 v[120:123], v[164:167], v[140:143], v[120:123]
    v_add_u32 v11, s42, v11
    v_mfma_f32_16x16x32_bf16 v[40:43], v[168:171], v[128:131], v[40:43]
    v_add_u32 v12, s42, v12
    v_mfma_f32_16x16x32_bf16 v[68:71], v[168:171], v[132:135], v[68:71]
    v_add_u32 v8, s42, v8
    v_mfma_f32_16x16x32_bf16 v[96:99], v[168:171], v[136:139], v[96:99]
    s_sub_u32 s41, s41, 1
    v_mfma_f32_16x16x32_bf16 v[124:127], v[168:171], v[140:143], v[124:127]
    s_cmp_eq_u32 s41, 0
    s_waitcnt lgkmcnt(0)
    s_cbranch_scc1 .Lk3_gt_70
    s_barrier
    v_mfma_f32_16x16x32_bf16 v[16:19], v[188:191], v[172:175], v[16:19]
    ds_read_b64_tr_b16 v[144:145], v10 offset:0
    v_mfma_f32_16x16x32_bf16 v[44:47], v[188:191], v[176:179], v[44:47]
    ds_read_b64_tr_b16 v[146:147], v10 offset:7168
    v_mfma_f32_16x16x32_bf16 v[72:75], v[188:191], v[180:183], v[72:75]
    ds_read_b128 v[128:131], v12 offset:0
    v_mfma_f32_16x16x32_bf16 v[100:103], v[188:191], v[184:187], v[100:103]
    ds_read_b128 v[132:135], v12 offset:2048
    v_mfma_f32_16x16x32_bf16 v[20:23], v[192:195], v[172:175], v[20:23]
    ds_read_b128 v[136:139], v12 offset:4096
    v_mfma_f32_16x16x32_bf16 v[48:51], v[192:195], v[176:179], v[48:51]
    ds_read_b128 v[140:143], v12 offset:6144
    v_mfma_f32_16x16x32_bf16 v[76:79], v[192:195], v[180:183], v[76:79]
    ds_read_b64_tr_b16 v[148:149], v11 offset:0
    v_mfma_f32_16x16x32_bf16 v[104:107], v[192:195], v[184:187], v[104:107]
    ds_read_b64_tr_b16 v[150:151], v11 offset:7168
    v_mfma_f32_16x16x32_bf16 v[24:27], v[196:199], v[172:175], v[24:27]
    ds_read_b64_tr_b16 v[152:153], v10 offset:256
    v_mfma_f32_16x16x32_bf16 v[52:55], v[196:199], v[176:179], v[52:55]
    ds_read_b64_tr_b16 v[154:155], v10 offset:7424
    v_mfma_f32_16x16x32_bf16 v[80:83], v[196:199], v[180:183], v[80:83]
    ds_read_b64_tr_b16 v[156:157], v11 offset:256
    v_mfma_f32_16x16x32_bf16 v[108:111], v[196:199], v[184:187], v[108:111]
    ds_read_b64_tr_b16 v[158:159], v11 offset:7424
    v_mfma_f32_16x16x32_bf16 v[28:31], v[200:203], v[172:175], v[28:31]
    ds_read_b64_tr_b16 v[160:161], v10 offset:512
    v_mfma_f32_16x16x32_bf16 v[56:59], v[200:203], v[176:179], v[56:59]
    ds_read_b64_tr_b16 v[162:163], v10 offset:7680
    v_mfma_f32_16x16x32_bf16 v[84:87], v[200:203], v[180:183], v[84:87]
    ds_read_b64_tr_b16 v[164:165], v11 offset:512
    v_mfma_f32_16x16x32_bf16 v[112:115], v[200:203], v[184:187], v[112:115]
    ds_read_b64_tr_b16 v[166:167], v11 offset:7680
    v_mfma_f32_16x16x32_bf16 v[32:35], v[204:207], v[172:175], v[32:35]
    ds_read_b64_tr_b16 v[168:169], v8 offset:768
    v_mfma_f32_16x16x32_bf16 v[60:63], v[204:207], v[176:179], v[60:63]
    ds_read_b64_tr_b16 v[170:171], v8 offset:7936
    v_mfma_f32_16x16x32_bf16 v[88:91], v[204:207], v[180:183], v[88:91]
    v_mfma_f32_16x16x32_bf16 v[116:119], v[204:207], v[184:187], v[116:119]
    v_mfma_f32_16x16x32_bf16 v[36:39], v[208:211], v[172:175], v[36:39]
    v_mfma_f32_16x16x32_bf16 v[64:67], v[208:211], v[176:179], v[64:67]
    v_mfma_f32_16x16x32_bf16 v[92:95], v[208:211], v[180:183], v[92:95]
    v_mfma_f32_16x16x32_bf16 v[120:123], v[208:211], v[184:187], v[120:123]
    v_mfma_f32_16x16x32_bf16 v[40:43], v[212:215], v[172:175], v[40:43]
    v_mfma_f32_16x16x32_bf16 v[68:71], v[212:215], v[176:179], v[68:71]
    v_mfma_f32_16x16x32_bf16 v[96:99], v[212:215], v[180:183], v[96:99]
    v_mfma_f32_16x16x32_bf16 v[124:127], v[212:215], v[184:187], v[124:127]
    s_branch .Lk3_gl_69
.Lk3_gt_70:
    v_mfma_f32_16x16x32_bf16 v[16:19], v[188:191], v[172:175], v[16:19]
    ds_read_b64 v[128:129], v13 offset:0
    ds_read_b64 v[130:131], v13 offset:128
    ds_read_b64 v[132:133], v13 offset:256
    v_mfma_f32_16x16x32_bf16 v[44:47], v[188:191], v[176:179], v[44:47]
    ds_read_b64 v[134:135], v13 offset:384
    ds_read_b128 v[136:139], v14 offset:0
    ds_read_b128 v[216:219], v14 offset:1024
    v_mfma_f32_16x16x32_bf16 v[72:75], v[188:191], v[180:183], v[72:75]
    ds_read_b128 v[140:143], v14 offset:64
    ds_read_b128 v[220:223], v14 offset:1088
    ds_read_b128 v[144:147], v14 offset:128
    v_mfma_f32_16x16x32_bf16 v[100:103], v[188:191], v[184:187], v[100:103]
    ds_read_b128 v[224:227], v14 offset:1152
    ds_read_b128 v[148:151], v14 offset:192
    ds_read_b128 v[228:231], v14 offset:1216
    v_mfma_f32_16x16x32_bf16 v[20:23], v[192:195], v[172:175], v[20:23]
    ds_read_b128 v[152:155], v14 offset:256
    ds_read_b128 v[232:235], v14 offset:1280
    ds_read_b128 v[156:159], v14 offset:320
    v_mfma_f32_16x16x32_bf16 v[48:51], v[192:195], v[176:179], v[48:51]
    ds_read_b128 v[236:239], v14 offset:1344
    ds_read_b128 v[160:163], v7 offset:0
    ds_read_b128 v[240:243], v7 offset:1024
    v_mfma_f32_16x16x32_bf16 v[76:79], v[192:195], v[180:183], v[76:79]
    v_mfma_f32_16x16x32_bf16 v[104:107], v[192:195], v[184:187], v[104:107]
    v_mfma_f32_16x16x32_bf16 v[24:27], v[196:199], v[172:175], v[24:27]
    v_mfma_f32_16x16x32_bf16 v[52:55], v[196:199], v[176:179], v[52:55]
    v_mfma_f32_16x16x32_bf16 v[80:83], v[196:199], v[180:183], v[80:83]
    v_mfma_f32_16x16x32_bf16 v[108:111], v[196:199], v[184:187], v[108:111]
    s_waitcnt lgkmcnt(10)
    v_mfma_f32_16x16x32_bf16 v[28:31], v[200:203], v[172:175], v[28:31]
    v_pk_fma_f32 v[164:165], v[128:129], v[136:137], v[216:217] op_sel:[1,0,0] op_sel_hi:[1,1,1] neg_lo:[1,0,0] neg_hi:[1,0,0]
    v_pk_fma_f32 v[164:165], v[128:129], v[16:17], v[164:165] op_sel:[0,0,0] op_sel_hi:[0,1,1]
    v_cvt_pk_bf16_f32 v16, v164, v165
    v_pk_max_i16 v16, v16, 0
    v_mfma_f32_16x16x32_bf16 v[56:59], v[200:203], v[176:179], v[56:59]
    v_pk_fma_f32 v[166:167], v[128:129], v[138:139], v[218:219] op_sel:[1,0,0] op_sel_hi:[1,1,1] neg_lo:[1,0,0] neg_hi:[1,0,0]
    v_pk_fma_f32 v[166:167], v[128:129], v[18:19], v[166:167] op_sel:[0,0,0] op_sel_hi:[0,1,1]
    v_cvt_pk_bf16_f32 v17, v166, v167
    v_pk_max_i16 v17, v17, 0
    v_mfma_f32_16x16x32_bf16 v[84:87], v[200:203], v[180:183], v[84:87]
    v_pk_fma_f32 v[168:169], v[128:129], v[140:141], v[220:221] op_sel:[1,0,0] op_sel_hi:[1,1,1] neg_lo:[1,0,0] neg_hi:[1,0,0]
    v_pk_fma_f32 v[168:169], v[128:129], v[20:21], v[168:169] op_sel:[0,0,0] op_sel_hi:[0,1,1]
    v_cvt_pk_bf16_f32 v18, v168, v169
    v_pk_max_i16 v18, v18, 0
    v_mfma_f32_16x16x32_bf16 v[112:115], v[200:203], v[184:187], v[112:115]
    v_pk_fma_f32 v[170:171], v[128:129], v[142:143], v[222:223] op_sel:[1,0,0] op_sel_hi:[1,1,1] neg_lo:[1,0,0] neg_hi:[1,0,0]
    v_pk_fma_f32 v[170:171], v[128:129], v[22:23], v[170:171] op_sel:[0,0,0] op_sel_hi:[0,1,1]
    v_cvt_pk_bf16_f32 v19, v170, v171
    v_pk_max_i16 v19, v19, 0
    buffer_store_dwordx4 v[16:19], v15, s[24:27], s46 offen sc1
    v_mfma_f32_16x16x32_bf16 v[32:35], v[204:207], v[172:175], v[32:35]
    v_pk_fma_f32 v[164:165], v[130:131], v[136:137], v[216:217] op_sel:[1,0,0] op_sel_hi:[1,1,1] neg_lo:[1,0,0] neg_hi:[1,0,0]
    v_pk_fma_f32 v[164:165], v[130:131], v[44:45], v[164:165] op_sel:[0,0,0] op_sel_hi:[0,1,1]
    v_cvt_pk_bf16_f32 v44, v164, v165
    v_pk_max_i16 v44, v44, 0
    v_mfma_f32_16x16x32_bf16 v[60:63], v[204:207], v[176:179], v[60:63]
    v_pk_fma_f32 v[166:167], v[130:131], v[138:139], v[218:219] op_sel:[1,0,0] op_sel_hi:[1,1,1] neg_lo:[1,0,0] neg_hi:[1,0,0]
    v_pk_fma_f32 v[166:167], v[130:131], v[46:47], v[166:167] op_sel:[0,0,0] op_sel_hi:[0,1,1]
    v_cvt_pk_bf16_f32 v45, v166, v167
    v_pk_max_i16 v45, v45, 0
    v_mfma_f32_16x16x32_bf16 v[88:91], v[204:207], v[180:183], v[88:91]
    v_pk_fma_f32 v[168:169], v[130:131], v[140:141], v[220:221] op_sel:[1,0,0] op_sel_hi:[1,1,1] neg_lo:[1,0,0] neg_hi:[1,0,0]
    v_pk_fma_f32 v[168:169], v[130:131], v[48:49], v[168:169] op_sel:[0,0,0] op_sel_hi:[0,1,1]
    v_cvt_pk_bf16_f32 v46, v168, v169
    v_pk_max_i16 v46, v46, 0
    v_mfma_f32_16x16x32_bf16 v[116:119], v[204:207], v[184:187], v[116:119]
    v_pk_fma_f32 v[170:171], v[130:131], v[142:143], v[222:223] op_sel:[1,0,0] op_sel_hi:[1,1,1] neg_lo:[1,0,0] neg_hi:[1,0,0]
    v_pk_fma_f32 v[170:171], v[130:131], v[50:51], v[170:171] op_sel:[0,0,0] op_sel_hi:[0,1,1]
    v_cvt_pk_bf16_f32 v47, v170, v171
    v_pk_max_i16 v47, v47, 0
    buffer_store_dwordx4 v[44:47], v15, s[24:27], s47 offen sc1
    v_mfma_f32_16x16x32_bf16 v[36:39], v[208:211], v[172:175], v[36:39]
    v_pk_fma_f32 v[164:165], v[132:133], v[136:137], v[216:217] op_sel:[1,0,0] op_sel_hi:[1,1,1] neg_lo:[1,0,0] neg_hi:[1,0,0]
    v_pk_fma_f32 v[164:165], v[132:133], v[72:73], v[164:165] op_sel:[0,0,0] op_sel_hi:[0,1,1]
    v_cvt_pk_bf16_f32 v72, v164, v165
    v_pk_max_i16 v72, v72, 0
    v_mfma_f32_16x16x32_bf16 v[64:67], v[208:211], v[176:179], v[64:67]
    v_pk_fma_f32 v[166:167], v[132:133], v[138:139], v[218:219] op_sel:[1,0,0] op_sel_hi:[1,1,1] neg_lo:[1,0,0] neg_hi:[1,0,0]
    v_pk_fma_f32 v[166:167], v[132:133], v[74:75], v[166:167] op_sel:[0,0,0] op_sel_hi:[0,1,1]
    v_cvt_pk_bf16_f32 v73, v166, v167
    v_pk_max_i16 v73, v73, 0
    v_mfma_f32_16x16x32_bf16 v[92:95], v[208:211], v[180:183], v[92:95]
    v_pk_fma_f32 v[168:169], v[132:133], v[140:141], v[220:221] op_sel:[1,0,0] op_sel_hi:[1,1,1] neg_lo:[1,0,0] neg_hi:[1,0,0]
    v_pk_fma_f32 v[168:169], v[132:133], v[76:77], v[168:169] op_sel:[0,0,0] op_sel_hi:[0,1,1]
    v_cvt_pk_bf16_f32 v74, v168, v169
    v_pk_max_i16 v74, v74, 0
    v_mfma_f32_16x16x32_bf16 v[120:123], v[208:211], v[184:187], v[120:123]
    v_pk_fma_f32 v[170:171], v[132:133], v[142:143], v[222:223] op_sel:[1,0,0] op_sel_hi:[1,1,1] neg_lo:[1,0,0] neg_hi:[1,0,0]
    v_pk_fma_f32 v[170:171], v[132:133], v[78:79], v[170:171] op_sel:[0,0,0] op_sel_hi:[0,1,1]
    v_cvt_pk_bf16_f32 v75, v170, v171
    v_pk_max_i16 v75, v75, 0
    buffer_store_dwordx4 v[72:75], v15, s[24:27], s48 offen sc1
    v_mfma_f32_16x16x32_bf16 v[40:43], v[212:215], v[172:175], v[40:43]
    v_pk_fma_f32 v[164:165], v[134:135], v[136:137], v[216:217] op_sel:[1,0,0] op_sel_hi:[1,1,1] neg_lo:[1,0,0] neg_hi:[1,0,0]
    v_pk_fma_f32 v[164:165], v[134:135], v[100:101], v[164:165] op_sel:[0,0,0] op_sel_hi:[0,1,1]
    v_cvt_pk_bf16_f32 v100, v164, v165
    v_pk_max_i16 v100, v100, 0
    v_mfma_f32_16x16x32_bf16 v[68:71], v[212:215], v[176:179], v[68:71]
    v_pk_fma_f32 v[166:167], v[134:135], v[138:139], v[218:219] op_sel:[1,0,0] op_sel_hi:[1,1,1] neg_lo:[1,0,0] neg_hi:[1,0,0]
    v_pk_fma_f32 v[166:167], v[134:135], v[102:103], v[166:167] op_sel:[0,0,0] op_sel_hi:[0,1,1]
    v_cvt_pk_bf16_f32 v101, v166, v167
    v_pk_max_i16 v101, v101, 0
    v_mfma_f32_16x16x32_bf16 v[96:99], v[212:215], v[180:183], v[96:99]
    v_pk_fma_f32 v[168:169], v[134:135], v[140:141], v[220:221] op_sel:[1,0,0] op_sel_hi:[1,1,1] neg_lo:[1,0,0] neg_hi:[1,0,0]
    v_pk_fma_f32 v[168:169], v[134:135], v[104:105], v[168:169] op_sel:[0,0,0] op_sel_hi:[0,1,1]
    v_cvt_pk_bf16_f32 v102, v168, v169
    v_pk_max_i16 v102, v102, 0
    v_mfma_f32_16x16x32_bf16 v[124:127], v[212:215], v[184:187], v[124:127]
    v_pk_fma_f32 v[170:171], v[134:135], v[142:143], v[222:223] op_sel:[1,0,0] op_sel_hi:[1,1,1] neg_lo:[1,0,0] neg_hi:[1,0,0]
    v_pk_fma_f32 v[170:171], v[134:135], v[106:107], v[170:171] op_sel:[0,0,0] op_sel_hi:[0,1,1]
    v_cvt_pk_bf16_f32 v103, v170, v171
    v_pk_max_i16 v103, v103, 0
    buffer_store_dwordx4 v[100:103], v15, s[24:27], s49 offen sc1
    s_waitcnt lgkmcnt(0)
    v_add_u32 v6, 4096, v15
    s_nop 7
    s_nop 7
    v_pk_fma_f32 v[164:165], v[128:129], v[144:145], v[224:225] op_sel:[1,0,0] op_sel_hi:[1,1,1] neg_lo:[1,0,0] neg_hi:[1,0,0]
    v_pk_fma_f32 v[164:165], v[128:129], v[24:25], v[164:165] op_sel:[0,0,0] op_sel_hi:[0,1,1]
    v_cvt_pk_bf16_f32 v20, v164, v165
    v_pk_max_i16 v20, v20, 0
    v_pk_fma_f32 v[166:167], v[128:129], v[146:147], v[226:227] op_sel:[1,0,0] op_sel_hi:[1,1,1] neg_lo:[1,0,0] neg_hi:[1,0,0]
    v_pk_fma_f32 v[166:167], v[128:129], v[26:27], v[166:167] op_sel:[0,0,0] op_sel_hi:[0,1,1]
    v_cvt_pk_bf16_f32 v21, v166, v167
    v_pk_max_i16 v21, v21, 0
    v_pk_fma_f32 v[168:169], v[128:129], v[148:149], v[228:229] op_sel:[1,0,0] op_sel_hi:[1,1,1] neg_lo:[1,0,0] neg_hi:[1,0,0]
    v_pk_fma_f32 v[168:169], v[128:129], v[28:29], v[168:169] op_sel:[0,0,0] op_sel_hi:[0,1,1]
    v_cvt_pk_bf16_f32 v22, v168, v169
    v_pk_max_i16 v22, v22, 0
    v_pk_fma_f32 v[170:171], v[128:129], v[150:151], v[230:231] op_sel:[1,0,0] op_sel_hi:[1,1,1] neg_lo:[1,0,0] neg_hi:[1,0,0]
    v_pk_fma_f32 v[170:171], v[128:129], v[30:31], v[170:171] op_sel:[0,0,0] op_sel_hi:[0,1,1]
    v_cvt_pk_bf16_f32 v23, v170, v171
    v_pk_max_i16 v23, v23, 0
    v_pk_fma_f32 v[164:165], v[130:131], v[144:145], v[224:225] op_sel:[1,0,0] op_sel_hi:[1,1,1] neg_lo:[1,0,0] neg_hi:[1,0,0]
    v_pk_fma_f32 v[164:165], v[130:131], v[52:53], v[164:165] op_sel:[0,0,0] op_sel_hi:[0,1,1]
    v_cvt_pk_bf16_f32 v48, v164, v165
    v_pk_max_i16 v48, v48, 0
    v_pk_fma_f32 v[166:167], v[130:131], v[146:147], v[226:227] op_sel:[1,0,0] op_sel_hi:[1,1,1] neg_lo:[1,0,0] neg_hi:[1,0,0]
    v_pk_fma_f32 v[166:167], v[130:131], v[54:55], v[166:167] op_sel:[0,0,0] op_sel_hi:[0,1,1]
    v_cvt_pk_bf16_f32 v49, v166, v167
    v_pk_max_i16 v49, v49, 0
    v_pk_fma_f32 v[168:169], v[130:131], v[148:149], v[228:229] op_sel:[1,0,0] op_sel_hi:[1,1,1] neg_lo:[1,0,0] neg_hi:[1,0,0]
    v_pk_fma_f32 v[168:169], v[130:131], v[56:57], v[168:169] op_sel:[0,0,0] op_sel_hi:[0,1,1]
    v_cvt_pk_bf16_f32 v50, v168, v169
    v_pk_max_i16 v50, v50, 0
    v_pk_fma_f32 v[170:171], v[130:131], v[150:151], v[230:231] op_sel:[1,0,0] op_sel_hi:[1,1,1] neg_lo:[1,0,0] neg_hi:[1,0,0]
    v_pk_fma_f32 v[170:171], v[130:131], v[58:59], v[170:171] op_sel:[0,0,0] op_sel_hi:[0,1,1]
    v_cvt_pk_bf16_f32 v51, v170, v171
    v_pk_max_i16 v51, v51, 0
    v_pk_fma_f32 v[164:165], v[132:133], v[144:145], v[224:225] op_sel:[1,0,0] op_sel_hi:[1,1,1] neg_lo:[1,0,0] neg_hi:[1,0,0]
    v_pk_fma_f32 v[164:165], v[132:133], v[80:81], v[164:165] op_sel:[0,0,0] op_sel_hi:[0,1,1]
    v_cvt_pk_bf16_f32 v76, v164, v165
    v_pk_max_i16 v76, v76, 0
    v_pk_fma_f32 v[166:167], v[132:133], v[146:147], v[226:227] op_sel:[1,0,0] op_sel_hi:[1,1,1] neg_lo:[1,0,0] neg_hi:[1,0,0]
    v_pk_fma_f32 v[166:167], v[132:133], v[82:83], v[166:167] op_sel:[0,0,0] op_sel_hi:[0,1,1]
    v_cvt_pk_bf16_f32 v77, v166, v167
    v_pk_max_i16 v77, v77, 0
    v_pk_fma_f32 v[168:169], v[132:133], v[148:149], v[228:229] op_sel:[1,0,0] op_sel_hi:[1,1,1] neg_lo:[1,0,0] neg_hi:[1,0,0]
    v_pk_fma_f32 v[168:169], v[132:133], v[84:85], v[168:169] op_sel:[0,0,0] op_sel_hi:[0,1,1]
    v_cvt_pk_bf16_f32 v78, v168, v169
    v_pk_max_i16 v78, v78, 0
    v_pk_fma_f32 v[170:171], v[132:133], v[150:151], v[230:231] op_sel:[1,0,0] op_sel_hi:[1,1,1] neg_lo:[1,0,0] neg_hi:[1,0,0]
    v_pk_fma_f32 v[170:171], v[132:133], v[86:87], v[170:171] op_sel:[0,0,0] op_sel_hi:[0,1,1]
    v_cvt_pk_bf16_f32 v79, v170, v171
    v_pk_max_i16 v79, v79, 0
    v_pk_fma_f32 v[164:165], v[134:135], v[144:145], v[224:225] op_sel:[1,0,0] op_sel_hi:[1,1,1] neg_lo:[1,0,0] neg_hi:[1,0,0]
    v_pk_fma_f32 v[164:165], v[134:135], v[108:109], v[164:165] op_sel:[0,0,0] op_sel_hi:[0,1,1]
    v_cvt_pk_bf16_f32 v104, v164, v165
    v_pk_max_i16 v104, v104, 0
    v_pk_fma_f32 v[166:167], v[134:135], v[146:147], v[226:227] op_sel:[1,0,0] op_sel_hi:[1,1,1] neg_lo:[1,0,0] neg_hi:[1,0,0]
    v_pk_fma_f32 v[166:167], v[134:135], v[110:111], v[166:167] op_sel:[0,0,0] op_sel_hi:[0,1,1]
    v_cvt_pk_bf16_f32 v105, v166, v167
    v_pk_max_i16 v105, v105, 0
    v_pk_fma_f32 v[168:169], v[134:135], v[148:149], v[228:229] op_sel:[1,0,0] op_sel_hi:[1,1,1] neg_lo:[1,0,0] neg_hi:[1,0,0]
    v_pk_fma_f32 v[168:169], v[134:135], v[112:113], v[168:169] op_sel:[0,0,0] op_sel_hi:[0,1,1]
    v_cvt_pk_bf16_f32 v106, v168, v169
    v_pk_max_i16 v106, v106, 0
    v_pk_fma_f32 v[170:171], v[134:135], v[150:151], v[230:231] op_sel:[1,0,0] op_sel_hi:[1,1,1] neg_lo:[1,0,0] neg_hi:[1,0,0]
    v_pk_fma_f32 v[170:171], v[134:135], v[114:115], v[170:171] op_sel:[0,0,0] op_sel_hi:[0,1,1]
    v_cvt_pk_bf16_f32 v107, v170, v171
    v_pk_max_i16 v107, v107, 0
    v_pk_fma_f32 v[164:165], v[128:129], v[152:153], v[232:233] op_sel:[1,0,0] op_sel_hi:[1,1,1] neg_lo:[1,0,0] neg_hi:[1,0,0]
    v_pk_fma_f32 v[164:165], v[128:129], v[32:33], v[164:165] op_sel:[0,0,0] op_sel_hi:[0,1,1]
    v_cvt_pk_bf16_f32 v24, v164, v165
    v_pk_max_i16 v24, v24, 0
    v_pk_fma_f32 v[166:167], v[128:129], v[154:155], v[234:235] op_sel:[1,0,0] op_sel_hi:[1,1,1] neg_lo:[1,0,0] neg_hi:[1,0,0]
    v_pk_fma_f32 v[166:167], v[128:129], v[34:35], v[166:167] op_sel:[0,0,0] op_sel_hi:[0,1,1]
    v_cvt_pk_bf16_f32 v25, v166, v167
    v_pk_max_i16 v25, v25, 0
    v_pk_fma_f32 v[168:169], v[128:129], v[156:157], v[236:237] op_sel:[1,0,0] op_sel_hi:[1,1,1] neg_lo:[1,0,0] neg_hi:[1,0,0]
    v_pk_fma_f32 v[168:169], v[128:129], v[36:37], v[168:169] op_sel:[0,0,0] op_sel_hi:[0,1,1]
    v_cvt_pk_bf16_f32 v26, v168, v169
    v_pk_max_i16 v26, v26, 0
    v_pk_fma_f32 v[170:171], v[128:129], v[158:159], v[238:239] op_sel:[1,0,0] op_sel_hi:[1,1,1] neg_lo:[1,0,0] neg_hi:[1,0,0]
    v_pk_fma_f32 v[170:171], v[128:129], v[38:39], v[170:171] op_sel:[0,0,0] op_sel_hi:[0,1,1]
    v_cvt_pk_bf16_f32 v27, v170, v171
    v_pk_max_i16 v27, v27, 0
    v_pk_fma_f32 v[164:165], v[130:131], v[152:153], v[232:233] op_sel:[1,0,0] op_sel_hi:[1,1,1] neg_lo:[1,0,0] neg_hi:[1,0,0]
    v_pk_fma_f32 v[164:165], v[130:131], v[60:61], v[164:165] op_sel:[0,0,0] op_sel_hi:[0,1,1]
    v_cvt_pk_bf16_f32 v52, v164, v165
    v_pk_max_i16 v52, v52, 0
    v_pk_fma_f32 v[166:167], v[130:131], v[154:155], v[234:235] op_sel:[1,0,0] op_sel_hi:[1,1,1] neg_lo:[1,0,0] neg_hi:[1,0,0]
    v_pk_fma_f32 v[166:167], v[130:131], v[62:63], v[166:167] op_sel:[0,0,0] op_sel_hi:[0,1,1]
    v_cvt_pk_bf16_f32 v53, v166, v167
    v_pk_max_i16 v53, v53, 0
    v_pk_fma_f32 v[168:169], v[130:131], v[156:157], v[236:237] op_sel:[1,0,0] op_sel_hi:[1,1,1] neg_lo:[1,0,0] neg_hi:[1,0,0]
    v_pk_fma_f32 v[168:169], v[130:131], v[64:65], v[168:169] op_sel:[0,0,0] op_sel_hi:[0,1,1]
    v_cvt_pk_bf16_f32 v54, v168, v169
    v_pk_max_i16 v54, v54, 0
    v_pk_fma_f32 v[170:171], v[130:131], v[158:159], v[238:239] op_sel:[1,0,0] op_sel_hi:[1,1,1] neg_lo:[1,0,0] neg_hi:[1,0,0]
    v_pk_fma_f32 v[170:171], v[130:131], v[66:67], v[170:171] op_sel:[0,0,0] op_sel_hi:[0,1,1]
    v_cvt_pk_bf16_f32 v55, v170, v171
    v_pk_max_i16 v55, v55, 0
    v_pk_fma_f32 v[164:165], v[132:133], v[152:153], v[232:233] op_sel:[1,0,0] op_sel_hi:[1,1,1] neg_lo:[1,0,0] neg_hi:[1,0,0]
    v_pk_fma_f32 v[164:165], v[132:133], v[88:89], v[164:165] op_sel:[0,0,0] op_sel_hi:[0,1,1]
    v_cvt_pk_bf16_f32 v80, v164, v165
    v_pk_max_i16 v80, v80, 0
    v_pk_fma_f32 v[166:167], v[132:133], v[154:155], v[234:235] op_sel:[1,0,0] op_sel_hi:[1,1,1] neg_lo:[1,0,0] neg_hi:[1,0,0]
    v_pk_fma_f32 v[166:167], v[132:133], v[90:91], v[166:167] op_sel:[0,0,0] op_sel_hi:[0,1,1]
    v_cvt_pk_bf16_f32 v81, v166, v167
    v_pk_max_i16 v81, v81, 0
    v_pk_fma_f32 v[168:169], v[132:133], v[156:157], v[236:237] op_sel:[1,0,0] op_sel_hi:[1,1,1] neg_lo:[1,0,0] neg_hi:[1,0,0]
    v_pk_fma_f32 v[168:169], v[132:133], v[92:93], v[168:169] op_sel:[0,0,0] op_sel_hi:[0,1,1]
    v_cvt_pk_bf16_f32 v82, v168, v169
    v_pk_max_i16 v82, v82, 0
    v_pk_fma_f32 v[170:171], v[132:133], v[158:159], v[238:239] op_sel:[1,0,0] op_sel_hi:[1,1,1] neg_lo:[1,0,0] neg_hi:[1,0,0]
    v_pk_fma_f32 v[170:171], v[132:133], v[94:95], v[170:171] op_sel:[0,0,0] op_sel_hi:[0,1,1]
    v_cvt_pk_bf16_f32 v83, v170, v171
    v_pk_max_i16 v83, v83, 0
    v_pk_fma_f32 v[164:165], v[134:135], v[152:153], v[232:233] op_sel:[1,0,0] op_sel_hi:[1,1,1] neg_lo:[1,0,0] neg_hi:[1,0,0]
    v_pk_fma_f32 v[164:165], v[134:135], v[116:117], v[164:165] op_sel:[0,0,0] op_sel_hi:[0,1,1]
    v_cvt_pk_bf16_f32 v108, v164, v165
    v_pk_max_i16 v108, v108, 0
    v_pk_fma_f32 v[166:167], v[134:135], v[154:155], v[234:235] op_sel:[1,0,0] op_sel_hi:[1,1,1] neg_lo:[1,0,0] neg_hi:[1,0,0]
    v_pk_fma_f32 v[166:167], v[134:135], v[118:119], v[166:167] op_sel:[0,0,0] op_sel_hi:[0,1,1]
    v_cvt_pk_bf16_f32 v109, v166, v167
    v_pk_max_i16 v109, v109, 0
    v_pk_fma_f32 v[168:169], v[134:135], v[156:157], v[236:237] op_sel:[1,0,0] op_sel_hi:[1,1,1] neg_lo:[1,0,0] neg_hi:[1,0,0]
    v_pk_fma_f32 v[168:169], v[134:135], v[120:121], v[168:169] op_sel:[0,0,0] op_sel_hi:[0,1,1]
    v_cvt_pk_bf16_f32 v110, v168, v169
    v_pk_max_i16 v110, v110, 0
    v_pk_fma_f32 v[170:171], v[134:135], v[158:159], v[238:239] op_sel:[1,0,0] op_sel_hi:[1,1,1] neg_lo:[1,0,0] neg_hi:[1,0,0]
    v_pk_fma_f32 v[170:171], v[134:135], v[122:123], v[170:171] op_sel:[0,0,0] op_sel_hi:[0,1,1]
    v_cvt_pk_bf16_f32 v111, v170, v171
    v_pk_max_i16 v111, v111, 0
    s_waitcnt vmcnt(0)
    s_add_u32 s3, s56, 196608
    v_mov_b32 v1, s100
    v_mov_b32 v5, 0
    s_mov_b64 exec, 1
    buffer_store_dword v1, v5, s[32:35], s3 offen sc1
    s_mov_b64 exec, -1
    buffer_store_dwordx4 v[20:23], v15, s[24:27], s46 offen offset:2048 sc1
    buffer_store_dwordx4 v[48:51], v15, s[24:27], s47 offen offset:2048 sc1
    buffer_store_dwordx4 v[76:79], v15, s[24:27], s48 offen offset:2048 sc1
    buffer_store_dwordx4 v[104:107], v15, s[24:27], s49 offen offset:2048 sc1
    buffer_store_dwordx4 v[24:27], v6, s[24:27], s46 offen offset:0 sc1
    buffer_store_dwordx4 v[52:55], v6, s[24:27], s47 offen offset:0 sc1
    buffer_store_dwordx4 v[80:83], v6, s[24:27], s48 offen offset:0 sc1
    buffer_store_dwordx4 v[108:111], v6, s[24:27], s49 offen offset:0 sc1
    v_pk_fma_f32 v[164:165], v[128:129], v[160:161], v[240:241] op_sel:[1,0,0] op_sel_hi:[1,1,1] neg_lo:[1,0,0] neg_hi:[1,0,0]
    v_pk_fma_f32 v[164:165], v[128:129], v[40:41], v[164:165] op_sel:[0,0,0] op_sel_hi:[0,1,1]
    v_cvt_pk_bf16_f32 v188, v164, v165
    v_pk_max_i16 v188, v188, 0
    v_pk_fma_f32 v[166:167], v[128:129], v[162:163], v[242:243] op_sel:[1,0,0] op_sel_hi:[1,1,1] neg_lo:[1,0,0] neg_hi:[1,0,0]
    v_pk_fma_f32 v[166:167], v[128:129], v[42:43], v[166:167] op_sel:[0,0,0] op_sel_hi:[0,1,1]
    v_cvt_pk_bf16_f32 v189, v166, v167
    v_pk_max_i16 v189, v189, 0
    v_pk_fma_f32 v[164:165], v[130:131], v[160:161], v[240:241] op_sel:[1,0,0] op_sel_hi:[1,1,1] neg_lo:[1,0,0] neg_hi:[1,0,0]
    v_pk_fma_f32 v[164:165], v[130:131], v[68:69], v[164:165] op_sel:[0,0,0] op_sel_hi:[0,1,1]
    v_cvt_pk_bf16_f32 v190, v164, v165
    v_pk_max_i16 v190, v190, 0
    v_pk_fma_f32 v[166:167], v[130:131], v[162:163], v[242:243] op_sel:[1,0,0] op_sel_hi:[1,1,1] neg_lo:[1,0,0] neg_hi:[1,0,0]
    v_pk_fma_f32 v[166:167], v[130:131], v[70:71], v[166:167] op_sel:[0,0,0] op_sel_hi:[0,1,1]
    v_cvt_pk_bf16_f32 v191, v166, v167
    v_pk_max_i16 v191, v191, 0
    v_permlane32_swap_b32 v188, v190
    s_nop 0
    v_permlane32_swap_b32 v189, v191
    buffer_store_dwordx4 v[188:191], v9, s[24:27], s50 offen sc1
    v_pk_fma_f32 v[164:165], v[132:133], v[160:161], v[240:241] op_sel:[1,0,0] op_sel_hi:[1,1,1] neg_lo:[1,0,0] neg_hi:[1,0,0]
    v_pk_fma_f32 v[164:165], v[132:133], v[96:97], v[164:165] op_sel:[0,0,0] op_sel_hi:[0,1,1]
    v_cvt_pk_bf16_f32 v192, v164, v165
    v_pk_max_i16 v192, v192, 0
    v_pk_fma_f32 v[166:167], v[132:133], v[162:163], v[242:243] op_sel:[1,0,0] op_sel_hi:[1,1,1] neg_lo:[1,0,0] neg_hi:[1,0,0]
    v_pk_fma_f32 v[166:167], v[132:133], v[98:99], v[166:167] op_sel:[0,0,0] op_sel_hi:[0,1,1]
    v_cvt_pk_bf16_f32 v193, v166, v167
    v_pk_max_i16 v193, v193, 0
    v_pk_fma_f32 v[164:165], v[134:135], v[160:161], v[240:241] op_sel:[1,0,0] op_sel_hi:[1,1,1] neg_lo:[1,0,0] neg_hi:[1,0,0]
    v_pk_fma_f32 v[164:165], v[134:135], v[124:125], v[164:165] op_sel:[0,0,0] op_sel_hi:[0,1,1]
    v_cvt_pk_bf16_f32 v194, v164, v165
    v_pk_max_i16 v194, v194, 0
    v_pk_fma_f32 v[166:167], v[134:135], v[162:163], v[242:243] op_sel:[1,0,0] op_sel_hi:[1,1,1] neg_lo:[1,0,0] neg_hi:[1,0,0]
    v_pk_fma_f32 v[166:167], v[134:135], v[126:127], v[166:167] op_sel:[0,0,0] op_sel_hi:[0,1,1]
    v_cvt_pk_bf16_f32 v195, v166, v167
    v_pk_max_i16 v195, v195, 0
    v_permlane32_swap_b32 v192, v194
    s_nop 0
    v_permlane32_swap_b32 v193, v195
    buffer_store_dwordx4 v[192:195], v9, s[24:27], s51 offen sc1
    s_barrier
    s_load_dwordx2 s[8:9], s[0:1], 80
    s_and_b32 s14, s2, 7
    s_lshr_b32 s15, s2, 3
    s_and_b32 s12, s14, 1
    s_lshl_b32 s12, s12, 3
    s_and_b32 s3, s15, 7
    s_add_u32 s12, s12, s3
    s_and_b32 s11, s14, 2
    s_lshl_b32 s11, s11, 1
    s_lshr_b32 s3, s15, 3
    s_add_u32 s11, s11, s3
    s_lshr_b32 s10, s14, 2
    s_lshl_b32 s13, s11, 1
    s_add_u32 s13, s13, s10
    s_lshr_b32 s38, s95, 1
    s_and_b32 s39, s95, 1
    v_and_b32 v3, 15, v2
    v_lshrrev_b32 v4, 4, v2
    v_lshrrev_b32 v5, 2, v2
    v_and_b32 v5, 3, v5
    v_and_b32 v6, 3, v2
    v_and_b32 v7, 1, v4
    v_mov_b32 v8, v4
    v_mul_u32_u24 v8, 1024, v8
    v_lshl_add_u32 v8, v5, 6, v8
    v_lshl_add_u32 v8, v6, 3, v8
    s_mul_i32 s40, s39, 2
    s_and_b32 s41, s40, 1
    v_xor_b32 v7, s41, v7
    v_lshl_add_u32 v8, v7, 5, v8
    s_lshr_b32 s41, s40, 1
    s_lshl_b32 s41, s41, 8
    v_add_u32 v10, s41, v8
    v_xor_b32 v8, 32, v8
    s_add_u32 s41, s40, 1
    s_lshr_b32 s41, s41, 1
    s_lshl_b32 s41, s41, 8
    v_add_u32 v11, s41, v8
    s_mul_i32 s41, s38, 8192
    s_add_u32 s41, s41, 16384
    v_lshlrev_b32 v8, 4, v2
    v_add_u32 v12, s41, v8
    s_mov_b32 s43, 32768
    s_mov_b32 s40, 0
    s_lshl_b32 s46, s13, 1
    s_add_u32 s46, s46, s39
    s_lshl_b32 s47, s12, 3
    s_lshl_b32 s3, s38, 2
    s_add_u32 s47, s47, s3
    v_lshlrev_b32 v14, 9, v4
    v_mov_b32 v16, 0
    v_mov_b32 v17, 0
    v_mov_b32 v18, 0
    v_mov_b32 v19, 0
    v_mov_b32 v20, 0
    v_mov_b32 v21, 0
    v_mov_b32 v22, 0
    v_mov_b32 v23, 0
    v_mov_b32 v24, 0
    v_mov_b32 v25, 0
    v_mov_b32 v26, 0
    v_mov_b32 v27, 0
    v_mov_b32 v28, 0
    v_mov_b32 v29, 0
    v_mov_b32 v30, 0
    v_mov_b32 v31, 0
    v_mov_b32 v32, 0
    v_mov_b32 v33, 0
    v_mov_b32 v34, 0
    v_mov_b32 v35, 0
    v_mov_b32 v36, 0
    v_mov_b32 v37, 0
    v_mov_b32 v38, 0
    v_mov_b32 v39, 0
    v_mov_b32 v40, 0
    v_mov_b32 v41, 0
    v_mov_b32 v42, 0
    v_mov_b32 v43, 0
    v_mov_b32 v44, 0
    v_mov_b32 v45, 0
    v_mov_b32 v46, 0
    v_mov_b32 v47, 0
    v_mov_b32 v48, 0
    v_mov_b32 v49, 0
    v_mov_b32 v50, 0
    v_mov_b32 v51, 0
    v_mov_b32 v52, 0
    v_mov_b32 v53, 0
    v_mov_b32 v54, 0
    v_mov_b32 v55, 0
    v_mov_b32 v56, 0
    v_mov_b32 v57, 0
    v_mov_b32 v58, 0
    v_mov_b32 v59, 0
    v_mov_b32 v60, 0
    v_mov_b32 v61, 0
    v_mov_b32 v62, 0
    v_mov_b32 v63, 0
    v_mov_b32 v64, 0
    v_mov_b32 v65, 0
    v_mov_b32 v66, 0
    v_mov_b32 v67, 0
    v_mov_b32 v68, 0
    v_mov_b32 v69, 0
    v_mov_b32 v70, 0
    v_mov_b32 v71, 0
    v_mov_b32 v72, 0
    v_mov_b32 v73, 0
    v_mov_b32 v74, 0
    v_mov_b32 v75, 0
    v_mov_b32 v76, 0
    v_mov_b32 v77, 0
    v_mov_b32 v78, 0
    v_mov_b32 v79, 0
    v_lshlrev_b32 v13, 11, v3
    v_and_b32 v7, 1, v4
    v_lshl_add_u32 v13, v7, 5, v13
    v_lshrrev_b32 v7, 1, v4
    v_lshl_add_u32 v13, v7, 4, v13
    s_lshl_b32 s48, s47, 15
    s_lshl_b32 s3, s46, 6
    s_add_u32 s48, s48, s3
    s_lshl_b32 s49, s95, 12
    s_xor_b32 s3, s2, 4
    s_mul_i32 s3, s3, 49152
    s_add_u32 s3, s3, s49
    s_add_u32 s52, s3, 0
    s_mul_i32 s57, s2, 49152
    s_add_u32 s57, s57, s49
    s_add_u32 s58, s57, 16384
    s_add_u32 s59, s57, 32768
    v_lshrrev_b32 v7, 2, v3
    v_cmp_eq_u32 vcc, v7, v4
    v_and_b32 v7, 1, v3
    v_lshlrev_b32 v7, 4, v7
    v_mov_b32 v8, 0x3f80
    v_lshlrev_b32 v8, v7, v8
    v_cndmask_b32 v8, 0, v8, vcc
    v_and_b32 v7, 2, v3
    v_cmp_eq_u32 vcc, 0, v7
    s_nop 1
    v_cndmask_b32 v242, 0, v8, vcc
    v_cndmask_b32 v243, v8, 0, vcc
    v_mov_b32 v240, 0
    v_mov_b32 v241, 0
    v_mov_b32 v244, 0
    v_mov_b32 v245, 0
    s_add_u32 s28, s6, 67108864
    s_addc_u32 s29, s7, 0
    s_mov_b32 s30, 12582912
    s_mov_b32 s31, 0x20000
    s_add_u32 s16, s6, 9437184
    s_addc_u32 s17, s7, 0
    s_mov_b32 s18, 4194304
    s_mov_b32 s19, 0x20000
    s_lshl_b32 s50, s47, 5
    s_add_u32 s50, s50, s46
    s_lshl_b32 s50, s50, 10
    s_barrier
    s_waitcnt vmcnt(0) lgkmcnt(0)
    v_mov_b32 v1, s100
    v_mov_b32 v5, 0
    s_mov_b64 exec, 1
    buffer_store_dword v1, v5, s[32:35], s56 offen sc1
    s_mov_b64 exec, -1
    s_mov_b32 s24, s8
    s_mov_b32 s25, s9
    s_mov_b32 s26, 4194304
    s_mov_b32 s27, 0x20000
    v_lshlrev_b32 v5, 4, v2
    s_setprio 0
    s_barrier
    ds_read_b64_tr_b16 v[176:177], v10 offset:0
    ds_read_b64_tr_b16 v[178:179], v10 offset:4096
    ds_read_b128 v[144:147], v12 offset:0
    ds_read_b128 v[148:151], v12 offset:2048
    ds_read_b128 v[152:155], v12 offset:4096
    ds_read_b128 v[156:159], v12 offset:6144
    ds_read_b64_tr_b16 v[180:181], v11 offset:0
    ds_read_b64_tr_b16 v[182:183], v11 offset:4096
    ds_read_b64_tr_b16 v[184:185], v10 offset:512
    ds_read_b64_tr_b16 v[186:187], v10 offset:4608
    ds_read_b64_tr_b16 v[188:189], v11 offset:512
    ds_read_b64_tr_b16 v[190:191], v11 offset:4608
    s_mov_b32 s41, 16
.Lk3_gl_71:
    s_waitcnt lgkmcnt(0)
    v_mfma_f32_16x16x32_bf16 v[16:19], v[176:179], v[144:147], v[16:19]
    ds_read_b64_tr_b16 v[224:225], v10 offset:8192
    ds_read_b64_tr_b16 v[226:227], v10 offset:12288
    v_mfma_f32_16x16x32_bf16 v[32:35], v[176:179], v[148:151], v[32:35]
    ds_read_b128 v[192:195], v12 offset:1024
    ds_read_b128 v[196:199], v12 offset:3072
    v_mfma_f32_16x16x32_bf16 v[48:51], v[176:179], v[152:155], v[48:51]
    ds_read_b128 v[200:203], v12 offset:5120
    ds_read_b128 v[204:207], v12 offset:7168
    v_mfma_f32_16x16x32_bf16 v[64:67], v[176:179], v[156:159], v[64:67]
    ds_read_b64_tr_b16 v[228:229], v11 offset:8192
    ds_read_b64_tr_b16 v[230:231], v11 offset:12288
    v_mfma_f32_16x16x32_bf16 v[20:23], v[180:183], v[144:147], v[20:23]
    ds_read_b64_tr_b16 v[232:233], v10 offset:8704
    ds_read_b64_tr_b16 v[234:235], v10 offset:12800
    v_mfma_f32_16x16x32_bf16 v[36:39], v[180:183], v[148:151], v[36:39]
    ds_read_b64_tr_b16 v[236:237], v11 offset:8704
    ds_read_b64_tr_b16 v[238:239], v11 offset:12800
    v_mfma_f32_16x16x32_bf16 v[52:55], v[180:183], v[152:155], v[52:55]
    s_add_u32 s40, s40, 32768
    s_cmp_eq_u32 s40, 163840
    v_mfma_f32_16x16x32_bf16 v[68:71], v[180:183], v[156:159], v[68:71]
    s_cselect_b32 s42, 0xfffe0000, s43
    s_cselect_b32 s40, 0, s40
    v_mfma_f32_16x16x32_bf16 v[24:27], v[184:187], v[144:147], v[24:27]
    v_add_u32 v10, s42, v10
    v_add_u32 v11, s42, v11
    v_mfma_f32_16x16x32_bf16 v[40:43], v[184:187], v[148:151], v[40:43]
    v_add_u32 v12, s42, v12
    s_sub_u32 s41, s41, 1
    v_mfma_f32_16x16x32_bf16 v[56:59], v[184:187], v[152:155], v[56:59]
    s_cmp_eq_u32 s41, 0
    v_mfma_f32_16x16x32_bf16 v[72:75], v[184:187], v[156:159], v[72:75]
    v_mfma_f32_16x16x32_bf16 v[28:31], v[188:191], v[144:147], v[28:31]
    v_mfma_f32_16x16x32_bf16 v[44:47], v[188:191], v[148:151], v[44:47]
    v_mfma_f32_16x16x32_bf16 v[60:63], v[188:191], v[152:155], v[60:63]
    v_mfma_f32_16x16x32_bf16 v[76:79], v[188:191], v[156:159], v[76:79]
    s_waitcnt lgkmcnt(0)
    s_cbranch_scc1 .Lk3_gt_72
    s_barrier
    v_mfma_f32_16x16x32_bf16 v[16:19], v[224:227], v[192:195], v[16:19]
    ds_read_b64_tr_b16 v[176:177], v10 offset:0
    ds_read_b64_tr_b16 v[178:179], v10 offset:4096
    v_mfma_f32_16x16x32_bf16 v[32:35], v[224:227], v[196:199], v[32:35]
    ds_read_b128 v[144:147], v12 offset:0
    ds_read_b128 v[148:151], v12 offset:2048
    v_mfma_f32_16x16x32_bf16 v[48:51], v[224:227], v[200:203], v[48:51]
    ds_read_b128 v[152:155], v12 offset:4096
    ds_read_b128 v[156:159], v12 offset:6144
    v_mfma_f32_16x16x32_bf16 v[64:67], v[224:227], v[204:207], v[64:67]
    ds_read_b64_tr_b16 v[180:181], v11 offset:0
    ds_read_b64_tr_b16 v[182:183], v11 offset:4096
    v_mfma_f32_16x16x32_bf16 v[20:23], v[228:231], v[192:195], v[20:23]
    ds_read_b64_tr_b16 v[184:185], v10 offset:512
    ds_read_b64_tr_b16 v[186:187], v10 offset:4608
    v_mfma_f32_16x16x32_bf16 v[36:39], v[228:231], v[196:199], v[36:39]
    ds_read_b64_tr_b16 v[188:189], v11 offset:512
    ds_read_b64_tr_b16 v[190:191], v11 offset:4608
    v_mfma_f32_16x16x32_bf16 v[52:55], v[228:231], v[200:203], v[52:55]
    v_mfma_f32_16x16x32_bf16 v[68:71], v[228:231], v[204:207], v[68:71]
    v_mfma_f32_16x16x32_bf16 v[24:27], v[232:235], v[192:195], v[24:27]
    v_mfma_f32_16x16x32_bf16 v[40:43], v[232:235], v[196:199], v[40:43]
    v_mfma_f32_16x16x32_bf16 v[56:59], v[232:235], v[200:203], v[56:59]
    v_mfma_f32_16x16x32_bf16 v[72:75], v[232:235], v[204:207], v[72:75]
    v_mfma_f32_16x16x32_bf16 v[28:31], v[236:239], v[192:195], v[28:31]
    v_mfma_f32_16x16x32_bf16 v[44:47], v[236:239], v[196:199], v[44:47]
    v_mfma_f32_16x16x32_bf16 v[60:63], v[236:239], v[200:203], v[60:63]
    v_mfma_f32_16x16x32_bf16 v[76:79], v[236:239], v[204:207], v[76:79]
    s_branch .Lk3_gl_71
.Lk3_gt_72:
    s_barrier
    v_mfma_f32_16x16x32_bf16 v[16:19], v[224:227], v[192:195], v[16:19]
    ds_read_b64_tr_b16 v[176:177], v10 offset:0
    ds_read_b64_tr_b16 v[178:179], v10 offset:4096
    v_mfma_f32_16x16x32_bf16 v[32:35], v[224:227], v[196:199], v[32:35]
    ds_read_b128 v[144:147], v12 offset:0
    ds_read_b128 v[148:151], v12 offset:2048
    v_mfma_f32_16x16x32_bf16 v[48:51], v[224:227], v[200:203], v[48:51]
    ds_read_b128 v[152:155], v12 offset:4096
    ds_read_b128 v[156:159], v12 offset:6144
    v_mfma_f32_16x16x32_bf16 v[64:67], v[224:227], v[204:207], v[64:67]
    ds_read_b64_tr_b16 v[180:181], v11 offset:0
    ds_read_b64_tr_b16 v[182:183], v11 offset:4096
    v_mfma_f32_16x16x32_bf16 v[20:23], v[228:231], v[192:195], v[20:23]
    ds_read_b64_tr_b16 v[184:185], v10 offset:512
    ds_read_b64_tr_b16 v[186:187], v10 offset:4608
    v_mfma_f32_16x16x32_bf16 v[36:39], v[228:231], v[196:199], v[36:39]
    ds_read_b64_tr_b16 v[188:189], v11 offset:512
    ds_read_b64_tr_b16 v[190:191], v11 offset:4608
    v_mfma_f32_16x16x32_bf16 v[52:55], v[228:231], v[200:203], v[52:55]
    v_mfma_f32_16x16x32_bf16 v[68:71], v[228:231], v[204:207], v[68:71]
    v_mfma_f32_16x16x32_bf16 v[24:27], v[232:235], v[192:195], v[24:27]
    v_mfma_f32_16x16x32_bf16 v[40:43], v[232:235], v[196:199], v[40:43]
    v_mfma_f32_16x16x32_bf16 v[56:59], v[232:235], v[200:203], v[56:59]
    v_mfma_f32_16x16x32_bf16 v[72:75], v[232:235], v[204:207], v[72:75]
    v_mfma_f32_16x16x32_bf16 v[28:31], v[236:239], v[192:195], v[28:31]
    v_mfma_f32_16x16x32_bf16 v[44:47], v[236:239], v[196:199], v[44:47]
    v_mfma_f32_16x16x32_bf16 v[60:63], v[236:239], v[200:203], v[60:63]
    v_mfma_f32_16x16x32_bf16 v[76:79], v[236:239], v[204:207], v[76:79]
    s_mov_b32 s41, 1
    s_waitcnt lgkmcnt(0)
    v_mfma_f32_16x16x32_bf16 v[16:19], v[176:179], v[144:147], v[16:19]
    ds_read_b64_tr_b16 v[224:225], v10 offset:8192
    ds_read_b64_tr_b16 v[226:227], v10 offset:12288
    v_mfma_f32_16x16x32_bf16 v[32:35], v[176:179], v[148:151], v[32:35]
    ds_read_b128 v[192:195], v12 offset:1024
    ds_read_b128 v[196:199], v12 offset:3072
    v_mfma_f32_16x16x32_bf16 v[48:51], v[176:179], v[152:155], v[48:51]
    ds_read_b128 v[200:203], v12 offset:5120
    ds_read_b128 v[204:207], v12 offset:7168
    v_mfma_f32_16x16x32_bf16 v[64:67], v[176:179], v[156:159], v[64:67]
    ds_read_b64_tr_b16 v[228:229], v11 offset:8192
    ds_read_b64_tr_b16 v[230:231], v11 offset:12288
    v_mfma_f32_16x16x32_bf16 v[20:23], v[180:183], v[144:147], v[20:23]
    ds_read_b64_tr_b16 v[232:233], v10 offset:8704
    ds_read_b64_tr_b16 v[234:235], v10 offset:12800
    v_mfma_f32_16x16x32_bf16 v[36:39], v[180:183], v[148:151], v[36:39]
    ds_read_b64_tr_b16 v[236:237], v11 offset:8704
    ds_read_b64_tr_b16 v[238:239], v11 offset:12800
    v_mfma_f32_16x16x32_bf16 v[52:55], v[180:183], v[152:155], v[52:55]
    s_add_u32 s40, s40, 32768
    s_cmp_eq_u32 s40, 163840
    v_mfma_f32_16x16x32_bf16 v[68:71], v[180:183], v[156:159], v[68:71]
    s_cselect_b32 s42, 0xfffe0000, s43
    s_cselect_b32 s40, 0, s40
    v_mfma_f32_16x16x32_bf16 v[24:27], v[184:187], v[144:147], v[24:27]
    v_add_u32 v10, s42, v10
    v_add_u32 v11, s42, v11
    v_mfma_f32_16x16x32_bf16 v[40:43], v[184:187], v[148:151], v[40:43]
    v_add_u32 v12, s42, v12
    s_sub_u32 s41, s41, 1
    v_mfma_f32_16x16x32_bf16 v[56:59], v[184:187], v[152:155], v[56:59]
    s_cmp_eq_u32 s41, 0
    v_mfma_f32_16x16x32_bf16 v[72:75], v[184:187], v[156:159], v[72:75]
    v_mfma_f32_16x16x32_bf16 v[28:31], v[188:191], v[144:147], v[28:31]
    v_mfma_f32_16x16x32_bf16 v[44:47], v[188:191], v[148:151], v[44:47]
    v_mfma_f32_16x16x32_bf16 v[60:63], v[188:191], v[152:155], v[60:63]
    v_mfma_f32_16x16x32_bf16 v[76:79], v[188:191], v[156:159], v[76:79]
    s_waitcnt lgkmcnt(0)
    s_barrier
    v_mfma_f32_16x16x32_bf16 v[16:19], v[224:227], v[192:195], v[16:19]
    ds_read_b64_tr_b16 v[176:177], v10 offset:0
    ds_read_b64_tr_b16 v[178:179], v10 offset:4096
    v_mfma_f32_16x16x32_bf16 v[32:35], v[224:227], v[196:199], v[32:35]
    ds_read_b128 v[144:147], v12 offset:0
    ds_read_b128 v[148:151], v12 offset:2048
    v_mfma_f32_16x16x32_bf16 v[48:51], v[224:227], v[200:203], v[48:51]
    ds_read_b128 v[152:155], v12 offset:4096
    ds_read_b128 v[156:159], v12 offset:6144
    buffer_load_dwordx4 v[80:83], v5, s[16:19], s50 offen sc1
    v_mfma_f32_16x16x32_bf16 v[64:67], v[224:227], v[204:207], v[64:67]
    ds_read_b64_tr_b16 v[180:181], v11 offset:0
    ds_read_b64_tr_b16 v[182:183], v11 offset:4096
    v_mfma_f32_16x16x32_bf16 v[20:23], v[228:231], v[192:195], v[20:23]
    ds_read_b64_tr_b16 v[184:185], v10 offset:512
    ds_read_b64_tr_b16 v[186:187], v10 offset:4608
    s_add_u32 s50, s50, 32768
    v_mfma_f32_16x16x32_bf16 v[36:39], v[228:231], v[196:199], v[36:39]
    ds_read_b64_tr_b16 v[188:189], v11 offset:512
    ds_read_b64_tr_b16 v[190:191], v11 offset:4608
    v_mfma_f32_16x16x32_bf16 v[52:55], v[228:231], v[200:203], v[52:55]
    buffer_load_dwordx4 v[84:87], v5, s[16:19], s50 offen sc1
    v_mfma_f32_16x16x32_bf16 v[68:71], v[228:231], v[204:207], v[68:71]
    v_mfma_f32_16x16x32_bf16 v[24:27], v[232:235], v[192:195], v[24:27]
    v_mfma_f32_16x16x32_bf16 v[40:43], v[232:235], v[196:199], v[40:43]
    s_add_u32 s50, s50, 32768
    v_mfma_f32_16x16x32_bf16 v[56:59], v[232:235], v[200:203], v[56:59]
    v_mfma_f32_16x16x32_bf16 v[72:75], v[232:235], v[204:207], v[72:75]
    buffer_load_dwordx4 v[88:91], v5, s[16:19], s50 offen sc1
    v_mfma_f32_16x16x32_bf16 v[28:31], v[236:239], v[192:195], v[28:31]
    v_mfma_f32_16x16x32_bf16 v[44:47], v[236:239], v[196:199], v[44:47]
    s_add_u32 s50, s50, 32768
    v_mfma_f32_16x16x32_bf16 v[60:63], v[236:239], v[200:203], v[60:63]
    v_mfma_f32_16x16x32_bf16 v[76:79], v[236:239], v[204:207], v[76:79]
    buffer_load_dwordx4 v[92:95], v5, s[16:19], s50 offen sc1
    s_mov_b32 s41, 4
.Lk3_gl_75:
    s_waitcnt lgkmcnt(0)
    v_mfma_f32_16x16x32_bf16 v[16:19], v[176:179], v[144:147], v[16:19]
    ds_read_b64_tr_b16 v[224:225], v10 offset:8192
    ds_read_b64_tr_b16 v[226:227], v10 offset:12288
    v_mfma_f32_16x16x32_bf16 v[32:35], v[176:179], v[148:151], v[32:35]
    ds_read_b128 v[192:195], v12 offset:1024
    ds_read_b128 v[196:199], v12 offset:3072
    v_mfma_f32_16x16x32_bf16 v[48:51], v[176:179], v[152:155], v[48:51]
    ds_read_b128 v[200:203], v12 offset:5120
    ds_read_b128 v[204:207], v12 offset:7168
    v_mfma_f32_16x16x32_bf16 v[64:67], v[176:179], v[156:159], v[64:67]
    ds_read_b64_tr_b16 v[228:229], v11 offset:8192
    ds_read_b64_tr_b16 v[230:231], v11 offset:12288
    v_mfma_f32_16x16x32_bf16 v[20:23], v[180:183], v[144:147], v[20:23]
    ds_read_b64_tr_b16 v[232:233], v10 offset:8704
    ds_read_b64_tr_b16 v[234:235], v10 offset:12800
    v_mfma_f32_16x16x32_bf16 v[36:39], v[180:183], v[148:151], v[36:39]
    ds_read_b64_tr_b16 v[236:237], v11 offset:8704
    ds_read_b64_tr_b16 v[238:239], v11 offset:12800
    v_mfma_f32_16x16x32_bf16 v[52:55], v[180:183], v[152:155], v[52:55]
    s_add_u32 s40, s40, 32768
    s_cmp_eq_u32 s40, 163840
    v_mfma_f32_16x16x32_bf16 v[68:71], v[180:183], v[156:159], v[68:71]
    s_cselect_b32 s42, 0xfffe0000, s43
    s_cselect_b32 s40, 0, s40
    v_mfma_f32_16x16x32_bf16 v[24:27], v[184:187], v[144:147], v[24:27]
    v_add_u32 v10, s42, v10
    v_add_u32 v11, s42, v11
    v_mfma_f32_16x16x32_bf16 v[40:43], v[184:187], v[148:151], v[40:43]
    v_add_u32 v12, s42, v12
    s_sub_u32 s41, s41, 1
    v_mfma_f32_16x16x32_bf16 v[56:59], v[184:187], v[152:155], v[56:59]
    s_cmp_eq_u32 s41, 0
    v_mfma_f32_16x16x32_bf16 v[72:75], v[184:187], v[156:159], v[72:75]
    v_mfma_f32_16x16x32_bf16 v[28:31], v[188:191], v[144:147], v[28:31]
    v_mfma_f32_16x16x32_bf16 v[44:47], v[188:191], v[148:151], v[44:47]
    v_mfma_f32_16x16x32_bf16 v[60:63], v[188:191], v[152:155], v[60:63]
    v_mfma_f32_16x16x32_bf16 v[76:79], v[188:191], v[156:159], v[76:79]
    s_waitcnt lgkmcnt(0)
    s_cbranch_scc1 .Lk3_gt_76
    s_barrier
    v_mfma_f32_16x16x32_bf16 v[16:19], v[224:227], v[192:195], v[16:19]
    ds_read_b64_tr_b16 v[176:177], v10 offset:0
    ds_read_b64_tr_b16 v[178:179], v10 offset:4096
    v_mfma_f32_16x16x32_bf16 v[32:35], v[224:227], v[196:199], v[32:35]
    ds_read_b128 v[144:147], v12 offset:0
    ds_read_b128 v[148:151], v12 offset:2048
    v_mfma_f32_16x16x32_bf16 v[48:51], v[224:227], v[200:203], v[48:51]
    ds_read_b128 v[152:155], v12 offset:4096
    ds_read_b128 v[156:159], v12 offset:6144
    v_mfma_f32_16x16x32_bf16 v[64:67], v[224:227], v[204:207], v[64:67]
    ds_read_b64_tr_b16 v[180:181], v11 offset:0
    ds_read_b64_tr_b16 v[182:183], v11 offset:4096
    v_mfma_f32_16x16x32_bf16 v[20:23], v[228:231], v[192:195], v[20:23]
    ds_read_b64_tr_b16 v[184:185], v10 offset:512
    ds_read_b64_tr_b16 v[186:187], v10 offset:4608
    v_mfma_f32_16x16x32_bf16 v[36:39], v[228:231], v[196:199], v[36:39]
    ds_read_b64_tr_b16 v[188:189], v11 offset:512
    ds_read_b64_tr_b16 v[190:191], v11 offset:4608
    v_mfma_f32_16x16x32_bf16 v[52:55], v[228:231], v[200:203], v[52:55]
    v_mfma_f32_16x16x32_bf16 v[68:71], v[228:231], v[204:207], v[68:71]
    v_mfma_f32_16x16x32_bf16 v[24:27], v[232:235], v[192:195], v[24:27]
    v_mfma_f32_16x16x32_bf16 v[40:43], v[232:235], v[196:199], v[40:43]
    v_mfma_f32_16x16x32_bf16 v[56:59], v[232:235], v[200:203], v[56:59]
    v_mfma_f32_16x16x32_bf16 v[72:75], v[232:235], v[204:207], v[72:75]
    v_mfma_f32_16x16x32_bf16 v[28:31], v[236:239], v[192:195], v[28:31]
    v_mfma_f32_16x16x32_bf16 v[44:47], v[236:239], v[196:199], v[44:47]
    v_mfma_f32_16x16x32_bf16 v[60:63], v[236:239], v[200:203], v[60:63]
    v_mfma_f32_16x16x32_bf16 v[76:79], v[236:239], v[204:207], v[76:79]
    s_branch .Lk3_gl_75
.Lk3_gt_76:
    s_barrier
    v_mfma_f32_16x16x32_bf16 v[16:19], v[224:227], v[192:195], v[16:19]
    ds_read_b64_tr_b16 v[176:177], v10 offset:0
    ds_read_b64_tr_b16 v[178:179], v10 offset:4096
    v_mfma_f32_16x16x32_bf16 v[32:35], v[224:227], v[196:199], v[32:35]
    ds_read_b128 v[144:147], v12 offset:0
    ds_read_b128 v[148:151], v12 offset:2048
    v_mfma_f32_16x16x32_bf16 v[48:51], v[224:227], v[200:203], v[48:51]
    ds_read_b128 v[152:155], v12 offset:4096
    ds_read_b128 v[156:159], v12 offset:6144
    v_mfma_f32_16x16x32_bf16 v[64:67], v[224:227], v[204:207], v[64:67]
    ds_read_b64_tr_b16 v[180:181], v11 offset:0
    ds_read_b64_tr_b16 v[182:183], v11 offset:4096
    v_mfma_f32_16x16x32_bf16 v[20:23], v[228:231], v[192:195], v[20:23]
    ds_read_b64_tr_b16 v[184:185], v10 offset:512
    ds_read_b64_tr_b16 v[186:187], v10 offset:4608
    v_mfma_f32_16x16x32_bf16 v[36:39], v[228:231], v[196:199], v[36:39]
    ds_read_b64_tr_b16 v[188:189], v11 offset:512
    ds_read_b64_tr_b16 v[190:191], v11 offset:4608
    v_mfma_f32_16x16x32_bf16 v[52:55], v[228:231], v[200:203], v[52:55]
    v_mfma_f32_16x16x32_bf16 v[68:71], v[228:231], v[204:207], v[68:71]
    v_mfma_f32_16x16x32_bf16 v[24:27], v[232:235], v[192:195], v[24:27]
    v_mfma_f32_16x16x32_bf16 v[40:43], v[232:235], v[196:199], v[40:43]
    v_mfma_f32_16x16x32_bf16 v[56:59], v[232:235], v[200:203], v[56:59]
    v_mfma_f32_16x16x32_bf16 v[72:75], v[232:235], v[204:207], v[72:75]
    v_mfma_f32_16x16x32_bf16 v[28:31], v[236:239], v[192:195], v[28:31]
    v_mfma_f32_16x16x32_bf16 v[44:47], v[236:239], v[196:199], v[44:47]
    v_mfma_f32_16x16x32_bf16 v[60:63], v[236:239], v[200:203], v[60:63]
    v_mfma_f32_16x16x32_bf16 v[76:79], v[236:239], v[204:207], v[76:79]
    s_mov_b32 s41, 1
    s_waitcnt lgkmcnt(0)
    v_mfma_f32_16x16x32_bf16 v[16:19], v[176:179], v[144:147], v[16:19]
    ds_read_b64_tr_b16 v[224:225], v10 offset:8192
    ds_read_b64_tr_b16 v[226:227], v10 offset:12288
    s_waitcnt vmcnt(0)
    v_mfma_f32_16x16x32_bf16 v[32:35], v[176:179], v[148:151], v[32:35]
    ds_read_b128 v[192:195], v12 offset:1024
    ds_read_b128 v[196:199], v12 offset:3072
    v_lshlrev_b32 v96, 16, v80
    v_mfma_f32_16x16x32_bf16 v[48:51], v[176:179], v[152:155], v[48:51]
    ds_read_b128 v[200:203], v12 offset:5120
    ds_read_b128 v[204:207], v12 offset:7168
    v_and_b32 v97, 0xffff0000, v80
    v_mfma_f32_16x16x32_bf16 v[64:67], v[176:179], v[156:159], v[64:67]
    ds_read_b64_tr_b16 v[228:229], v11 offset:8192
    ds_read_b64_tr_b16 v[230:231], v11 offset:12288
    v_lshlrev_b32 v98, 16, v81
    v_mfma_f32_16x16x32_bf16 v[20:23], v[180:183], v[144:147], v[20:23]
    ds_read_b64_tr_b16 v[232:233], v10 offset:8704
    ds_read_b64_tr_b16 v[234:235], v10 offset:12800
    v_and_b32 v99, 0xffff0000, v81
    v_mfma_f32_16x16x32_bf16 v[36:39], v[180:183], v[148:151], v[36:39]
    ds_read_b64_tr_b16 v[236:237], v11 offset:8704
    ds_read_b64_tr_b16 v[238:239], v11 offset:12800
    v_lshlrev_b32 v100, 16, v82
    v_mfma_f32_16x16x32_bf16 v[52:55], v[180:183], v[152:155], v[52:55]
    v_and_b32 v101, 0xffff0000, v82
    v_mfma_f32_16x16x32_bf16 v[68:71], v[180:183], v[156:159], v[68:71]
    v_lshlrev_b32 v102, 16, v83
    v_mfma_f32_16x16x32_bf16 v[24:27], v[184:187], v[144:147], v[24:27]
    v_and_b32 v103, 0xffff0000, v83
    v_mfma_f32_16x16x32_bf16 v[40:43], v[184:187], v[148:151], v[40:43]
    v_lshlrev_b32 v104, 16, v84
    v_mfma_f32_16x16x32_bf16 v[56:59], v[184:187], v[152:155], v[56:59]
    v_and_b32 v105, 0xffff0000, v84
    v_mfma_f32_16x16x32_bf16 v[72:75], v[184:187], v[156:159], v[72:75]
    v_lshlrev_b32 v106, 16, v85
    v_mfma_f32_16x16x32_bf16 v[28:31], v[188:191], v[144:147], v[28:31]
    v_and_b32 v107, 0xffff0000, v85
    v_mfma_f32_16x16x32_bf16 v[44:47], v[188:191], v[148:151], v[44:47]
    v_lshlrev_b32 v108, 16, v86
    v_mfma_f32_16x16x32_bf16 v[60:63], v[188:191], v[152:155], v[60:63]
    v_and_b32 v109, 0xffff0000, v86
    v_mfma_f32_16x16x32_bf16 v[76:79], v[188:191], v[156:159], v[76:79]
    v_lshlrev_b32 v110, 16, v87
    v_and_b32 v111, 0xffff0000, v87
    s_add_u32 s40, s40, 32768
    s_cmp_eq_u32 s40, 163840
    s_cselect_b32 s42, 0xfffe0000, s43
    s_cselect_b32 s40, 0, s40
    v_add_u32 v10, s42, v10
    v_add_u32 v11, s42, v11
    v_add_u32 v12, s42, v12
    s_sub_u32 s41, s41, 1
    s_cmp_eq_u32 s41, 0
    s_waitcnt lgkmcnt(0)
    s_barrier
    v_mfma_f32_16x16x32_bf16 v[16:19], v[224:227], v[192:195], v[16:19]
    ds_read_b64_tr_b16 v[176:177], v10 offset:0
    ds_read_b64_tr_b16 v[178:179], v10 offset:4096
    v_lshlrev_b32 v112, 16, v88
    v_mfma_f32_16x16x32_bf16 v[32:35], v[224:227], v[196:199], v[32:35]
    ds_read_b128 v[144:147], v12 offset:0
    ds_read_b128 v[148:151], v12 offset:2048
    v_and_b32 v113, 0xffff0000, v88
    v_mfma_f32_16x16x32_bf16 v[48:51], v[224:227], v[200:203], v[48:51]
    ds_read_b128 v[152:155], v12 offset:4096
    ds_read_b128 v[156:159], v12 offset:6144
    v_lshlrev_b32 v114, 16, v89
    v_mfma_f32_16x16x32_bf16 v[64:67], v[224:227], v[204:207], v[64:67]
    ds_read_b64_tr_b16 v[180:181], v11 offset:0
    ds_read_b64_tr_b16 v[182:183], v11 offset:4096
    v_and_b32 v115, 0xffff0000, v89
    v_mfma_f32_16x16x32_bf16 v[20:23], v[228:231], v[192:195], v[20:23]
    ds_read_b64_tr_b16 v[184:185], v10 offset:512
    ds_read_b64_tr_b16 v[186:187], v10 offset:4608
    v_lshlrev_b32 v116, 16, v90
    v_mfma_f32_16x16x32_bf16 v[36:39], v[228:231], v[196:199], v[36:39]
    ds_read_b64_tr_b16 v[188:189], v11 offset:512
    ds_read_b64_tr_b16 v[190:191], v11 offset:4608
    v_and_b32 v117, 0xffff0000, v90
    v_mfma_f32_16x16x32_bf16 v[52:55], v[228:231], v[200:203], v[52:55]
    v_lshlrev_b32 v118, 16, v91
    v_mfma_f32_16x16x32_bf16 v[68:71], v[228:231], v[204:207], v[68:71]
    v_and_b32 v119, 0xffff0000, v91
    v_mfma_f32_16x16x32_bf16 v[24:27], v[232:235], v[192:195], v[24:27]
    v_lshlrev_b32 v120, 16, v92
    v_mfma_f32_16x16x32_bf16 v[40:43], v[232:235], v[196:199], v[40:43]
    v_and_b32 v121, 0xffff0000, v92
    v_mfma_f32_16x16x32_bf16 v[56:59], v[232:235], v[200:203], v[56:59]
    v_lshlrev_b32 v122, 16, v93
    v_mfma_f32_16x16x32_bf16 v[72:75], v[232:235], v[204:207], v[72:75]
    v_and_b32 v123, 0xffff0000, v93
    v_mfma_f32_16x16x32_bf16 v[28:31], v[236:239], v[192:195], v[28:31]
    v_lshlrev_b32 v124, 16, v94
    v_mfma_f32_16x16x32_bf16 v[44:47], v[236:239], v[196:199], v[44:47]
    v_and_b32 v125, 0xffff0000, v94
    v_mfma_f32_16x16x32_bf16 v[60:63], v[236:239], v[200:203], v[60:63]
    v_lshlrev_b32 v126, 16, v95
    v_mfma_f32_16x16x32_bf16 v[76:79], v[236:239], v[204:207], v[76:79]
    v_and_b32 v127, 0xffff0000, v95
    s_mov_b32 s41, 2
.Lk3_gl_79:
    s_waitcnt lgkmcnt(0)
    v_mfma_f32_16x16x32_bf16 v[16:19], v[176:179], v[144:147], v[16:19]
    ds_read_b64_tr_b16 v[224:225], v10 offset:8192
    ds_read_b64_tr_b16 v[226:227], v10 offset:12288
    v_mfma_f32_16x16x32_bf16 v[32:35], v[176:179], v[148:151], v[32:35]
    ds_read_b128 v[192:195], v12 offset:1024
    ds_read_b128 v[196:199], v12 offset:3072
    v_mfma_f32_16x16x32_bf16 v[48:51], v[176:179], v[152:155], v[48:51]
    ds_read_b128 v[200:203], v12 offset:5120
    ds_read_b128 v[204:207], v12 offset:7168
    v_mfma_f32_16x16x32_bf16 v[64:67], v[176:179], v[156:159], v[64:67]
    ds_read_b64_tr_b16 v[228:229], v11 offset:8192
    ds_read_b64_tr_b16 v[230:231], v11 offset:12288
    v_mfma_f32_16x16x32_bf16 v[20:23], v[180:183], v[144:147], v[20:23]
    ds_read_b64_tr_b16 v[232:233], v10 offset:8704
    ds_read_b64_tr_b16 v[234:235], v10 offset:12800
    v_mfma_f32_16x16x32_bf16 v[36:39], v[180:183], v[148:151], v[36:39]
    ds_read_b64_tr_b16 v[236:237], v11 offset:8704
    ds_read_b64_tr_b16 v[238:239], v11 offset:12800
    v_mfma_f32_16x16x32_bf16 v[52:55], v[180:183], v[152:155], v[52:55]
    s_add_u32 s40, s40, 32768
    s_cmp_eq_u32 s40, 163840
    v_mfma_f32_16x16x32_bf16 v[68:71], v[180:183], v[156:159], v[68:71]
    s_cselect_b32 s42, 0xfffe0000, s43
    s_cselect_b32 s40, 0, s40
    v_mfma_f32_16x16x32_bf16 v[24:27], v[184:187], v[144:147], v[24:27]
    v_add_u32 v10, s42, v10
    v_add_u32 v11, s42, v11
    v_mfma_f32_16x16x32_bf16 v[40:43], v[184:187], v[148:151], v[40:43]
    v_add_u32 v12, s42, v12
    s_sub_u32 s41, s41, 1
    v_mfma_f32_16x16x32_bf16 v[56:59], v[184:187], v[152:155], v[56:59]
    s_cmp_eq_u32 s41, 0
    v_mfma_f32_16x16x32_bf16 v[72:75], v[184:187], v[156:159], v[72:75]
    v_mfma_f32_16x16x32_bf16 v[28:31], v[188:191], v[144:147], v[28:31]
    v_mfma_f32_16x16x32_bf16 v[44:47], v[188:191], v[148:151], v[44:47]
    v_mfma_f32_16x16x32_bf16 v[60:63], v[188:191], v[152:155], v[60:63]
    v_mfma_f32_16x16x32_bf16 v[76:79], v[188:191], v[156:159], v[76:79]
    s_waitcnt lgkmcnt(0)
    s_cbranch_scc1 .Lk3_gt_80
    s_barrier
    v_mfma_f32_16x16x32_bf16 v[16:19], v[224:227], v[192:195], v[16:19]
    ds_read_b64_tr_b16 v[176:177], v10 offset:0
    ds_read_b64_tr_b16 v[178:179], v10 offset:4096
    v_mfma_f32_16x16x32_bf16 v[32:35], v[224:227], v[196:199], v[32:35]
    ds_read_b128 v[144:147], v12 offset:0
    ds_read_b128 v[148:151], v12 offset:2048
    v_mfma_f32_16x16x32_bf16 v[48:51], v[224:227], v[200:203], v[48:51]
    ds_read_b128 v[152:155], v12 offset:4096
    ds_read_b128 v[156:159], v12 offset:6144
    v_mfma_f32_16x16x32_bf16 v[64:67], v[224:227], v[204:207], v[64:67]
    ds_read_b64_tr_b16 v[180:181], v11 offset:0
    ds_read_b64_tr_b16 v[182:183], v11 offset:4096
    v_mfma_f32_16x16x32_bf16 v[20:23], v[228:231], v[192:195], v[20:23]
    ds_read_b64_tr_b16 v[184:185], v10 offset:512
    ds_read_b64_tr_b16 v[186:187], v10 offset:4608
    v_mfma_f32_16x16x32_bf16 v[36:39], v[228:231], v[196:199], v[36:39]
    ds_read_b64_tr_b16 v[188:189], v11 offset:512
    ds_read_b64_tr_b16 v[190:191], v11 offset:4608
    v_mfma_f32_16x16x32_bf16 v[52:55], v[228:231], v[200:203], v[52:55]
    v_mfma_f32_16x16x32_bf16 v[68:71], v[228:231], v[204:207], v[68:71]
    v_mfma_f32_16x16x32_bf16 v[24:27], v[232:235], v[192:195], v[24:27]
    v_mfma_f32_16x16x32_bf16 v[40:43], v[232:235], v[196:199], v[40:43]
    v_mfma_f32_16x16x32_bf16 v[56:59], v[232:235], v[200:203], v[56:59]
    v_mfma_f32_16x16x32_bf16 v[72:75], v[232:235], v[204:207], v[72:75]
    v_mfma_f32_16x16x32_bf16 v[28:31], v[236:239], v[192:195], v[28:31]
    v_mfma_f32_16x16x32_bf16 v[44:47], v[236:239], v[196:199], v[44:47]
    v_mfma_f32_16x16x32_bf16 v[60:63], v[236:239], v[200:203], v[60:63]
    v_mfma_f32_16x16x32_bf16 v[76:79], v[236:239], v[204:207], v[76:79]
    s_branch .Lk3_gl_79
.Lk3_gt_80:
    v_sub_u32 v10, v10, v14
    v_sub_u32 v11, v11, v14
    s_barrier
    v_mfma_f32_16x16x32_bf16 v[16:19], v[224:227], v[192:195], v[16:19]
    ds_read_b64_tr_b16 v[176:177], v10 offset:0
    ds_read_b64_tr_b16 v[178:179], v10 offset:2048
    v_mfma_f32_16x16x32_bf16 v[32:35], v[224:227], v[196:199], v[32:35]
    ds_read_b128 v[144:147], v12 offset:0
    ds_read_b128 v[148:151], v12 offset:2048
    v_mfma_f32_16x16x32_bf16 v[48:51], v[224:227], v[200:203], v[48:51]
    ds_read_b128 v[152:155], v12 offset:4096
    ds_read_b128 v[156:159], v12 offset:6144
    v_mfma_f32_16x16x32_bf16 v[64:67], v[224:227], v[204:207], v[64:67]
    ds_read_b64_tr_b16 v[180:181], v11 offset:0
    ds_read_b64_tr_b16 v[182:183], v11 offset:2048
    v_mfma_f32_16x16x32_bf16 v[20:23], v[228:231], v[192:195], v[20:23]
    v_mfma_f32_16x16x32_bf16 v[36:39], v[228:231], v[196:199], v[36:39]
    v_mfma_f32_16x16x32_bf16 v[52:55], v[228:231], v[200:203], v[52:55]
    v_mfma_f32_16x16x32_bf16 v[68:71], v[228:231], v[204:207], v[68:71]
    v_mfma_f32_16x16x32_bf16 v[24:27], v[232:235], v[192:195], v[24:27]
    v_mfma_f32_16x16x32_bf16 v[40:43], v[232:235], v[196:199], v[40:43]
    v_mfma_f32_16x16x32_bf16 v[56:59], v[232:235], v[200:203], v[56:59]
    v_mfma_f32_16x16x32_bf16 v[72:75], v[232:235], v[204:207], v[72:75]
    v_mfma_f32_16x16x32_bf16 v[28:31], v[236:239], v[192:195], v[28:31]
    v_mfma_f32_16x16x32_bf16 v[44:47], v[236:239], v[196:199], v[44:47]
    v_mfma_f32_16x16x32_bf16 v[60:63], v[236:239], v[200:203], v[60:63]
    v_mfma_f32_16x16x32_bf16 v[76:79], v[236:239], v[204:207], v[76:79]
    s_waitcnt lgkmcnt(0)
    v_mfma_f32_16x16x32_bf16 v[16:19], v[176:179], v[144:147], v[16:19]
    ds_read_b64_tr_b16 v[224:225], v10 offset:4096
    ds_read_b64_tr_b16 v[226:227], v10 offset:6144
    s_nop 0
    v_cvt_pk_bf16_f32 v24, v24, v25
    v_mfma_f32_16x16x32_bf16 v[32:35], v[176:179], v[148:151], v[32:35]
    ds_read_b128 v[192:195], v12 offset:1024
    ds_read_b128 v[196:199], v12 offset:3072
    v_cvt_pk_bf16_f32 v25, v26, v27
    v_cvt_pk_bf16_f32 v26, v28, v29
    v_mfma_f32_16x16x32_bf16 v[48:51], v[176:179], v[152:155], v[48:51]
    ds_read_b128 v[200:203], v12 offset:5120
    ds_read_b128 v[204:207], v12 offset:7168
    v_cvt_pk_bf16_f32 v27, v30, v31
    v_min_u32 v24, 0xfffffffe, v24
    v_min_u32 v25, 0xfffffffe, v25
    v_mfma_f32_16x16x32_bf16 v[64:67], v[176:179], v[156:159], v[64:67]
    ds_read_b64_tr_b16 v[228:229], v11 offset:4096
    ds_read_b64_tr_b16 v[230:231], v11 offset:6144
    v_min_u32 v26, 0xfffffffe, v26
    v_min_u32 v27, 0xfffffffe, v27
    v_mfma_f32_16x16x32_bf16 v[20:23], v[180:183], v[144:147], v[20:23]
    buffer_store_dwordx4 v[24:27], v5, s[28:31], s52 offen offset:0 sc1
    v_cvt_pk_bf16_f32 v40, v40, v41
    v_mfma_f32_16x16x32_bf16 v[36:39], v[180:183], v[148:151], v[36:39]
    v_cvt_pk_bf16_f32 v41, v42, v43
    v_cvt_pk_bf16_f32 v42, v44, v45
    v_cvt_pk_bf16_f32 v43, v46, v47
    v_mfma_f32_16x16x32_bf16 v[52:55], v[180:183], v[152:155], v[52:55]
    v_min_u32 v40, 0xfffffffe, v40
    v_min_u32 v41, 0xfffffffe, v41
    v_mfma_f32_16x16x32_bf16 v[68:71], v[180:183], v[156:159], v[68:71]
    v_min_u32 v42, 0xfffffffe, v42
    v_min_u32 v43, 0xfffffffe, v43
    buffer_store_dwordx4 v[40:43], v5, s[28:31], s52 offen offset:1024 sc1
    s_add_u32 s40, s40, 32768
    s_cmp_eq_u32 s40, 163840
    s_cselect_b32 s42, 0xfffe0000, s43
    s_cselect_b32 s40, 0, s40
    v_add_u32 v10, s42, v10
    v_add_u32 v11, s42, v11
    v_add_u32 v12, s42, v12
    s_waitcnt lgkmcnt(0)
    s_barrier
    v_mfma_f32_16x16x32_bf16 v[16:19], v[224:227], v[192:195], v[16:19]
    ds_read_b64_tr_b16 v[176:177], v10 offset:0
    ds_read_b64_tr_b16 v[178:179], v10 offset:2048
    v_cvt_pk_bf16_f32 v56, v56, v57
    v_cvt_pk_bf16_f32 v57, v58, v59
    v_mfma_f32_16x16x32_bf16 v[32:35], v[224:227], v[196:199], v[32:35]
    ds_read_b128 v[144:147], v12 offset:0
    ds_read_b128 v[148:151], v12 offset:2048
    v_cvt_pk_bf16_f32 v58, v60, v61
    v_cvt_pk_bf16_f32 v59, v62, v63
    v_mfma_f32_16x16x32_bf16 v[48:51], v[224:227], v[200:203], v[48:51]
    ds_read_b128 v[152:155], v12 offset:4096
    ds_read_b128 v[156:159], v12 offset:6144
    v_min_u32 v56, 0xfffffffe, v56
    v_min_u32 v57, 0xfffffffe, v57
    v_mfma_f32_16x16x32_bf16 v[64:67], v[224:227], v[204:207], v[64:67]
    ds_read_b64_tr_b16 v[180:181], v11 offset:0
    ds_read_b64_tr_b16 v[182:183], v11 offset:2048
    v_min_u32 v58, 0xfffffffe, v58
    v_min_u32 v59, 0xfffffffe, v59
    buffer_store_dwordx4 v[56:59], v5, s[28:31], s52 offen offset:2048 sc1
    v_mfma_f32_16x16x32_bf16 v[20:23], v[228:231], v[192:195], v[20:23]
    v_cvt_pk_bf16_f32 v72, v72, v73
    v_cvt_pk_bf16_f32 v73, v74, v75
    v_mfma_f32_16x16x32_bf16 v[36:39], v[228:231], v[196:199], v[36:39]
    v_cvt_pk_bf16_f32 v74, v76, v77
    v_cvt_pk_bf16_f32 v75, v78, v79
    v_mfma_f32_16x16x32_bf16 v[52:55], v[228:231], v[200:203], v[52:55]
    v_min_u32 v72, 0xfffffffe, v72
    v_min_u32 v73, 0xfffffffe, v73
    v_mfma_f32_16x16x32_bf16 v[68:71], v[228:231], v[204:207], v[68:71]
    v_min_u32 v74, 0xfffffffe, v74
    v_min_u32 v75, 0xfffffffe, v75
    buffer_store_dwordx4 v[72:75], v5, s[28:31], s52 offen offset:3072 sc1
    s_waitcnt lgkmcnt(0)
    v_mfma_f32_16x16x32_bf16 v[16:19], v[176:179], v[144:147], v[16:19]
    ds_read_b64_tr_b16 v[224:225], v10 offset:4096
    ds_read_b64_tr_b16 v[226:227], v10 offset:6144
    v_mfma_f32_16x16x32_bf16 v[32:35], v[176:179], v[148:151], v[32:35]
    ds_read_b128 v[192:195], v12 offset:1024
    ds_read_b128 v[196:199], v12 offset:3072
    v_mfma_f32_16x16x32_bf16 v[48:51], v[176:179], v[152:155], v[48:51]
    ds_read_b128 v[200:203], v12 offset:5120
    ds_read_b128 v[204:207], v12 offset:7168
    v_mfma_f32_16x16x32_bf16 v[64:67], v[176:179], v[156:159], v[64:67]
    ds_read_b64_tr_b16 v[228:229], v11 offset:4096
    ds_read_b64_tr_b16 v[230:231], v11 offset:6144
    v_mfma_f32_16x16x32_bf16 v[20:23], v[180:183], v[144:147], v[20:23]
    v_mfma_f32_16x16x32_bf16 v[36:39], v[180:183], v[148:151], v[36:39]
    v_mfma_f32_16x16x32_bf16 v[52:55], v[180:183], v[152:155], v[52:55]
    v_mfma_f32_16x16x32_bf16 v[68:71], v[180:183], v[156:159], v[68:71]
    s_add_u32 s40, s40, 32768
    s_cmp_eq_u32 s40, 163840
    s_cselect_b32 s42, 0xfffe0000, s43
    s_cselect_b32 s40, 0, s40
    v_add_u32 v10, s42, v10
    v_add_u32 v11, s42, v11
    v_add_u32 v12, s42, v12
    s_waitcnt lgkmcnt(0)
    s_barrier
    v_mfma_f32_16x16x32_bf16 v[16:19], v[224:227], v[192:195], v[16:19]
    ds_read_b64_tr_b16 v[176:177], v10 offset:0
    ds_read_b64_tr_b16 v[178:179], v10 offset:2048
    v_mfma_f32_16x16x32_bf16 v[32:35], v[224:227], v[196:199], v[32:35]
    ds_read_b128 v[144:147], v12 offset:0
    ds_read_b128 v[148:151], v12 offset:2048
    v_mfma_f32_16x16x32_bf16 v[48:51], v[224:227], v[200:203], v[48:51]
    ds_read_b128 v[152:155], v12 offset:4096
    ds_read_b128 v[156:159], v12 offset:6144
    v_mfma_f32_16x16x32_bf16 v[64:67], v[224:227], v[204:207], v[64:67]
    ds_read_b64_tr_b16 v[180:181], v11 offset:0
    ds_read_b64_tr_b16 v[182:183], v11 offset:2048
    v_mfma_f32_16x16x32_bf16 v[20:23], v[228:231], v[192:195], v[20:23]
    v_mfma_f32_16x16x32_bf16 v[36:39], v[228:231], v[196:199], v[36:39]
    v_mfma_f32_16x16x32_bf16 v[52:55], v[228:231], v[200:203], v[52:55]
    v_mfma_f32_16x16x32_bf16 v[68:71], v[228:231], v[204:207], v[68:71]
    s_waitcnt lgkmcnt(0)
    v_mfma_f32_16x16x32_bf16 v[16:19], v[176:179], v[144:147], v[16:19]
    ds_read_b64_tr_b16 v[224:225], v10 offset:4096
    ds_read_b64_tr_b16 v[226:227], v10 offset:6144
    v_mfma_f32_16x16x32_bf16 v[32:35], v[176:179], v[148:151], v[32:35]
    ds_read_b128 v[192:195], v12 offset:1024
    ds_read_b128 v[196:199], v12 offset:3072
    v_mfma_f32_16x16x32_bf16 v[48:51], v[176:179], v[152:155], v[48:51]
    ds_read_b128 v[200:203], v12 offset:5120
    ds_read_b128 v[204:207], v12 offset:7168
    v_mfma_f32_16x16x32_bf16 v[64:67], v[176:179], v[156:159], v[64:67]
    ds_read_b64_tr_b16 v[228:229], v11 offset:4096
    ds_read_b64_tr_b16 v[230:231], v11 offset:6144
    v_mfma_f32_16x16x32_bf16 v[20:23], v[180:183], v[144:147], v[20:23]
    v_mfma_f32_16x16x32_bf16 v[36:39], v[180:183], v[148:151], v[36:39]
    v_mfma_f32_16x16x32_bf16 v[52:55], v[180:183], v[152:155], v[52:55]
    v_mfma_f32_16x16x32_bf16 v[68:71], v[180:183], v[156:159], v[68:71]
    s_add_u32 s40, s40, 32768
    s_cmp_eq_u32 s40, 163840
    s_cselect_b32 s42, 0xfffe0000, s43
    s_cselect_b32 s40, 0, s40
    v_add_u32 v10, s42, v10
    v_add_u32 v11, s42, v11
    v_add_u32 v12, s42, v12
    s_waitcnt lgkmcnt(0)
    s_barrier
    v_mfma_f32_16x16x32_bf16 v[16:19], v[224:227], v[192:195], v[16:19]
    ds_read_b64_tr_b16 v[176:177], v10 offset:0
    ds_read_b64_tr_b16 v[178:179], v10 offset:2048
    v_mfma_f32_16x16x32_bf16 v[32:35], v[224:227], v[196:199], v[32:35]
    ds_read_b128 v[144:147], v12 offset:0
    ds_read_b128 v[148:151], v12 offset:2048
    v_mfma_f32_16x16x32_bf16 v[48:51], v[224:227], v[200:203], v[48:51]
    ds_read_b128 v[152:155], v12 offset:4096
    ds_read_b128 v[156:159], v12 offset:6144
    v_mfma_f32_16x16x32_bf16 v[64:67], v[224:227], v[204:207], v[64:67]
    ds_read_b64_tr_b16 v[180:181], v11 offset:0
    ds_read_b64_tr_b16 v[182:183], v11 offset:2048
    v_mfma_f32_16x16x32_bf16 v[20:23], v[228:231], v[192:195], v[20:23]
    v_mfma_f32_16x16x32_bf16 v[36:39], v[228:231], v[196:199], v[36:39]
    v_mfma_f32_16x16x32_bf16 v[52:55], v[228:231], v[200:203], v[52:55]
    v_mfma_f32_16x16x32_bf16 v[68:71], v[228:231], v[204:207], v[68:71]
    s_waitcnt lgkmcnt(0)
    v_mfma_f32_16x16x32_bf16 v[16:19], v[176:179], v[144:147], v[16:19]
    ds_read_b64_tr_b16 v[224:225], v10 offset:4096
    ds_read_b64_tr_b16 v[226:227], v10 offset:6144
    v_mfma_f32_16x16x32_bf16 v[32:35], v[176:179], v[148:151], v[32:35]
    ds_read_b128 v[192:195], v12 offset:1024
    ds_read_b128 v[196:199], v12 offset:3072
    v_mfma_f32_16x16x32_bf16 v[48:51], v[176:179], v[152:155], v[48:51]
    ds_read_b128 v[200:203], v12 offset:5120
    ds_read_b128 v[204:207], v12 offset:7168
    v_mfma_f32_16x16x32_bf16 v[64:67], v[176:179], v[156:159], v[64:67]
    ds_read_b64_tr_b16 v[228:229], v11 offset:4096
    ds_read_b64_tr_b16 v[230:231], v11 offset:6144
    v_mfma_f32_16x16x32_bf16 v[20:23], v[180:183], v[144:147], v[20:23]
    v_mfma_f32_16x16x32_bf16 v[36:39], v[180:183], v[148:151], v[36:39]
    v_mfma_f32_16x16x32_bf16 v[52:55], v[180:183], v[152:155], v[52:55]
    v_mfma_f32_16x16x32_bf16 v[68:71], v[180:183], v[156:159], v[68:71]
    s_add_u32 s40, s40, 32768
    s_cmp_eq_u32 s40, 163840
    s_cselect_b32 s42, 0xfffe0000, s43
    s_cselect_b32 s40, 0, s40
    v_add_u32 v10, s42, v10
    v_add_u32 v11, s42, v11
    v_add_u32 v12, s42, v12
    s_waitcnt lgkmcnt(0)
    s_barrier
    v_mfma_f32_16x16x32_bf16 v[16:19], v[224:227], v[192:195], v[16:19]
    ds_read_b64_tr_b16 v[176:177], v10 offset:0
    ds_read_b64_tr_b16 v[178:179], v10 offset:2048
    v_mfma_f32_16x16x32_bf16 v[32:35], v[224:227], v[196:199], v[32:35]
    ds_read_b128 v[144:147], v12 offset:0
    ds_read_b128 v[148:151], v12 offset:2048
    v_mfma_f32_16x16x32_bf16 v[48:51], v[224:227], v[200:203], v[48:51]
    ds_read_b128 v[152:155], v12 offset:4096
    ds_read_b128 v[156:159], v12 offset:6144
    v_mfma_f32_16x16x32_bf16 v[64:67], v[224:227], v[204:207], v[64:67]
    ds_read_b64_tr_b16 v[180:181], v11 offset:0
    ds_read_b64_tr_b16 v[182:183], v11 offset:2048
    v_mfma_f32_16x16x32_bf16 v[20:23], v[228:231], v[192:195], v[20:23]
    v_mfma_f32_16x16x32_bf16 v[36:39], v[228:231], v[196:199], v[36:39]
    v_mfma_f32_16x16x32_bf16 v[52:55], v[228:231], v[200:203], v[52:55]
    v_mfma_f32_16x16x32_bf16 v[68:71], v[228:231], v[204:207], v[68:71]
    s_waitcnt lgkmcnt(0)
    v_mfma_f32_16x16x32_bf16 v[16:19], v[176:179], v[144:147], v[16:19]
    ds_read_b64_tr_b16 v[224:225], v10 offset:4096
    ds_read_b64_tr_b16 v[226:227], v10 offset:6144
    v_mfma_f32_16x16x32_bf16 v[32:35], v[176:179], v[148:151], v[32:35]
    ds_read_b128 v[192:195], v12 offset:1024
    ds_read_b128 v[196:199], v12 offset:3072
    v_mfma_f32_16x16x32_bf16 v[48:51], v[176:179], v[152:155], v[48:51]
    ds_read_b128 v[200:203], v12 offset:5120
    ds_read_b128 v[204:207], v12 offset:7168
    v_mfma_f32_16x16x32_bf16 v[64:67], v[176:179], v[156:159], v[64:67]
    ds_read_b64_tr_b16 v[228:229], v11 offset:4096
    ds_read_b64_tr_b16 v[230:231], v11 offset:6144
    v_mfma_f32_16x16x32_bf16 v[20:23], v[180:183], v[144:147], v[20:23]
    v_mfma_f32_16x16x32_bf16 v[36:39], v[180:183], v[148:151], v[36:39]
    v_mfma_f32_16x16x32_bf16 v[52:55], v[180:183], v[152:155], v[52:55]
    v_mfma_f32_16x16x32_bf16 v[68:71], v[180:183], v[156:159], v[68:71]
    s_add_u32 s40, s40, 32768
    s_cmp_eq_u32 s40, 163840
    s_cselect_b32 s42, 0xfffe0000, s43
    s_cselect_b32 s40, 0, s40
    v_add_u32 v10, s42, v10
    v_add_u32 v11, s42, v11
    v_add_u32 v12, s42, v12
    s_waitcnt lgkmcnt(0)
    s_barrier
    v_mfma_f32_16x16x32_bf16 v[16:19], v[224:227], v[192:195], v[16:19]
    ds_read_b64_tr_b16 v[176:177], v10 offset:0
    ds_read_b64_tr_b16 v[178:179], v10 offset:2048
    v_mfma_f32_16x16x32_bf16 v[32:35], v[224:227], v[196:199], v[32:35]
    ds_read_b128 v[144:147], v12 offset:0
    ds_read_b128 v[148:151], v12 offset:2048
    v_mfma_f32_16x16x32_bf16 v[48:51], v[224:227], v[200:203], v[48:51]
    ds_read_b128 v[152:155], v12 offset:4096
    ds_read_b128 v[156:159], v12 offset:6144
    v_mfma_f32_16x16x32_bf16 v[64:67], v[224:227], v[204:207], v[64:67]
    ds_read_b64_tr_b16 v[180:181], v11 offset:0
    ds_read_b64_tr_b16 v[182:183], v11 offset:2048
    v_mfma_f32_16x16x32_bf16 v[20:23], v[228:231], v[192:195], v[20:23]
    v_mfma_f32_16x16x32_bf16 v[36:39], v[228:231], v[196:199], v[36:39]
    v_mfma_f32_16x16x32_bf16 v[52:55], v[228:231], v[200:203], v[52:55]
    v_mfma_f32_16x16x32_bf16 v[68:71], v[228:231], v[204:207], v[68:71]
    s_waitcnt lgkmcnt(0)
    v_mfma_f32_16x16x32_bf16 v[16:19], v[176:179], v[144:147], v[16:19]
    ds_read_b64_tr_b16 v[224:225], v10 offset:4096
    ds_read_b64_tr_b16 v[226:227], v10 offset:6144
    v_mfma_f32_16x16x32_bf16 v[32:35], v[176:179], v[148:151], v[32:35]
    ds_read_b128 v[192:195], v12 offset:1024
    ds_read_b128 v[196:199], v12 offset:3072
    v_mfma_f32_16x16x32_bf16 v[48:51], v[176:179], v[152:155], v[48:51]
    ds_read_b128 v[200:203], v12 offset:5120
    ds_read_b128 v[204:207], v12 offset:7168
    v_mfma_f32_16x16x32_bf16 v[64:67], v[176:179], v[156:159], v[64:67]
    ds_read_b64_tr_b16 v[228:229], v11 offset:4096
    ds_read_b64_tr_b16 v[230:231], v11 offset:6144
    v_mfma_f32_16x16x32_bf16 v[20:23], v[180:183], v[144:147], v[20:23]
    v_mfma_f32_16x16x32_bf16 v[36:39], v[180:183], v[148:151], v[36:39]
    v_mfma_f32_16x16x32_bf16 v[52:55], v[180:183], v[152:155], v[52:55]
    v_mfma_f32_16x16x32_bf16 v[68:71], v[180:183], v[156:159], v[68:71]
    s_add_u32 s40, s40, 32768
    s_cmp_eq_u32 s40, 163840
    s_cselect_b32 s42, 0xfffe0000, s43
    s_cselect_b32 s40, 0, s40
    v_add_u32 v10, s42, v10
    v_add_u32 v11, s42, v11
    v_add_u32 v12, s42, v12
    s_waitcnt lgkmcnt(0)
    s_barrier
    v_mfma_f32_16x16x32_bf16 v[16:19], v[224:227], v[192:195], v[16:19]
    ds_read_b64_tr_b16 v[176:177], v10 offset:0
    ds_read_b64_tr_b16 v[178:179], v10 offset:2048
    v_mfma_f32_16x16x32_bf16 v[32:35], v[224:227], v[196:199], v[32:35]
    ds_read_b128 v[144:147], v12 offset:0
    ds_read_b128 v[148:151], v12 offset:2048
    v_mfma_f32_16x16x32_bf16 v[48:51], v[224:227], v[200:203], v[48:51]
    ds_read_b128 v[152:155], v12 offset:4096
    ds_read_b128 v[156:159], v12 offset:6144
    v_mfma_f32_16x16x32_bf16 v[64:67], v[224:227], v[204:207], v[64:67]
    ds_read_b64_tr_b16 v[180:181], v11 offset:0
    ds_read_b64_tr_b16 v[182:183], v11 offset:2048
    v_mfma_f32_16x16x32_bf16 v[20:23], v[228:231], v[192:195], v[20:23]
    v_mfma_f32_16x16x32_bf16 v[36:39], v[228:231], v[196:199], v[36:39]
    v_mfma_f32_16x16x32_bf16 v[52:55], v[228:231], v[200:203], v[52:55]
    v_mfma_f32_16x16x32_bf16 v[68:71], v[228:231], v[204:207], v[68:71]
    s_waitcnt lgkmcnt(0)
    v_mfma_f32_16x16x32_bf16 v[16:19], v[176:179], v[144:147], v[16:19]
    ds_read_b64_tr_b16 v[224:225], v10 offset:4096
    ds_read_b64_tr_b16 v[226:227], v10 offset:6144
    v_mfma_f32_16x16x32_bf16 v[32:35], v[176:179], v[148:151], v[32:35]
    ds_read_b128 v[192:195], v12 offset:1024
    ds_read_b128 v[196:199], v12 offset:3072
    buffer_load_dwordx4 v[128:131], v5, s[28:31], s57 offen offset:0 sc1
    v_mfma_f32_16x16x32_bf16 v[48:51], v[176:179], v[152:155], v[48:51]
    ds_read_b128 v[200:203], v12 offset:5120
    ds_read_b128 v[204:207], v12 offset:7168
    v_mfma_f32_16x16x32_bf16 v[64:67], v[176:179], v[156:159], v[64:67]
    ds_read_b64_tr_b16 v[228:229], v11 offset:4096
    ds_read_b64_tr_b16 v[230:231], v11 offset:6144
    buffer_load_dwordx4 v[132:135], v5, s[28:31], s57 offen offset:1024 sc1
    v_mfma_f32_16x16x32_bf16 v[20:23], v[180:183], v[144:147], v[20:23]
    v_mfma_f32_16x16x32_bf16 v[36:39], v[180:183], v[148:151], v[36:39]
    buffer_load_dwordx4 v[136:139], v5, s[28:31], s57 offen offset:2048 sc1
    v_mfma_f32_16x16x32_bf16 v[52:55], v[180:183], v[152:155], v[52:55]
    v_mfma_f32_16x16x32_bf16 v[68:71], v[180:183], v[156:159], v[68:71]
    buffer_load_dwordx4 v[140:143], v5, s[28:31], s57 offen offset:3072 sc1
    s_add_u32 s40, s40, 32768
    s_cmp_eq_u32 s40, 163840
    s_cselect_b32 s42, 0xfffe0000, s43
    s_cselect_b32 s40, 0, s40
    v_add_u32 v10, s42, v10
    v_add_u32 v11, s42, v11
    v_add_u32 v12, s42, v12
    s_waitcnt lgkmcnt(0)
    s_barrier
    v_mfma_f32_16x16x32_bf16 v[16:19], v[224:227], v[192:195], v[16:19]
    ds_read_b64_tr_b16 v[176:177], v10 offset:0
    ds_read_b64_tr_b16 v[178:179], v10 offset:2048
    v_mfma_f32_16x16x32_bf16 v[32:35], v[224:227], v[196:199], v[32:35]
    ds_read_b128 v[144:147], v12 offset:0
    ds_read_b128 v[148:151], v12 offset:2048
    v_mfma_f32_16x16x32_bf16 v[48:51], v[224:227], v[200:203], v[48:51]
    ds_read_b128 v[152:155], v12 offset:4096
    ds_read_b128 v[156:159], v12 offset:6144
    v_mfma_f32_16x16x32_bf16 v[64:67], v[224:227], v[204:207], v[64:67]
    ds_read_b64_tr_b16 v[180:181], v11 offset:0
    ds_read_b64_tr_b16 v[182:183], v11 offset:2048
    v_mfma_f32_16x16x32_bf16 v[20:23], v[228:231], v[192:195], v[20:23]
    v_mfma_f32_16x16x32_bf16 v[36:39], v[228:231], v[196:199], v[36:39]
    v_mfma_f32_16x16x32_bf16 v[52:55], v[228:231], v[200:203], v[52:55]
    v_mfma_f32_16x16x32_bf16 v[68:71], v[228:231], v[204:207], v[68:71]
    s_waitcnt lgkmcnt(0)
    v_mfma_f32_16x16x32_bf16 v[16:19], v[176:179], v[144:147], v[16:19]
    ds_read_b64_tr_b16 v[224:225], v10 offset:4096
    ds_read_b64_tr_b16 v[226:227], v10 offset:6144
    v_mfma_f32_16x16x32_bf16 v[32:35], v[176:179], v[148:151], v[32:35]
    ds_read_b128 v[192:195], v12 offset:1024
    ds_read_b128 v[196:199], v12 offset:3072
    v_mfma_f32_16x16x32_bf16 v[48:51], v[176:179], v[152:155], v[48:51]
    ds_read_b128 v[200:203], v12 offset:5120
    ds_read_b128 v[204:207], v12 offset:7168
    v_mfma_f32_16x16x32_bf16 v[64:67], v[176:179], v[156:159], v[64:67]
    ds_read_b64_tr_b16 v[228:229], v11 offset:4096
    ds_read_b64_tr_b16 v[230:231], v11 offset:6144
    v_mfma_f32_16x16x32_bf16 v[20:23], v[180:183], v[144:147], v[20:23]
    v_mfma_f32_16x16x32_bf16 v[36:39], v[180:183], v[148:151], v[36:39]
    v_mfma_f32_16x16x32_bf16 v[52:55], v[180:183], v[152:155], v[52:55]
    v_mfma_f32_16x16x32_bf16 v[68:71], v[180:183], v[156:159], v[68:71]
    s_add_u32 s40, s40, 32768
    s_cmp_eq_u32 s40, 163840
    s_cselect_b32 s42, 0xfffe0000, s43
    s_cselect_b32 s40, 0, s40
    v_add_u32 v10, s42, v10
    v_add_u32 v11, s42, v11
    v_add_u32 v12, s42, v12
    s_waitcnt lgkmcnt(0)
    v_mfma_f32_16x16x32_bf16 v[16:19], v[224:227], v[192:195], v[16:19]
    v_mfma_f32_16x16x32_bf16 v[32:35], v[224:227], v[196:199], v[32:35]
    v_mfma_f32_16x16x32_bf16 v[48:51], v[224:227], v[200:203], v[48:51]
    v_mfma_f32_16x16x32_bf16 v[64:67], v[224:227], v[204:207], v[64:67]
    v_mfma_f32_16x16x32_bf16 v[20:23], v[228:231], v[192:195], v[20:23]
    v_mfma_f32_16x16x32_bf16 v[36:39], v[228:231], v[196:199], v[36:39]
    v_mfma_f32_16x16x32_bf16 v[52:55], v[228:231], v[200:203], v[52:55]
    v_mfma_f32_16x16x32_bf16 v[68:71], v[228:231], v[204:207], v[68:71]
    s_mov_b32 s56, 0x100000
    s_waitcnt vmcnt(0)
.Lk3_poll_81:
    v_max3_u32 v7, v128, v129, v130
    v_max3_u32 v7, v7, v131, v132
    v_max3_u32 v7, v7, v133, v134
    v_max3_u32 v7, v7, v135, v136
    v_max3_u32 v7, v7, v137, v138
    v_max3_u32 v7, v7, v139, v140
    v_max3_u32 v7, v7, v141, v142
    v_max_u32 v7, v7, v143
    v_cmp_eq_u32 vcc, -1, v7
    s_cbranch_vccz .Lk3_ok_82
    buffer_load_dwordx4 v[128:131], v5, s[28:31], s57 offen offset:0 sc1
    buffer_load_dwordx4 v[132:135], v5, s[28:31], s57 offen offset:1024 sc1
    buffer_load_dwordx4 v[136:139], v5, s[28:31], s57 offen offset:2048 sc1
    buffer_load_dwordx4 v[140:143], v5, s[28:31], s57 offen offset:3072 sc1
    s_waitcnt vmcnt(0)
    s_sub_u32 s56, s56, 1
    s_cbranch_scc0 .Lk3_poll_81
.Lk3_ok_82:
    v_mfma_f32_16x16x32_bf16 v[16:19], v[242:245], v[128:131], v[16:19]
    v_mfma_f32_16x16x32_bf16 v[32:35], v[242:245], v[132:135], v[32:35]
    v_mfma_f32_16x16x32_bf16 v[48:51], v[242:245], v[136:139], v[48:51]
    v_mfma_f32_16x16x32_bf16 v[64:67], v[242:245], v[140:143], v[64:67]
    v_mfma_f32_16x16x32_bf16 v[20:23], v[240:243], v[128:131], v[20:23]
    v_mfma_f32_16x16x32_bf16 v[36:39], v[240:243], v[132:135], v[36:39]
    v_mfma_f32_16x16x32_bf16 v[52:55], v[240:243], v[136:139], v[52:55]
    v_mfma_f32_16x16x32_bf16 v[68:71], v[240:243], v[140:143], v[68:71]
    s_nop 4
    v_pk_fma_f32 v[96:97], v[246:247], v[16:17], v[96:97]
    v_pk_fma_f32 v[98:99], v[248:249], v[18:19], v[98:99]
    v_pk_fma_f32 v[100:101], v[250:251], v[20:21], v[100:101]
    v_pk_fma_f32 v[102:103], v[252:253], v[22:23], v[102:103]
    v_cvt_pk_bf16_f32 v144, v96, v97
    v_cvt_pk_bf16_f32 v145, v98, v99
    v_cvt_pk_bf16_f32 v146, v100, v101
    v_cvt_pk_bf16_f32 v147, v102, v103
    s_nop 0
    v_permlane16_swap_b32 v144, v146
    v_permlane16_swap_b32 v145, v147
    buffer_store_dwordx4 v[144:147], v13, s[24:27], s48 offen sc0 sc1
    s_add_u32 s48, s48, 32768
    v_pk_fma_f32 v[104:105], v[246:247], v[32:33], v[104:105]
    v_pk_fma_f32 v[106:107], v[248:249], v[34:35], v[106:107]
    v_pk_fma_f32 v[108:109], v[250:251], v[36:37], v[108:109]
    v_pk_fma_f32 v[110:111], v[252:253], v[38:39], v[110:111]
    v_cvt_pk_bf16_f32 v148, v104, v105
    v_cvt_pk_bf16_f32 v149, v106, v107
    v_cvt_pk_bf16_f32 v150, v108, v109
    v_cvt_pk_bf16_f32 v151, v110, v111
    s_nop 0
    v_permlane16_swap_b32 v148, v150
    v_permlane16_swap_b32 v149, v151
    buffer_store_dwordx4 v[148:151], v13, s[24:27], s48 offen sc0 sc1
    s_add_u32 s48, s48, 32768
    v_pk_fma_f32 v[112:113], v[246:247], v[48:49], v[112:113]
    v_pk_fma_f32 v[114:115], v[248:249], v[50:51], v[114:115]
    v_pk_fma_f32 v[116:117], v[250:251], v[52:53], v[116:117]
    v_pk_fma_f32 v[118:119], v[252:253], v[54:55], v[118:119]
    v_cvt_pk_bf16_f32 v152, v112, v113
    v_cvt_pk_bf16_f32 v153, v114, v115
    v_cvt_pk_bf16_f32 v154, v116, v117
    v_cvt_pk_bf16_f32 v155, v118, v119
    s_nop 0
    v_permlane16_swap_b32 v152, v154
    v_permlane16_swap_b32 v153, v155
    buffer_store_dwordx4 v[152:155], v13, s[24:27], s48 offen sc0 sc1
    s_add_u32 s48, s48, 32768
    v_pk_fma_f32 v[120:121], v[246:247], v[64:65], v[120:121]
    v_pk_fma_f32 v[122:123], v[248:249], v[66:67], v[122:123]
    v_pk_fma_f32 v[124:125], v[250:251], v[68:69], v[124:125]
    v_pk_fma_f32 v[126:127], v[252:253], v[70:71], v[126:127]
    v_cvt_pk_bf16_f32 v156, v120, v121
    v_cvt_pk_bf16_f32 v157, v122, v123
    v_cvt_pk_bf16_f32 v158, v124, v125
    v_cvt_pk_bf16_f32 v159, v126, v127
    s_nop 0
    v_permlane16_swap_b32 v156, v158
    v_permlane16_swap_b32 v157, v159
    buffer_store_dwordx4 v[156:159], v13, s[24:27], s48 offen sc0 sc1
.Lk3_end_1:
    s_endpgm

.section .rodata,"a"
.p2align 6
.amdhsa_kernel k3_attn_kernel
  .amdhsa_next_free_vgpr 256
  .amdhsa_next_free_sgpr 102
  .amdhsa_accum_offset 256
  .amdhsa_group_segment_fixed_size 0
  .amdhsa_kernarg_size 104
  .amdhsa_user_sgpr_count 2
  .amdhsa_user_sgpr_kernarg_segment_ptr 1
  .amdhsa_system_sgpr_workgroup_id_x 1
.end_amdhsa_kernel
```
